```python
import torch

def _softmax(x, axis=-1):
    return torch.softmax(x, dim=axis)
def _gelu(x):
    return torch.nn.functional.gelu(x, approximate="tanh")
def _silu(x):
    return torch.nn.functional.silu(x)
def _sigmoid(x):
    return torch.sigmoid(x)
def _layernorm(x, axis=-1, eps=1e-5):
    m = x.mean(dim=axis, keepdim=True)
    v = x.var(dim=axis, keepdim=True, unbiased=False)
    return (x - m) / torch.sqrt(v + eps)
def _scatter_add(tgt, idx, src, axis=0):
    return tgt.clone().index_add_(axis, idx, src)
def _segment_sum(src, seg, n):
    out = torch.zeros((n,) + src.shape[1:], dtype=src.dtype)
    return out.index_add_(0, seg, src)
def _pad(x, pw):
    flat = tuple(v for pair in reversed(pw) for v in pair)
    return torch.nn.functional.pad(x, flat)

kernel_name = 'parallel_sum__mha_block__swiglu_ffn__prompt'

def setup_inputs():

    _w = (lambda a: (lambda t: t.to(torch.bfloat16) if t.is_floating_point() else t)(torch.as_tensor(a)))
    def _A_setup():
        B, S, D, H = 1, 2048, 512, 32
        return {
            "x": _w((lambda *s: torch.randn(*s, dtype=torch.bfloat16) * 0.05)(B, S, D)),
            "wqkv": _w((lambda *s: torch.randn(*s, dtype=torch.bfloat16) * 0.2)(D, 3 * D)),
            "wo": _w((lambda *s: torch.randn(*s, dtype=torch.bfloat16) * 0.1)(D, D)),
        }
    _A_in = _A_setup()

    def _B_setup():
        B, S, D, F = 1, 2048, 512, 1376
        return {
            "x": _w((lambda *s: torch.randn(*s, dtype=torch.bfloat16) * 0.05)(B, S, D)),
            "w_gate": _w((lambda *s: torch.randn(*s, dtype=torch.bfloat16) * 0.1)(D, F)),
            "w_up": _w((lambda *s: torch.randn(*s, dtype=torch.bfloat16) * 0.1)(D, F)),
            "w_down": _w((lambda *s: torch.randn(*s, dtype=torch.bfloat16) * 0.1)(F, D)),
        }
    _B_in = _B_setup()

    return {
        "A_x": _A_in["x"],
        "A_wqkv": _A_in["wqkv"],
        "A_wo": _A_in["wo"],
        "B_x": _B_in["x"],
        "B_w_gate": _B_in["w_gate"],
        "B_w_up": _B_in["w_up"],
        "B_w_down": _B_in["w_down"],
    }

def reference(A_x, A_wqkv, A_wo, B_x, B_w_gate, B_w_up, B_w_down):
    def _A_ref(x, wqkv, wo):
        B, S, D = x.shape
        H = 32
        Dh = D // H
        qkv = (lambda x, *d: x.permute(*d))((x @ wqkv).reshape(B, S, 3, H, Dh), 2, 0, 3, 1, 4)
        q, k, v = qkv[0], qkv[1], qkv[2]
        scores = torch.einsum("bhqd,bhkd->bhqk", q, k) * (Dh ** -0.5)
        p = _softmax(scores, axis=-1)
        o = torch.einsum("bhqk,bhkd->bhqd", p, v)
        return (lambda x, *d: x.permute(*d))(o, 0, 2, 1, 3).reshape(B, S, D) @ wo

    def _B_ref(x, w_gate, w_up, w_down):
        g = _silu(x @ w_gate)
        u = x @ w_up
        return (g * u) @ w_down

    x = A_x
    xn = _layernorm(x, axis=-1)
    return x + _A_ref(xn, A_wqkv, A_wo) + _B_ref(xn, B_w_gate, B_w_up, B_w_down)
```

```asm
; @launch kernel=k1_kernel grid=(256,1,1) block=(512,1,1) lds=163840
; @launch kernel=k2_kernel grid=(256,1,1) block=(512,1,1) lds=133120
; @launch kernel=k3_kernel grid=(256,1,1) block=(256,1,1) lds=0
.amdgcn_target "amdgcn-amd-amdhsa--gfx950"
.text
.globl k1_kernel
.p2align 8
.type k1_kernel,@function
k1_kernel:
    s_cmp_ge_u32 s2, 256
    s_cbranch_scc1 K1_end
    s_load_dwordx4 s[4:7], s[0:1], 0
    s_load_dwordx4 s[8:11], s[0:1], 32
    s_load_dwordx2 s[12:13], s[0:1], 72
    s_load_dwordx2 s[44:45], s[0:1], 16
    s_load_dwordx2 s[48:49], s[0:1], 48
    v_lshrrev_b32 v1, 6, v0
    v_and_b32 v2, 63, v0
    s_nop 0
    v_readfirstlane_b32 s3, v1
    s_and_b32 s14, s2, 1
    s_lshl_b32 s14, s14, 3
    s_lshr_b32 s15, s2, 5
    s_add_u32 s14, s14, s15
    s_lshr_b32 s15, s2, 1
    s_and_b32 s15, s15, 3
    s_lshl_b32 s15, s15, 2
    s_lshr_b32 s40, s2, 3
    s_and_b32 s40, s40, 3
    s_add_u32 s15, s15, s40
    s_and_b32 s40, s3, 3
    s_lshr_b32 s41, s3, 2
    s_lshl_b32 s26, s15, 7
    s_lshl_b32 s27, s40, 5
    s_add_u32 s26, s26, s27
    v_and_b32 v3, 31, v2
    v_lshrrev_b32 v4, 5, v2
    v_add_u32 v5, s26, v3
    s_waitcnt lgkmcnt(0)
    s_mov_b32 s16, s4
    s_mov_b32 s17, s5
    s_mov_b32 s18, 0x200000
    s_mov_b32 s19, 0x00020000
    s_mov_b32 s20, s12
    s_mov_b32 s21, s13
    s_mov_b32 s22, 25165824
    s_mov_b32 s23, 0x00020000
    s_mov_b32 s36, s6
    s_mov_b32 s37, s7
    s_mov_b32 s38, 1572864
    s_mov_b32 s39, 0x00020000
    s_lshl_b32 s29, s40, 15
    s_lshl_b32 s42, s41, 14
    s_add_u32 s42, s42, s29
    s_lshl_b32 s28, s15, 17
    s_add_u32 s28, s28, s42

    s_mov_b32 s46, 524288
    s_mov_b32 s47, 0x00020000
    s_mov_b32 s50, 1409024
    s_mov_b32 s51, 0x00020000
    s_lshl_b32 s52, s2, 3
    s_add_u32 s52, s52, s3
    s_lshr_b32 s53, s52, 4
    s_and_b32 s54, s52, 15
    s_mul_i32 s55, s54, 118
    s_add_u32 s55, s55, s53
    s_lshl_b32 s55, s55, 10
    s_add_u32 s55, s55, 14680064
    s_lshl_b32 s35, s54, 6

    v_xor_b32 v6, 0, v2
    v_lshlrev_b32 v6, 4, v6
    s_add_u32 s30, s42, 0
    s_mov_b32 m0, s30
    s_add_u32 s31, s28, 0
    buffer_load_dwordx4 v6, s[16:19], s31 offen lds

    v_xor_b32 v6, 1, v2
    v_lshlrev_b32 v6, 4, v6
    s_add_u32 s30, s42, 1024
    s_mov_b32 m0, s30
    s_add_u32 s31, s28, 1024
    buffer_load_dwordx4 v6, s[16:19], s31 offen lds

    v_xor_b32 v6, 2, v2
    v_lshlrev_b32 v6, 4, v6
    s_add_u32 s30, s42, 2048
    s_mov_b32 m0, s30
    s_add_u32 s31, s28, 2048
    buffer_load_dwordx4 v6, s[16:19], s31 offen lds

    v_xor_b32 v6, 3, v2
    v_lshlrev_b32 v6, 4, v6
    s_add_u32 s30, s42, 3072
    s_mov_b32 m0, s30
    s_add_u32 s31, s28, 3072
    buffer_load_dwordx4 v6, s[16:19], s31 offen lds

    v_xor_b32 v6, 4, v2
    v_lshlrev_b32 v6, 4, v6
    s_add_u32 s30, s42, 4096
    s_mov_b32 m0, s30
    s_add_u32 s31, s28, 4096
    buffer_load_dwordx4 v6, s[16:19], s31 offen lds

    v_xor_b32 v6, 5, v2
    v_lshlrev_b32 v6, 4, v6
    s_add_u32 s30, s42, 5120
    s_mov_b32 m0, s30
    s_add_u32 s31, s28, 5120
    buffer_load_dwordx4 v6, s[16:19], s31 offen lds

    v_xor_b32 v6, 6, v2
    v_lshlrev_b32 v6, 4, v6
    s_add_u32 s30, s42, 6144
    s_mov_b32 m0, s30
    s_add_u32 s31, s28, 6144
    buffer_load_dwordx4 v6, s[16:19], s31 offen lds

    v_xor_b32 v6, 7, v2
    v_lshlrev_b32 v6, 4, v6
    s_add_u32 s30, s42, 7168
    s_mov_b32 m0, s30
    s_add_u32 s31, s28, 7168
    buffer_load_dwordx4 v6, s[16:19], s31 offen lds

    v_xor_b32 v6, 8, v2
    v_lshlrev_b32 v6, 4, v6
    s_add_u32 s30, s42, 8192
    s_mov_b32 m0, s30
    s_add_u32 s31, s28, 8192
    buffer_load_dwordx4 v6, s[16:19], s31 offen lds

    v_xor_b32 v6, 9, v2
    v_lshlrev_b32 v6, 4, v6
    s_add_u32 s30, s42, 9216
    s_mov_b32 m0, s30
    s_add_u32 s31, s28, 9216
    buffer_load_dwordx4 v6, s[16:19], s31 offen lds

    v_xor_b32 v6, 10, v2
    v_lshlrev_b32 v6, 4, v6
    s_add_u32 s30, s42, 10240
    s_mov_b32 m0, s30
    s_add_u32 s31, s28, 10240
    buffer_load_dwordx4 v6, s[16:19], s31 offen lds

    v_xor_b32 v6, 11, v2
    v_lshlrev_b32 v6, 4, v6
    s_add_u32 s30, s42, 11264
    s_mov_b32 m0, s30
    s_add_u32 s31, s28, 11264
    buffer_load_dwordx4 v6, s[16:19], s31 offen lds

    v_xor_b32 v6, 12, v2
    v_lshlrev_b32 v6, 4, v6
    s_add_u32 s30, s42, 12288
    s_mov_b32 m0, s30
    s_add_u32 s31, s28, 12288
    buffer_load_dwordx4 v6, s[16:19], s31 offen lds

    v_xor_b32 v6, 13, v2
    v_lshlrev_b32 v6, 4, v6
    s_add_u32 s30, s42, 13312
    s_mov_b32 m0, s30
    s_add_u32 s31, s28, 13312
    buffer_load_dwordx4 v6, s[16:19], s31 offen lds

    v_xor_b32 v6, 14, v2
    v_lshlrev_b32 v6, 4, v6
    s_add_u32 s30, s42, 14336
    s_mov_b32 m0, s30
    s_add_u32 s31, s28, 14336
    buffer_load_dwordx4 v6, s[16:19], s31 offen lds

    v_xor_b32 v6, 15, v2
    v_lshlrev_b32 v6, 4, v6
    s_add_u32 s30, s42, 15360
    s_mov_b32 m0, s30
    s_add_u32 s31, s28, 15360
    buffer_load_dwordx4 v6, s[16:19], s31 offen lds

    v_lshrrev_b32 v6, 4, v2
    v_and_b32 v7, 15, v2
    v_lshlrev_b32 v8, 2, v6
    v_xor_b32 v7, v7, v8
    v_mul_u32_u24 v9, 3072, v6
    v_lshl_add_u32 v9, v7, 4, v9
    v_mul_u32_u24 v10, 2752, v6
    v_and_b32 v11, 8, v7
    v_cmp_ne_u32 vcc, 0, v11
    v_and_b32 v11, 7, v7
    v_xor_b32 v12, 2, v11
    v_mov_b32 v13, s8
    v_mov_b32 v14, s9
    v_mov_b32 v15, s10
    v_cndmask_b32 v11, v11, v12, vcc
    v_mov_b32 v12, s11
    v_cndmask_b32 v13, v13, v15, vcc
    v_cndmask_b32 v14, v14, v12, vcc
    v_lshl_add_u32 v10, v11, 4, v10
    v_add_co_u32 v10, vcc, v13, v10
    s_nop 1
    v_addc_co_u32 v11, vcc, 0, v14, vcc
    v_lshrrev_b32 v12, 2, v2
    v_mul_u32_u24 v12, 2752, v12
    v_and_b32 v13, 1, v2
    v_lshl_add_u32 v12, v13, 4, v12
    v_and_b32 v13, 2, v2
    v_cmp_ne_u32 vcc, 0, v13
    v_mov_b32 v13, s8
    v_mov_b32 v14, s9
    v_mov_b32 v15, s10
    v_mov_b32 v32, s11
    v_cndmask_b32 v13, v13, v15, vcc
    v_cndmask_b32 v14, v14, v32, vcc
    s_nop 1
    v_add_co_u32 v12, vcc, v13, v12
    s_nop 1
    v_addc_co_u32 v13, vcc, 0, v14, vcc
    s_lshl_b32 s33, s3, 12
    s_lshl_b32 s34, s3, 4
    s_cmp_ge_u32 s14, 6
    s_cbranch_scc1 K1_ffn
    s_cmp_ge_u32 s14, 4
    s_cbranch_scc1 K1_v

    s_mul_i32 s30, s34, 3072
    s_lshl_b32 s31, s14, 9
    s_add_u32 s30, s30, s31
    s_add_u32 s30, s30, 0

    s_add_u32 s31, s33, 131072
    s_mov_b32 m0, s31
    s_add_u32 s32, s30, 0
    buffer_load_dwordx4 v9, s[36:39], s32 offen lds

    s_add_u32 s31, s33, 132096
    s_mov_b32 m0, s31
    s_add_u32 s32, s30, 12288
    buffer_load_dwordx4 v9, s[36:39], s32 offen lds

    s_add_u32 s31, s33, 133120
    s_mov_b32 m0, s31
    s_add_u32 s32, s30, 24576
    buffer_load_dwordx4 v9, s[36:39], s32 offen lds

    s_add_u32 s31, s33, 134144
    s_mov_b32 m0, s31
    s_add_u32 s32, s30, 36864
    buffer_load_dwordx4 v9, s[36:39], s32 offen lds

    v_and_b32 v6, 15, v3
    v_lshlrev_b32 v7, 10, v3
    v_add_u32 v7, s29, v7

    v_add_u32 v8, 0, v4
    v_xor_b32 v8, v8, v6
    v_lshl_add_u32 v16, v8, 4, v7

    v_add_u32 v8, 2, v4
    v_xor_b32 v8, v8, v6
    v_lshl_add_u32 v17, v8, 4, v7

    v_add_u32 v8, 4, v4
    v_xor_b32 v8, v8, v6
    v_lshl_add_u32 v18, v8, 4, v7

    v_add_u32 v8, 6, v4
    v_xor_b32 v8, v8, v6
    v_lshl_add_u32 v19, v8, 4, v7

    v_add_u32 v8, 8, v4
    v_xor_b32 v8, v8, v6
    v_lshl_add_u32 v20, v8, 4, v7

    v_add_u32 v8, 10, v4
    v_xor_b32 v8, v8, v6
    v_lshl_add_u32 v21, v8, 4, v7

    v_add_u32 v8, 12, v4
    v_xor_b32 v8, v8, v6
    v_lshl_add_u32 v22, v8, 4, v7

    v_add_u32 v8, 14, v4
    v_xor_b32 v8, v8, v6
    v_lshl_add_u32 v23, v8, 4, v7

    s_waitcnt vmcnt(4)
    s_barrier
    ds_read_b128 v[128:131], v16 offset:0
    ds_read_b128 v[132:135], v17 offset:0
    ds_read_b128 v[136:139], v18 offset:0
    ds_read_b128 v[140:143], v19 offset:0
    ds_read_b128 v[144:147], v20 offset:0
    ds_read_b128 v[148:151], v21 offset:0
    ds_read_b128 v[152:155], v22 offset:0
    ds_read_b128 v[156:159], v23 offset:0
    s_waitcnt lgkmcnt(0)
    ds_read_b128 v[160:163], v16 offset:256
    ds_read_b128 v[164:167], v17 offset:256
    ds_read_b128 v[168:171], v18 offset:256
    ds_read_b128 v[172:175], v19 offset:256
    ds_read_b128 v[176:179], v20 offset:256
    ds_read_b128 v[180:183], v21 offset:256
    ds_read_b128 v[184:187], v22 offset:256
    ds_read_b128 v[188:191], v23 offset:256
    s_waitcnt lgkmcnt(0)
    ds_read_b128 v[192:195], v16 offset:512
    ds_read_b128 v[196:199], v17 offset:512
    ds_read_b128 v[200:203], v18 offset:512
    ds_read_b128 v[204:207], v19 offset:512
    ds_read_b128 v[208:211], v20 offset:512
    ds_read_b128 v[212:215], v21 offset:512
    ds_read_b128 v[216:219], v22 offset:512
    ds_read_b128 v[220:223], v23 offset:512
    s_waitcnt lgkmcnt(0)
    ds_read_b128 v[224:227], v16 offset:768
    ds_read_b128 v[228:231], v17 offset:768
    ds_read_b128 v[232:235], v18 offset:768
    ds_read_b128 v[236:239], v19 offset:768
    ds_read_b128 v[240:243], v20 offset:768
    ds_read_b128 v[244:247], v21 offset:768
    ds_read_b128 v[248:251], v22 offset:768
    ds_read_b128 v[252:255], v23 offset:768
    s_waitcnt lgkmcnt(0)
    s_barrier
    v_mov_b32 v20, 0x3f803f80
    v_mov_b32 v21, 0
    v_mov_b32 v22, 0
    v_mov_b32 v25, 0x00003f80
    v_mov_b32 v26, 0x3f800000

    v_dot2_f32_bf16 v21, v128, v20, v21
    v_dot2_f32_bf16 v22, v129, v20, v22
    v_dot2_f32_bf16 v21, v130, v20, v21
    v_dot2_f32_bf16 v22, v131, v20, v22
    v_dot2_f32_bf16 v21, v132, v20, v21
    v_dot2_f32_bf16 v22, v133, v20, v22
    v_dot2_f32_bf16 v21, v134, v20, v21
    v_dot2_f32_bf16 v22, v135, v20, v22
    v_dot2_f32_bf16 v21, v136, v20, v21
    v_dot2_f32_bf16 v22, v137, v20, v22
    v_dot2_f32_bf16 v21, v138, v20, v21
    v_dot2_f32_bf16 v22, v139, v20, v22
    v_dot2_f32_bf16 v21, v140, v20, v21
    v_dot2_f32_bf16 v22, v141, v20, v22
    v_dot2_f32_bf16 v21, v142, v20, v21
    v_dot2_f32_bf16 v22, v143, v20, v22
    v_dot2_f32_bf16 v21, v144, v20, v21
    v_dot2_f32_bf16 v22, v145, v20, v22
    v_dot2_f32_bf16 v21, v146, v20, v21
    v_dot2_f32_bf16 v22, v147, v20, v22
    v_dot2_f32_bf16 v21, v148, v20, v21
    v_dot2_f32_bf16 v22, v149, v20, v22
    v_dot2_f32_bf16 v21, v150, v20, v21
    v_dot2_f32_bf16 v22, v151, v20, v22
    v_dot2_f32_bf16 v21, v152, v20, v21
    v_dot2_f32_bf16 v22, v153, v20, v22
    v_dot2_f32_bf16 v21, v154, v20, v21
    v_dot2_f32_bf16 v22, v155, v20, v22
    v_dot2_f32_bf16 v21, v156, v20, v21
    v_dot2_f32_bf16 v22, v157, v20, v22
    v_dot2_f32_bf16 v21, v158, v20, v21
    v_dot2_f32_bf16 v22, v159, v20, v22
    s_mul_i32 s56, s34, 3072
    s_lshl_b32 s57, s14, 9
    s_add_u32 s56, s56, s57
    s_add_u32 s56, s56, 393216
    s_add_u32 s57, s33, 0
    s_mov_b32 m0, s57
    s_nop 0
    buffer_load_dwordx4 v9, s[36:39], s56 offen lds

    v_dot2_f32_bf16 v21, v160, v20, v21
    v_dot2_f32_bf16 v22, v161, v20, v22
    v_dot2_f32_bf16 v21, v162, v20, v21
    v_dot2_f32_bf16 v22, v163, v20, v22
    v_dot2_f32_bf16 v21, v164, v20, v21
    v_dot2_f32_bf16 v22, v165, v20, v22
    v_dot2_f32_bf16 v21, v166, v20, v21
    v_dot2_f32_bf16 v22, v167, v20, v22
    v_dot2_f32_bf16 v21, v168, v20, v21
    v_dot2_f32_bf16 v22, v169, v20, v22
    v_dot2_f32_bf16 v21, v170, v20, v21
    v_dot2_f32_bf16 v22, v171, v20, v22
    v_dot2_f32_bf16 v21, v172, v20, v21
    v_dot2_f32_bf16 v22, v173, v20, v22
    v_dot2_f32_bf16 v21, v174, v20, v21
    v_dot2_f32_bf16 v22, v175, v20, v22
    v_dot2_f32_bf16 v21, v176, v20, v21
    v_dot2_f32_bf16 v22, v177, v20, v22
    v_dot2_f32_bf16 v21, v178, v20, v21
    v_dot2_f32_bf16 v22, v179, v20, v22
    v_dot2_f32_bf16 v21, v180, v20, v21
    v_dot2_f32_bf16 v22, v181, v20, v22
    v_dot2_f32_bf16 v21, v182, v20, v21
    v_dot2_f32_bf16 v22, v183, v20, v22
    v_dot2_f32_bf16 v21, v184, v20, v21
    v_dot2_f32_bf16 v22, v185, v20, v22
    v_dot2_f32_bf16 v21, v186, v20, v21
    v_dot2_f32_bf16 v22, v187, v20, v22
    v_dot2_f32_bf16 v21, v188, v20, v21
    v_dot2_f32_bf16 v22, v189, v20, v22
    v_dot2_f32_bf16 v21, v190, v20, v21
    v_dot2_f32_bf16 v22, v191, v20, v22
    s_mul_i32 s56, s34, 3072
    s_lshl_b32 s57, s14, 9
    s_add_u32 s56, s56, s57
    s_add_u32 s56, s56, 405504
    s_add_u32 s57, s33, 1024
    s_mov_b32 m0, s57
    s_nop 0
    buffer_load_dwordx4 v9, s[36:39], s56 offen lds

    v_dot2_f32_bf16 v21, v192, v20, v21
    v_dot2_f32_bf16 v22, v193, v20, v22
    v_dot2_f32_bf16 v21, v194, v20, v21
    v_dot2_f32_bf16 v22, v195, v20, v22
    v_dot2_f32_bf16 v21, v196, v20, v21
    v_dot2_f32_bf16 v22, v197, v20, v22
    v_dot2_f32_bf16 v21, v198, v20, v21
    v_dot2_f32_bf16 v22, v199, v20, v22
    v_dot2_f32_bf16 v21, v200, v20, v21
    v_dot2_f32_bf16 v22, v201, v20, v22
    v_dot2_f32_bf16 v21, v202, v20, v21
    v_dot2_f32_bf16 v22, v203, v20, v22
    v_dot2_f32_bf16 v21, v204, v20, v21
    v_dot2_f32_bf16 v22, v205, v20, v22
    v_dot2_f32_bf16 v21, v206, v20, v21
    v_dot2_f32_bf16 v22, v207, v20, v22
    v_dot2_f32_bf16 v21, v208, v20, v21
    v_dot2_f32_bf16 v22, v209, v20, v22
    v_dot2_f32_bf16 v21, v210, v20, v21
    v_dot2_f32_bf16 v22, v211, v20, v22
    v_dot2_f32_bf16 v21, v212, v20, v21
    v_dot2_f32_bf16 v22, v213, v20, v22
    v_dot2_f32_bf16 v21, v214, v20, v21
    v_dot2_f32_bf16 v22, v215, v20, v22
    v_dot2_f32_bf16 v21, v216, v20, v21
    v_dot2_f32_bf16 v22, v217, v20, v22
    v_dot2_f32_bf16 v21, v218, v20, v21
    v_dot2_f32_bf16 v22, v219, v20, v22
    v_dot2_f32_bf16 v21, v220, v20, v21
    v_dot2_f32_bf16 v22, v221, v20, v22
    v_dot2_f32_bf16 v21, v222, v20, v21
    v_dot2_f32_bf16 v22, v223, v20, v22
    s_mul_i32 s56, s34, 3072
    s_lshl_b32 s57, s14, 9
    s_add_u32 s56, s56, s57
    s_add_u32 s56, s56, 417792
    s_add_u32 s57, s33, 2048
    s_mov_b32 m0, s57
    s_nop 0
    buffer_load_dwordx4 v9, s[36:39], s56 offen lds

    v_dot2_f32_bf16 v21, v224, v20, v21
    v_dot2_f32_bf16 v22, v225, v20, v22
    v_dot2_f32_bf16 v21, v226, v20, v21
    v_dot2_f32_bf16 v22, v227, v20, v22
    v_dot2_f32_bf16 v21, v228, v20, v21
    v_dot2_f32_bf16 v22, v229, v20, v22
    v_dot2_f32_bf16 v21, v230, v20, v21
    v_dot2_f32_bf16 v22, v231, v20, v22
    v_dot2_f32_bf16 v21, v232, v20, v21
    v_dot2_f32_bf16 v22, v233, v20, v22
    v_dot2_f32_bf16 v21, v234, v20, v21
    v_dot2_f32_bf16 v22, v235, v20, v22
    v_dot2_f32_bf16 v21, v236, v20, v21
    v_dot2_f32_bf16 v22, v237, v20, v22
    v_dot2_f32_bf16 v21, v238, v20, v21
    v_dot2_f32_bf16 v22, v239, v20, v22
    v_dot2_f32_bf16 v21, v240, v20, v21
    v_dot2_f32_bf16 v22, v241, v20, v22
    v_dot2_f32_bf16 v21, v242, v20, v21
    v_dot2_f32_bf16 v22, v243, v20, v22
    v_dot2_f32_bf16 v21, v244, v20, v21
    v_dot2_f32_bf16 v22, v245, v20, v22
    v_dot2_f32_bf16 v21, v246, v20, v21
    v_dot2_f32_bf16 v22, v247, v20, v22
    v_dot2_f32_bf16 v21, v248, v20, v21
    v_dot2_f32_bf16 v22, v249, v20, v22
    v_dot2_f32_bf16 v21, v250, v20, v21
    v_dot2_f32_bf16 v22, v251, v20, v22
    v_dot2_f32_bf16 v21, v252, v20, v21
    v_dot2_f32_bf16 v22, v253, v20, v22
    v_dot2_f32_bf16 v21, v254, v20, v21
    v_dot2_f32_bf16 v22, v255, v20, v22
    s_mul_i32 s56, s34, 3072
    s_lshl_b32 s57, s14, 9
    s_add_u32 s56, s56, s57
    s_add_u32 s56, s56, 430080
    s_add_u32 s57, s33, 3072
    s_mov_b32 m0, s57
    s_nop 0
    buffer_load_dwordx4 v9, s[36:39], s56 offen lds

    s_nop 3
    v_add_f32 v21, v21, v22
    v_mov_b32 v22, v21
    s_nop 1
    v_permlane32_swap_b32 v21, v22
    s_nop 1
    v_add_f32 v21, v21, v22
    v_mul_f32 v21, 0x3b000000, v21
    v_cvt_pk_bf16_f32 v22, v21, v21
    v_and_b32 v22, 0xffff0000, v22
    v_sub_f32 v23, v21, v22
    v_sub_f32 v22, 0, v22
    v_mov_b32 v24, 0
    v_mov_b32 v27, 0

    v_dot2_f32_bf16 v28, v128, v25, v22
    v_dot2_f32_bf16 v29, v128, v26, v22
    v_dot2_f32_bf16 v30, v129, v25, v22
    v_dot2_f32_bf16 v31, v129, v26, v22
    v_dot2_f32_bf16 v32, v130, v25, v22
    v_dot2_f32_bf16 v33, v130, v26, v22
    v_dot2_f32_bf16 v34, v131, v25, v22
    v_dot2_f32_bf16 v35, v131, v26, v22
    v_cvt_pk_bf16_f32 v128, v28, v29
    v_cvt_pk_bf16_f32 v129, v30, v31
    v_cvt_pk_bf16_f32 v130, v32, v33
    v_cvt_pk_bf16_f32 v131, v34, v35
    v_fmac_f32 v24, v28, v28
    v_fmac_f32 v27, v29, v29
    v_fmac_f32 v24, v30, v30
    v_fmac_f32 v27, v31, v31
    v_fmac_f32 v24, v32, v32
    v_fmac_f32 v27, v33, v33
    v_fmac_f32 v24, v34, v34
    v_fmac_f32 v27, v35, v35
    v_dot2_f32_bf16 v28, v132, v25, v22
    v_dot2_f32_bf16 v29, v132, v26, v22
    v_dot2_f32_bf16 v30, v133, v25, v22
    v_dot2_f32_bf16 v31, v133, v26, v22
    v_dot2_f32_bf16 v32, v134, v25, v22
    v_dot2_f32_bf16 v33, v134, v26, v22
    v_dot2_f32_bf16 v34, v135, v25, v22
    v_dot2_f32_bf16 v35, v135, v26, v22
    v_cvt_pk_bf16_f32 v132, v28, v29
    v_cvt_pk_bf16_f32 v133, v30, v31
    v_cvt_pk_bf16_f32 v134, v32, v33
    v_cvt_pk_bf16_f32 v135, v34, v35
    v_fmac_f32 v24, v28, v28
    v_fmac_f32 v27, v29, v29
    v_fmac_f32 v24, v30, v30
    v_fmac_f32 v27, v31, v31
    v_fmac_f32 v24, v32, v32
    v_fmac_f32 v27, v33, v33
    v_fmac_f32 v24, v34, v34
    v_fmac_f32 v27, v35, v35
    v_dot2_f32_bf16 v28, v136, v25, v22
    v_dot2_f32_bf16 v29, v136, v26, v22
    v_dot2_f32_bf16 v30, v137, v25, v22
    v_dot2_f32_bf16 v31, v137, v26, v22
    v_dot2_f32_bf16 v32, v138, v25, v22
    v_dot2_f32_bf16 v33, v138, v26, v22
    v_dot2_f32_bf16 v34, v139, v25, v22
    v_dot2_f32_bf16 v35, v139, v26, v22
    v_cvt_pk_bf16_f32 v136, v28, v29
    v_cvt_pk_bf16_f32 v137, v30, v31
    v_cvt_pk_bf16_f32 v138, v32, v33
    v_cvt_pk_bf16_f32 v139, v34, v35
    v_fmac_f32 v24, v28, v28
    v_fmac_f32 v27, v29, v29
    v_fmac_f32 v24, v30, v30
    v_fmac_f32 v27, v31, v31
    v_fmac_f32 v24, v32, v32
    v_fmac_f32 v27, v33, v33
    v_fmac_f32 v24, v34, v34
    v_fmac_f32 v27, v35, v35
    v_dot2_f32_bf16 v28, v140, v25, v22
    v_dot2_f32_bf16 v29, v140, v26, v22
    v_dot2_f32_bf16 v30, v141, v25, v22
    v_dot2_f32_bf16 v31, v141, v26, v22
    v_dot2_f32_bf16 v32, v142, v25, v22
    v_dot2_f32_bf16 v33, v142, v26, v22
    v_dot2_f32_bf16 v34, v143, v25, v22
    v_dot2_f32_bf16 v35, v143, v26, v22
    v_cvt_pk_bf16_f32 v140, v28, v29
    v_cvt_pk_bf16_f32 v141, v30, v31
    v_cvt_pk_bf16_f32 v142, v32, v33
    v_cvt_pk_bf16_f32 v143, v34, v35
    v_fmac_f32 v24, v28, v28
    v_fmac_f32 v27, v29, v29
    v_fmac_f32 v24, v30, v30
    v_fmac_f32 v27, v31, v31
    v_fmac_f32 v24, v32, v32
    v_fmac_f32 v27, v33, v33
    v_fmac_f32 v24, v34, v34
    v_fmac_f32 v27, v35, v35
    s_mul_i32 s56, s34, 3072
    s_lshl_b32 s57, s14, 9
    s_add_u32 s56, s56, s57
    s_add_u32 s56, s56, 786432
    s_add_u32 s57, s33, 32768
    s_mov_b32 m0, s57
    s_nop 0
    buffer_load_dwordx4 v9, s[36:39], s56 offen lds

    v_dot2_f32_bf16 v28, v144, v25, v22
    v_dot2_f32_bf16 v29, v144, v26, v22
    v_dot2_f32_bf16 v30, v145, v25, v22
    v_dot2_f32_bf16 v31, v145, v26, v22
    v_dot2_f32_bf16 v32, v146, v25, v22
    v_dot2_f32_bf16 v33, v146, v26, v22
    v_dot2_f32_bf16 v34, v147, v25, v22
    v_dot2_f32_bf16 v35, v147, v26, v22
    v_cvt_pk_bf16_f32 v144, v28, v29
    v_cvt_pk_bf16_f32 v145, v30, v31
    v_cvt_pk_bf16_f32 v146, v32, v33
    v_cvt_pk_bf16_f32 v147, v34, v35
    v_fmac_f32 v24, v28, v28
    v_fmac_f32 v27, v29, v29
    v_fmac_f32 v24, v30, v30
    v_fmac_f32 v27, v31, v31
    v_fmac_f32 v24, v32, v32
    v_fmac_f32 v27, v33, v33
    v_fmac_f32 v24, v34, v34
    v_fmac_f32 v27, v35, v35
    v_dot2_f32_bf16 v28, v148, v25, v22
    v_dot2_f32_bf16 v29, v148, v26, v22
    v_dot2_f32_bf16 v30, v149, v25, v22
    v_dot2_f32_bf16 v31, v149, v26, v22
    v_dot2_f32_bf16 v32, v150, v25, v22
    v_dot2_f32_bf16 v33, v150, v26, v22
    v_dot2_f32_bf16 v34, v151, v25, v22
    v_dot2_f32_bf16 v35, v151, v26, v22
    v_cvt_pk_bf16_f32 v148, v28, v29
    v_cvt_pk_bf16_f32 v149, v30, v31
    v_cvt_pk_bf16_f32 v150, v32, v33
    v_cvt_pk_bf16_f32 v151, v34, v35
    v_fmac_f32 v24, v28, v28
    v_fmac_f32 v27, v29, v29
    v_fmac_f32 v24, v30, v30
    v_fmac_f32 v27, v31, v31
    v_fmac_f32 v24, v32, v32
    v_fmac_f32 v27, v33, v33
    v_fmac_f32 v24, v34, v34
    v_fmac_f32 v27, v35, v35
    v_dot2_f32_bf16 v28, v152, v25, v22
    v_dot2_f32_bf16 v29, v152, v26, v22
    v_dot2_f32_bf16 v30, v153, v25, v22
    v_dot2_f32_bf16 v31, v153, v26, v22
    v_dot2_f32_bf16 v32, v154, v25, v22
    v_dot2_f32_bf16 v33, v154, v26, v22
    v_dot2_f32_bf16 v34, v155, v25, v22
    v_dot2_f32_bf16 v35, v155, v26, v22
    v_cvt_pk_bf16_f32 v152, v28, v29
    v_cvt_pk_bf16_f32 v153, v30, v31
    v_cvt_pk_bf16_f32 v154, v32, v33
    v_cvt_pk_bf16_f32 v155, v34, v35
    v_fmac_f32 v24, v28, v28
    v_fmac_f32 v27, v29, v29
    v_fmac_f32 v24, v30, v30
    v_fmac_f32 v27, v31, v31
    v_fmac_f32 v24, v32, v32
    v_fmac_f32 v27, v33, v33
    v_fmac_f32 v24, v34, v34
    v_fmac_f32 v27, v35, v35
    v_dot2_f32_bf16 v28, v156, v25, v22
    v_dot2_f32_bf16 v29, v156, v26, v22
    v_dot2_f32_bf16 v30, v157, v25, v22
    v_dot2_f32_bf16 v31, v157, v26, v22
    v_dot2_f32_bf16 v32, v158, v25, v22
    v_dot2_f32_bf16 v33, v158, v26, v22
    v_dot2_f32_bf16 v34, v159, v25, v22
    v_dot2_f32_bf16 v35, v159, v26, v22
    v_cvt_pk_bf16_f32 v156, v28, v29
    v_cvt_pk_bf16_f32 v157, v30, v31
    v_cvt_pk_bf16_f32 v158, v32, v33
    v_cvt_pk_bf16_f32 v159, v34, v35
    v_fmac_f32 v24, v28, v28
    v_fmac_f32 v27, v29, v29
    v_fmac_f32 v24, v30, v30
    v_fmac_f32 v27, v31, v31
    v_fmac_f32 v24, v32, v32
    v_fmac_f32 v27, v33, v33
    v_fmac_f32 v24, v34, v34
    v_fmac_f32 v27, v35, v35
    s_mul_i32 s56, s34, 3072
    s_lshl_b32 s57, s14, 9
    s_add_u32 s56, s56, s57
    s_add_u32 s56, s56, 798720
    s_add_u32 s57, s33, 33792
    s_mov_b32 m0, s57
    s_nop 0
    buffer_load_dwordx4 v9, s[36:39], s56 offen lds

    v_dot2_f32_bf16 v28, v160, v25, v22
    v_dot2_f32_bf16 v29, v160, v26, v22
    v_dot2_f32_bf16 v30, v161, v25, v22
    v_dot2_f32_bf16 v31, v161, v26, v22
    v_dot2_f32_bf16 v32, v162, v25, v22
    v_dot2_f32_bf16 v33, v162, v26, v22
    v_dot2_f32_bf16 v34, v163, v25, v22
    v_dot2_f32_bf16 v35, v163, v26, v22
    v_cvt_pk_bf16_f32 v160, v28, v29
    v_cvt_pk_bf16_f32 v161, v30, v31
    v_cvt_pk_bf16_f32 v162, v32, v33
    v_cvt_pk_bf16_f32 v163, v34, v35
    v_fmac_f32 v24, v28, v28
    v_fmac_f32 v27, v29, v29
    v_fmac_f32 v24, v30, v30
    v_fmac_f32 v27, v31, v31
    v_fmac_f32 v24, v32, v32
    v_fmac_f32 v27, v33, v33
    v_fmac_f32 v24, v34, v34
    v_fmac_f32 v27, v35, v35
    v_dot2_f32_bf16 v28, v164, v25, v22
    v_dot2_f32_bf16 v29, v164, v26, v22
    v_dot2_f32_bf16 v30, v165, v25, v22
    v_dot2_f32_bf16 v31, v165, v26, v22
    v_dot2_f32_bf16 v32, v166, v25, v22
    v_dot2_f32_bf16 v33, v166, v26, v22
    v_dot2_f32_bf16 v34, v167, v25, v22
    v_dot2_f32_bf16 v35, v167, v26, v22
    v_cvt_pk_bf16_f32 v164, v28, v29
    v_cvt_pk_bf16_f32 v165, v30, v31
    v_cvt_pk_bf16_f32 v166, v32, v33
    v_cvt_pk_bf16_f32 v167, v34, v35
    v_fmac_f32 v24, v28, v28
    v_fmac_f32 v27, v29, v29
    v_fmac_f32 v24, v30, v30
    v_fmac_f32 v27, v31, v31
    v_fmac_f32 v24, v32, v32
    v_fmac_f32 v27, v33, v33
    v_fmac_f32 v24, v34, v34
    v_fmac_f32 v27, v35, v35
    v_dot2_f32_bf16 v28, v168, v25, v22
    v_dot2_f32_bf16 v29, v168, v26, v22
    v_dot2_f32_bf16 v30, v169, v25, v22
    v_dot2_f32_bf16 v31, v169, v26, v22
    v_dot2_f32_bf16 v32, v170, v25, v22
    v_dot2_f32_bf16 v33, v170, v26, v22
    v_dot2_f32_bf16 v34, v171, v25, v22
    v_dot2_f32_bf16 v35, v171, v26, v22
    v_cvt_pk_bf16_f32 v168, v28, v29
    v_cvt_pk_bf16_f32 v169, v30, v31
    v_cvt_pk_bf16_f32 v170, v32, v33
    v_cvt_pk_bf16_f32 v171, v34, v35
    v_fmac_f32 v24, v28, v28
    v_fmac_f32 v27, v29, v29
    v_fmac_f32 v24, v30, v30
    v_fmac_f32 v27, v31, v31
    v_fmac_f32 v24, v32, v32
    v_fmac_f32 v27, v33, v33
    v_fmac_f32 v24, v34, v34
    v_fmac_f32 v27, v35, v35
    v_dot2_f32_bf16 v28, v172, v25, v22
    v_dot2_f32_bf16 v29, v172, v26, v22
    v_dot2_f32_bf16 v30, v173, v25, v22
    v_dot2_f32_bf16 v31, v173, v26, v22
    v_dot2_f32_bf16 v32, v174, v25, v22
    v_dot2_f32_bf16 v33, v174, v26, v22
    v_dot2_f32_bf16 v34, v175, v25, v22
    v_dot2_f32_bf16 v35, v175, v26, v22
    v_cvt_pk_bf16_f32 v172, v28, v29
    v_cvt_pk_bf16_f32 v173, v30, v31
    v_cvt_pk_bf16_f32 v174, v32, v33
    v_cvt_pk_bf16_f32 v175, v34, v35
    v_fmac_f32 v24, v28, v28
    v_fmac_f32 v27, v29, v29
    v_fmac_f32 v24, v30, v30
    v_fmac_f32 v27, v31, v31
    v_fmac_f32 v24, v32, v32
    v_fmac_f32 v27, v33, v33
    v_fmac_f32 v24, v34, v34
    v_fmac_f32 v27, v35, v35
    s_mul_i32 s56, s34, 3072
    s_lshl_b32 s57, s14, 9
    s_add_u32 s56, s56, s57
    s_add_u32 s56, s56, 811008
    s_add_u32 s57, s33, 34816
    s_mov_b32 m0, s57
    s_nop 0
    buffer_load_dwordx4 v9, s[36:39], s56 offen lds

    v_dot2_f32_bf16 v28, v176, v25, v22
    v_dot2_f32_bf16 v29, v176, v26, v22
    v_dot2_f32_bf16 v30, v177, v25, v22
    v_dot2_f32_bf16 v31, v177, v26, v22
    v_dot2_f32_bf16 v32, v178, v25, v22
    v_dot2_f32_bf16 v33, v178, v26, v22
    v_dot2_f32_bf16 v34, v179, v25, v22
    v_dot2_f32_bf16 v35, v179, v26, v22
    v_cvt_pk_bf16_f32 v176, v28, v29
    v_cvt_pk_bf16_f32 v177, v30, v31
    v_cvt_pk_bf16_f32 v178, v32, v33
    v_cvt_pk_bf16_f32 v179, v34, v35
    v_fmac_f32 v24, v28, v28
    v_fmac_f32 v27, v29, v29
    v_fmac_f32 v24, v30, v30
    v_fmac_f32 v27, v31, v31
    v_fmac_f32 v24, v32, v32
    v_fmac_f32 v27, v33, v33
    v_fmac_f32 v24, v34, v34
    v_fmac_f32 v27, v35, v35
    v_dot2_f32_bf16 v28, v180, v25, v22
    v_dot2_f32_bf16 v29, v180, v26, v22
    v_dot2_f32_bf16 v30, v181, v25, v22
    v_dot2_f32_bf16 v31, v181, v26, v22
    v_dot2_f32_bf16 v32, v182, v25, v22
    v_dot2_f32_bf16 v33, v182, v26, v22
    v_dot2_f32_bf16 v34, v183, v25, v22
    v_dot2_f32_bf16 v35, v183, v26, v22
    v_cvt_pk_bf16_f32 v180, v28, v29
    v_cvt_pk_bf16_f32 v181, v30, v31
    v_cvt_pk_bf16_f32 v182, v32, v33
    v_cvt_pk_bf16_f32 v183, v34, v35
    v_fmac_f32 v24, v28, v28
    v_fmac_f32 v27, v29, v29
    v_fmac_f32 v24, v30, v30
    v_fmac_f32 v27, v31, v31
    v_fmac_f32 v24, v32, v32
    v_fmac_f32 v27, v33, v33
    v_fmac_f32 v24, v34, v34
    v_fmac_f32 v27, v35, v35
    v_dot2_f32_bf16 v28, v184, v25, v22
    v_dot2_f32_bf16 v29, v184, v26, v22
    v_dot2_f32_bf16 v30, v185, v25, v22
    v_dot2_f32_bf16 v31, v185, v26, v22
    v_dot2_f32_bf16 v32, v186, v25, v22
    v_dot2_f32_bf16 v33, v186, v26, v22
    v_dot2_f32_bf16 v34, v187, v25, v22
    v_dot2_f32_bf16 v35, v187, v26, v22
    v_cvt_pk_bf16_f32 v184, v28, v29
    v_cvt_pk_bf16_f32 v185, v30, v31
    v_cvt_pk_bf16_f32 v186, v32, v33
    v_cvt_pk_bf16_f32 v187, v34, v35
    v_fmac_f32 v24, v28, v28
    v_fmac_f32 v27, v29, v29
    v_fmac_f32 v24, v30, v30
    v_fmac_f32 v27, v31, v31
    v_fmac_f32 v24, v32, v32
    v_fmac_f32 v27, v33, v33
    v_fmac_f32 v24, v34, v34
    v_fmac_f32 v27, v35, v35
    v_dot2_f32_bf16 v28, v188, v25, v22
    v_dot2_f32_bf16 v29, v188, v26, v22
    v_dot2_f32_bf16 v30, v189, v25, v22
    v_dot2_f32_bf16 v31, v189, v26, v22
    v_dot2_f32_bf16 v32, v190, v25, v22
    v_dot2_f32_bf16 v33, v190, v26, v22
    v_dot2_f32_bf16 v34, v191, v25, v22
    v_dot2_f32_bf16 v35, v191, v26, v22
    v_cvt_pk_bf16_f32 v188, v28, v29
    v_cvt_pk_bf16_f32 v189, v30, v31
    v_cvt_pk_bf16_f32 v190, v32, v33
    v_cvt_pk_bf16_f32 v191, v34, v35
    v_fmac_f32 v24, v28, v28
    v_fmac_f32 v27, v29, v29
    v_fmac_f32 v24, v30, v30
    v_fmac_f32 v27, v31, v31
    v_fmac_f32 v24, v32, v32
    v_fmac_f32 v27, v33, v33
    v_fmac_f32 v24, v34, v34
    v_fmac_f32 v27, v35, v35
    s_mul_i32 s56, s34, 3072
    s_lshl_b32 s57, s14, 9
    s_add_u32 s56, s56, s57
    s_add_u32 s56, s56, 823296
    s_add_u32 s57, s33, 35840
    s_mov_b32 m0, s57
    s_nop 0
    buffer_load_dwordx4 v9, s[36:39], s56 offen lds

    v_dot2_f32_bf16 v28, v192, v25, v22
    v_dot2_f32_bf16 v29, v192, v26, v22
    v_dot2_f32_bf16 v30, v193, v25, v22
    v_dot2_f32_bf16 v31, v193, v26, v22
    v_dot2_f32_bf16 v32, v194, v25, v22
    v_dot2_f32_bf16 v33, v194, v26, v22
    v_dot2_f32_bf16 v34, v195, v25, v22
    v_dot2_f32_bf16 v35, v195, v26, v22
    v_cvt_pk_bf16_f32 v192, v28, v29
    v_cvt_pk_bf16_f32 v193, v30, v31
    v_cvt_pk_bf16_f32 v194, v32, v33
    v_cvt_pk_bf16_f32 v195, v34, v35
    v_fmac_f32 v24, v28, v28
    v_fmac_f32 v27, v29, v29
    v_fmac_f32 v24, v30, v30
    v_fmac_f32 v27, v31, v31
    v_fmac_f32 v24, v32, v32
    v_fmac_f32 v27, v33, v33
    v_fmac_f32 v24, v34, v34
    v_fmac_f32 v27, v35, v35
    v_dot2_f32_bf16 v28, v196, v25, v22
    v_dot2_f32_bf16 v29, v196, v26, v22
    v_dot2_f32_bf16 v30, v197, v25, v22
    v_dot2_f32_bf16 v31, v197, v26, v22
    v_dot2_f32_bf16 v32, v198, v25, v22
    v_dot2_f32_bf16 v33, v198, v26, v22
    v_dot2_f32_bf16 v34, v199, v25, v22
    v_dot2_f32_bf16 v35, v199, v26, v22
    v_cvt_pk_bf16_f32 v196, v28, v29
    v_cvt_pk_bf16_f32 v197, v30, v31
    v_cvt_pk_bf16_f32 v198, v32, v33
    v_cvt_pk_bf16_f32 v199, v34, v35
    v_fmac_f32 v24, v28, v28
    v_fmac_f32 v27, v29, v29
    v_fmac_f32 v24, v30, v30
    v_fmac_f32 v27, v31, v31
    v_fmac_f32 v24, v32, v32
    v_fmac_f32 v27, v33, v33
    v_fmac_f32 v24, v34, v34
    v_fmac_f32 v27, v35, v35
    v_dot2_f32_bf16 v28, v200, v25, v22
    v_dot2_f32_bf16 v29, v200, v26, v22
    v_dot2_f32_bf16 v30, v201, v25, v22
    v_dot2_f32_bf16 v31, v201, v26, v22
    v_dot2_f32_bf16 v32, v202, v25, v22
    v_dot2_f32_bf16 v33, v202, v26, v22
    v_dot2_f32_bf16 v34, v203, v25, v22
    v_dot2_f32_bf16 v35, v203, v26, v22
    v_cvt_pk_bf16_f32 v200, v28, v29
    v_cvt_pk_bf16_f32 v201, v30, v31
    v_cvt_pk_bf16_f32 v202, v32, v33
    v_cvt_pk_bf16_f32 v203, v34, v35
    v_fmac_f32 v24, v28, v28
    v_fmac_f32 v27, v29, v29
    v_fmac_f32 v24, v30, v30
    v_fmac_f32 v27, v31, v31
    v_fmac_f32 v24, v32, v32
    v_fmac_f32 v27, v33, v33
    v_fmac_f32 v24, v34, v34
    v_fmac_f32 v27, v35, v35
    v_dot2_f32_bf16 v28, v204, v25, v22
    v_dot2_f32_bf16 v29, v204, v26, v22
    v_dot2_f32_bf16 v30, v205, v25, v22
    v_dot2_f32_bf16 v31, v205, v26, v22
    v_dot2_f32_bf16 v32, v206, v25, v22
    v_dot2_f32_bf16 v33, v206, v26, v22
    v_dot2_f32_bf16 v34, v207, v25, v22
    v_dot2_f32_bf16 v35, v207, v26, v22
    v_cvt_pk_bf16_f32 v204, v28, v29
    v_cvt_pk_bf16_f32 v205, v30, v31
    v_cvt_pk_bf16_f32 v206, v32, v33
    v_cvt_pk_bf16_f32 v207, v34, v35
    v_fmac_f32 v24, v28, v28
    v_fmac_f32 v27, v29, v29
    v_fmac_f32 v24, v30, v30
    v_fmac_f32 v27, v31, v31
    v_fmac_f32 v24, v32, v32
    v_fmac_f32 v27, v33, v33
    v_fmac_f32 v24, v34, v34
    v_fmac_f32 v27, v35, v35
    s_mul_i32 s56, s34, 3072
    s_lshl_b32 s57, s14, 9
    s_add_u32 s56, s56, s57
    s_add_u32 s56, s56, 1179648
    s_add_u32 s57, s33, 65536
    s_mov_b32 m0, s57
    s_nop 0
    buffer_load_dwordx4 v9, s[36:39], s56 offen lds

    v_dot2_f32_bf16 v28, v208, v25, v22
    v_dot2_f32_bf16 v29, v208, v26, v22
    v_dot2_f32_bf16 v30, v209, v25, v22
    v_dot2_f32_bf16 v31, v209, v26, v22
    v_dot2_f32_bf16 v32, v210, v25, v22
    v_dot2_f32_bf16 v33, v210, v26, v22
    v_dot2_f32_bf16 v34, v211, v25, v22
    v_dot2_f32_bf16 v35, v211, v26, v22
    v_cvt_pk_bf16_f32 v208, v28, v29
    v_cvt_pk_bf16_f32 v209, v30, v31
    v_cvt_pk_bf16_f32 v210, v32, v33
    v_cvt_pk_bf16_f32 v211, v34, v35
    v_fmac_f32 v24, v28, v28
    v_fmac_f32 v27, v29, v29
    v_fmac_f32 v24, v30, v30
    v_fmac_f32 v27, v31, v31
    v_fmac_f32 v24, v32, v32
    v_fmac_f32 v27, v33, v33
    v_fmac_f32 v24, v34, v34
    v_fmac_f32 v27, v35, v35
    v_dot2_f32_bf16 v28, v212, v25, v22
    v_dot2_f32_bf16 v29, v212, v26, v22
    v_dot2_f32_bf16 v30, v213, v25, v22
    v_dot2_f32_bf16 v31, v213, v26, v22
    v_dot2_f32_bf16 v32, v214, v25, v22
    v_dot2_f32_bf16 v33, v214, v26, v22
    v_dot2_f32_bf16 v34, v215, v25, v22
    v_dot2_f32_bf16 v35, v215, v26, v22
    v_cvt_pk_bf16_f32 v212, v28, v29
    v_cvt_pk_bf16_f32 v213, v30, v31
    v_cvt_pk_bf16_f32 v214, v32, v33
    v_cvt_pk_bf16_f32 v215, v34, v35
    v_fmac_f32 v24, v28, v28
    v_fmac_f32 v27, v29, v29
    v_fmac_f32 v24, v30, v30
    v_fmac_f32 v27, v31, v31
    v_fmac_f32 v24, v32, v32
    v_fmac_f32 v27, v33, v33
    v_fmac_f32 v24, v34, v34
    v_fmac_f32 v27, v35, v35
    v_dot2_f32_bf16 v28, v216, v25, v22
    v_dot2_f32_bf16 v29, v216, v26, v22
    v_dot2_f32_bf16 v30, v217, v25, v22
    v_dot2_f32_bf16 v31, v217, v26, v22
    v_dot2_f32_bf16 v32, v218, v25, v22
    v_dot2_f32_bf16 v33, v218, v26, v22
    v_dot2_f32_bf16 v34, v219, v25, v22
    v_dot2_f32_bf16 v35, v219, v26, v22
    v_cvt_pk_bf16_f32 v216, v28, v29
    v_cvt_pk_bf16_f32 v217, v30, v31
    v_cvt_pk_bf16_f32 v218, v32, v33
    v_cvt_pk_bf16_f32 v219, v34, v35
    v_fmac_f32 v24, v28, v28
    v_fmac_f32 v27, v29, v29
    v_fmac_f32 v24, v30, v30
    v_fmac_f32 v27, v31, v31
    v_fmac_f32 v24, v32, v32
    v_fmac_f32 v27, v33, v33
    v_fmac_f32 v24, v34, v34
    v_fmac_f32 v27, v35, v35
    v_dot2_f32_bf16 v28, v220, v25, v22
    v_dot2_f32_bf16 v29, v220, v26, v22
    v_dot2_f32_bf16 v30, v221, v25, v22
    v_dot2_f32_bf16 v31, v221, v26, v22
    v_dot2_f32_bf16 v32, v222, v25, v22
    v_dot2_f32_bf16 v33, v222, v26, v22
    v_dot2_f32_bf16 v34, v223, v25, v22
    v_dot2_f32_bf16 v35, v223, v26, v22
    v_cvt_pk_bf16_f32 v220, v28, v29
    v_cvt_pk_bf16_f32 v221, v30, v31
    v_cvt_pk_bf16_f32 v222, v32, v33
    v_cvt_pk_bf16_f32 v223, v34, v35
    v_fmac_f32 v24, v28, v28
    v_fmac_f32 v27, v29, v29
    v_fmac_f32 v24, v30, v30
    v_fmac_f32 v27, v31, v31
    v_fmac_f32 v24, v32, v32
    v_fmac_f32 v27, v33, v33
    v_fmac_f32 v24, v34, v34
    v_fmac_f32 v27, v35, v35
    s_mul_i32 s56, s34, 3072
    s_lshl_b32 s57, s14, 9
    s_add_u32 s56, s56, s57
    s_add_u32 s56, s56, 1191936
    s_add_u32 s57, s33, 66560
    s_mov_b32 m0, s57
    s_nop 0
    buffer_load_dwordx4 v9, s[36:39], s56 offen lds

    v_dot2_f32_bf16 v28, v224, v25, v22
    v_dot2_f32_bf16 v29, v224, v26, v22
    v_dot2_f32_bf16 v30, v225, v25, v22
    v_dot2_f32_bf16 v31, v225, v26, v22
    v_dot2_f32_bf16 v32, v226, v25, v22
    v_dot2_f32_bf16 v33, v226, v26, v22
    v_dot2_f32_bf16 v34, v227, v25, v22
    v_dot2_f32_bf16 v35, v227, v26, v22
    v_cvt_pk_bf16_f32 v224, v28, v29
    v_cvt_pk_bf16_f32 v225, v30, v31
    v_cvt_pk_bf16_f32 v226, v32, v33
    v_cvt_pk_bf16_f32 v227, v34, v35
    v_fmac_f32 v24, v28, v28
    v_fmac_f32 v27, v29, v29
    v_fmac_f32 v24, v30, v30
    v_fmac_f32 v27, v31, v31
    v_fmac_f32 v24, v32, v32
    v_fmac_f32 v27, v33, v33
    v_fmac_f32 v24, v34, v34
    v_fmac_f32 v27, v35, v35
    v_dot2_f32_bf16 v28, v228, v25, v22
    v_dot2_f32_bf16 v29, v228, v26, v22
    v_dot2_f32_bf16 v30, v229, v25, v22
    v_dot2_f32_bf16 v31, v229, v26, v22
    v_dot2_f32_bf16 v32, v230, v25, v22
    v_dot2_f32_bf16 v33, v230, v26, v22
    v_dot2_f32_bf16 v34, v231, v25, v22
    v_dot2_f32_bf16 v35, v231, v26, v22
    v_cvt_pk_bf16_f32 v228, v28, v29
    v_cvt_pk_bf16_f32 v229, v30, v31
    v_cvt_pk_bf16_f32 v230, v32, v33
    v_cvt_pk_bf16_f32 v231, v34, v35
    v_fmac_f32 v24, v28, v28
    v_fmac_f32 v27, v29, v29
    v_fmac_f32 v24, v30, v30
    v_fmac_f32 v27, v31, v31
    v_fmac_f32 v24, v32, v32
    v_fmac_f32 v27, v33, v33
    v_fmac_f32 v24, v34, v34
    v_fmac_f32 v27, v35, v35
    v_dot2_f32_bf16 v28, v232, v25, v22
    v_dot2_f32_bf16 v29, v232, v26, v22
    v_dot2_f32_bf16 v30, v233, v25, v22
    v_dot2_f32_bf16 v31, v233, v26, v22
    v_dot2_f32_bf16 v32, v234, v25, v22
    v_dot2_f32_bf16 v33, v234, v26, v22
    v_dot2_f32_bf16 v34, v235, v25, v22
    v_dot2_f32_bf16 v35, v235, v26, v22
    v_cvt_pk_bf16_f32 v232, v28, v29
    v_cvt_pk_bf16_f32 v233, v30, v31
    v_cvt_pk_bf16_f32 v234, v32, v33
    v_cvt_pk_bf16_f32 v235, v34, v35
    v_fmac_f32 v24, v28, v28
    v_fmac_f32 v27, v29, v29
    v_fmac_f32 v24, v30, v30
    v_fmac_f32 v27, v31, v31
    v_fmac_f32 v24, v32, v32
    v_fmac_f32 v27, v33, v33
    v_fmac_f32 v24, v34, v34
    v_fmac_f32 v27, v35, v35
    v_dot2_f32_bf16 v28, v236, v25, v22
    v_dot2_f32_bf16 v29, v236, v26, v22
    v_dot2_f32_bf16 v30, v237, v25, v22
    v_dot2_f32_bf16 v31, v237, v26, v22
    v_dot2_f32_bf16 v32, v238, v25, v22
    v_dot2_f32_bf16 v33, v238, v26, v22
    v_dot2_f32_bf16 v34, v239, v25, v22
    v_dot2_f32_bf16 v35, v239, v26, v22
    v_cvt_pk_bf16_f32 v236, v28, v29
    v_cvt_pk_bf16_f32 v237, v30, v31
    v_cvt_pk_bf16_f32 v238, v32, v33
    v_cvt_pk_bf16_f32 v239, v34, v35
    v_fmac_f32 v24, v28, v28
    v_fmac_f32 v27, v29, v29
    v_fmac_f32 v24, v30, v30
    v_fmac_f32 v27, v31, v31
    v_fmac_f32 v24, v32, v32
    v_fmac_f32 v27, v33, v33
    v_fmac_f32 v24, v34, v34
    v_fmac_f32 v27, v35, v35
    s_mul_i32 s56, s34, 3072
    s_lshl_b32 s57, s14, 9
    s_add_u32 s56, s56, s57
    s_add_u32 s56, s56, 1204224
    s_add_u32 s57, s33, 67584
    s_mov_b32 m0, s57
    s_nop 0
    buffer_load_dwordx4 v9, s[36:39], s56 offen lds

    v_dot2_f32_bf16 v28, v240, v25, v22
    v_dot2_f32_bf16 v29, v240, v26, v22
    v_dot2_f32_bf16 v30, v241, v25, v22
    v_dot2_f32_bf16 v31, v241, v26, v22
    v_dot2_f32_bf16 v32, v242, v25, v22
    v_dot2_f32_bf16 v33, v242, v26, v22
    v_dot2_f32_bf16 v34, v243, v25, v22
    v_dot2_f32_bf16 v35, v243, v26, v22
    v_cvt_pk_bf16_f32 v240, v28, v29
    v_cvt_pk_bf16_f32 v241, v30, v31
    v_cvt_pk_bf16_f32 v242, v32, v33
    v_cvt_pk_bf16_f32 v243, v34, v35
    v_fmac_f32 v24, v28, v28
    v_fmac_f32 v27, v29, v29
    v_fmac_f32 v24, v30, v30
    v_fmac_f32 v27, v31, v31
    v_fmac_f32 v24, v32, v32
    v_fmac_f32 v27, v33, v33
    v_fmac_f32 v24, v34, v34
    v_fmac_f32 v27, v35, v35
    v_dot2_f32_bf16 v28, v244, v25, v22
    v_dot2_f32_bf16 v29, v244, v26, v22
    v_dot2_f32_bf16 v30, v245, v25, v22
    v_dot2_f32_bf16 v31, v245, v26, v22
    v_dot2_f32_bf16 v32, v246, v25, v22
    v_dot2_f32_bf16 v33, v246, v26, v22
    v_dot2_f32_bf16 v34, v247, v25, v22
    v_dot2_f32_bf16 v35, v247, v26, v22
    v_cvt_pk_bf16_f32 v244, v28, v29
    v_cvt_pk_bf16_f32 v245, v30, v31
    v_cvt_pk_bf16_f32 v246, v32, v33
    v_cvt_pk_bf16_f32 v247, v34, v35
    v_fmac_f32 v24, v28, v28
    v_fmac_f32 v27, v29, v29
    v_fmac_f32 v24, v30, v30
    v_fmac_f32 v27, v31, v31
    v_fmac_f32 v24, v32, v32
    v_fmac_f32 v27, v33, v33
    v_fmac_f32 v24, v34, v34
    v_fmac_f32 v27, v35, v35
    v_dot2_f32_bf16 v28, v248, v25, v22
    v_dot2_f32_bf16 v29, v248, v26, v22
    v_dot2_f32_bf16 v30, v249, v25, v22
    v_dot2_f32_bf16 v31, v249, v26, v22
    v_dot2_f32_bf16 v32, v250, v25, v22
    v_dot2_f32_bf16 v33, v250, v26, v22
    v_dot2_f32_bf16 v34, v251, v25, v22
    v_dot2_f32_bf16 v35, v251, v26, v22
    v_cvt_pk_bf16_f32 v248, v28, v29
    v_cvt_pk_bf16_f32 v249, v30, v31
    v_cvt_pk_bf16_f32 v250, v32, v33
    v_cvt_pk_bf16_f32 v251, v34, v35
    v_fmac_f32 v24, v28, v28
    v_fmac_f32 v27, v29, v29
    v_fmac_f32 v24, v30, v30
    v_fmac_f32 v27, v31, v31
    v_fmac_f32 v24, v32, v32
    v_fmac_f32 v27, v33, v33
    v_fmac_f32 v24, v34, v34
    v_fmac_f32 v27, v35, v35
    v_dot2_f32_bf16 v28, v252, v25, v22
    v_dot2_f32_bf16 v29, v252, v26, v22
    v_dot2_f32_bf16 v30, v253, v25, v22
    v_dot2_f32_bf16 v31, v253, v26, v22
    v_dot2_f32_bf16 v32, v254, v25, v22
    v_dot2_f32_bf16 v33, v254, v26, v22
    v_dot2_f32_bf16 v34, v255, v25, v22
    v_dot2_f32_bf16 v35, v255, v26, v22
    v_cvt_pk_bf16_f32 v252, v28, v29
    v_cvt_pk_bf16_f32 v253, v30, v31
    v_cvt_pk_bf16_f32 v254, v32, v33
    v_cvt_pk_bf16_f32 v255, v34, v35
    v_fmac_f32 v24, v28, v28
    v_fmac_f32 v27, v29, v29
    v_fmac_f32 v24, v30, v30
    v_fmac_f32 v27, v31, v31
    v_fmac_f32 v24, v32, v32
    v_fmac_f32 v27, v33, v33
    v_fmac_f32 v24, v34, v34
    v_fmac_f32 v27, v35, v35
    s_mul_i32 s56, s34, 3072
    s_lshl_b32 s57, s14, 9
    s_add_u32 s56, s56, s57
    s_add_u32 s56, s56, 1216512
    s_add_u32 s57, s33, 68608
    s_mov_b32 m0, s57
    s_nop 0
    buffer_load_dwordx4 v9, s[36:39], s56 offen lds

    s_mul_i32 s30, s3, 176128
    s_lshl_b32 s31, s14, 5
    s_add_u32 s30, s30, s31
    s_add_u32 s30, s30, 2560

    s_add_u32 s31, s33, 98304
    s_mov_b32 m0, s31
    v_add_co_u32 v14, vcc, s30, v12
    s_add_u32 s30, s30, 44032
    s_nop 0
    v_addc_co_u32 v15, vcc, 0, v13, vcc
    global_load_lds_dwordx4 v[14:15], off

    s_add_u32 s31, s33, 99328
    s_mov_b32 m0, s31
    v_add_co_u32 v14, vcc, s30, v12
    s_add_u32 s30, s30, 44032
    s_nop 0
    v_addc_co_u32 v15, vcc, 0, v13, vcc
    global_load_lds_dwordx4 v[14:15], off

    s_add_u32 s31, s33, 100352
    s_mov_b32 m0, s31
    v_add_co_u32 v14, vcc, s30, v12
    s_add_u32 s30, s30, 44032
    s_nop 0
    v_addc_co_u32 v15, vcc, 0, v13, vcc
    global_load_lds_dwordx4 v[14:15], off

    s_add_u32 s31, s33, 101376
    s_mov_b32 m0, s31
    v_add_co_u32 v14, vcc, s30, v12
    s_add_u32 s30, s30, 44032
    s_nop 0
    v_addc_co_u32 v15, vcc, 0, v13, vcc
    global_load_lds_dwordx4 v[14:15], off

    s_nop 3
    v_add_f32 v24, v24, v27
    v_mov_b32 v27, v24
    s_nop 1
    v_permlane32_swap_b32 v24, v27
    s_nop 1
    v_add_f32 v24, v24, v27
    v_mul_f32 v24, 0x3b000000, v24
    v_fma_f32 v24, -v23, v23, v24
    v_max_f32 v24, 0, v24
    v_cvt_pk_bf16_f32 v24, v24, v24
    v_and_b32 v24, 0xffff0000, v24
    v_add_f32 v24, 0x3727c5ac, v24
    v_cvt_pk_bf16_f32 v24, v24, v24
    v_and_b32 v24, 0xffff0000, v24
    v_sqrt_f32 v24, v24
    s_nop 0
    v_cvt_pk_bf16_f32 v24, v24, v24
    v_and_b32 v24, 0xffff0000, v24
    v_rcp_f32 v24, v24

    v_lshlrev_b32 v26, 3, v4
    v_and_b32 v27, 15, v2
    v_lshrrev_b32 v27, 2, v27
    v_add_u32 v26, v26, v27
    v_and_b32 v27, 3, v27
    v_lshrrev_b32 v28, 4, v2
    v_and_b32 v28, 1, v28
    v_and_b32 v29, 3, v2
    v_lshlrev_b32 v29, 3, v29
    v_lshl_add_u32 v29, v26, 8, v29
    s_lshl_b32 s43, s41, 1

    s_add_u32 s30, s43, 0
    v_xor_b32 v30, s30, v27
    v_lshl_add_u32 v30, v30, 6, v29
    v_lshl_add_u32 v16, v28, 5, v30

    s_add_u32 s30, s43, 1
    v_xor_b32 v30, s30, v27
    v_lshl_add_u32 v30, v30, 6, v29
    v_lshl_add_u32 v17, v28, 5, v30

    v_lshlrev_b32 v20, 6, v26
    v_lshl_add_u32 v20, v28, 5, v20
    v_and_b32 v30, 3, v2
    v_lshl_add_u32 v20, v30, 3, v20
    v_lshlrev_b32 v22, 5, v5
    v_lshl_add_u32 v22, v4, 4, v22
    v_add_u32 v36, 98304, v20

    v_lshlrev_b32 v21, 5, v5
    v_lshl_add_u32 v21, v4, 4, v21

    v_lshlrev_b32 v6, 13, v4
    v_lshl_add_u32 v6, v3, 1, v6
    v_add_u32 v6, s35, v6
    s_cmp_ge_u32 s52, 1888
    s_cbranch_scc1 K1q_wtd
    s_cmp_ge_u32 s53, 32
    s_cbranch_scc1 K1q_wtb
    s_lshl_b32 s54, s53, 14
    s_add_u32 s27, s54, 4096

    buffer_load_ushort v26, v6, s[44:47], s54 offen offset:0
    buffer_load_ushort v27, v6, s[44:47], s54 offen offset:1024
    buffer_load_ushort v28, v6, s[44:47], s54 offen offset:2048
    buffer_load_ushort v29, v6, s[44:47], s54 offen offset:3072
    buffer_load_ushort v30, v6, s[44:47], s27 offen offset:0
    buffer_load_ushort v31, v6, s[44:47], s27 offen offset:1024
    buffer_load_ushort v32, v6, s[44:47], s27 offen offset:2048
    buffer_load_ushort v33, v6, s[44:47], s27 offen offset:3072
    s_branch K1q_wtd
K1q_wtb:
    s_sub_u32 s54, s53, 32
    s_lshl_b32 s54, s54, 14
    s_add_u32 s27, s54, 4096

    buffer_load_ushort v26, v6, s[48:51], s54 offen offset:0
    buffer_load_ushort v27, v6, s[48:51], s54 offen offset:1024
    buffer_load_ushort v28, v6, s[48:51], s54 offen offset:2048
    buffer_load_ushort v29, v6, s[48:51], s54 offen offset:3072
    buffer_load_ushort v30, v6, s[48:51], s27 offen offset:0
    buffer_load_ushort v31, v6, s[48:51], s27 offen offset:1024
    buffer_load_ushort v32, v6, s[48:51], s27 offen offset:2048
    buffer_load_ushort v33, v6, s[48:51], s27 offen offset:3072
K1q_wtd:
    s_waitcnt vmcnt(16)
    s_waitcnt lgkmcnt(0)
    s_barrier
    v_add_u32 v34, 131072, v16
    v_add_u32 v35, 131072, v17
    ds_read_b64_tr_b16 v[40:41], v34 offset:0
    ds_read_b64_tr_b16 v[42:43], v34 offset:1024
    ds_read_b64_tr_b16 v[44:45], v35 offset:0
    ds_read_b64_tr_b16 v[46:47], v35 offset:1024
    ds_read_b64_tr_b16 v[48:49], v34 offset:4096
    ds_read_b64_tr_b16 v[50:51], v34 offset:5120
    ds_read_b64_tr_b16 v[52:53], v35 offset:4096
    ds_read_b64_tr_b16 v[54:55], v35 offset:5120
    ds_read_b64_tr_b16 v[56:57], v34 offset:8192
    ds_read_b64_tr_b16 v[58:59], v34 offset:9216
    ds_read_b64_tr_b16 v[60:61], v35 offset:8192
    ds_read_b64_tr_b16 v[62:63], v35 offset:9216
    s_waitcnt lgkmcnt(10)
    v_mfma_f32_32x32x16_bf16 v[64:79], v[40:43], v[128:131], 0
    ds_read_b64_tr_b16 v[40:41], v34 offset:12288
    ds_read_b64_tr_b16 v[42:43], v34 offset:13312
    s_waitcnt lgkmcnt(10)
    v_mfma_f32_32x32x16_bf16 v[80:95], v[44:47], v[128:131], 0
    ds_read_b64_tr_b16 v[44:45], v35 offset:12288
    ds_read_b64_tr_b16 v[46:47], v35 offset:13312
    s_waitcnt lgkmcnt(10)
    v_mfma_f32_32x32x16_bf16 v[64:79], v[48:51], v[132:135], v[64:79]
    ds_read_b64_tr_b16 v[48:49], v34 offset:16384
    ds_read_b64_tr_b16 v[50:51], v34 offset:17408
    s_waitcnt lgkmcnt(10)
    v_mfma_f32_32x32x16_bf16 v[80:95], v[52:55], v[132:135], v[80:95]
    ds_read_b64_tr_b16 v[52:53], v35 offset:16384
    ds_read_b64_tr_b16 v[54:55], v35 offset:17408
    s_waitcnt lgkmcnt(10)
    v_mfma_f32_32x32x16_bf16 v[64:79], v[56:59], v[136:139], v[64:79]
    ds_read_b64_tr_b16 v[56:57], v34 offset:20480
    ds_read_b64_tr_b16 v[58:59], v34 offset:21504
    s_waitcnt lgkmcnt(10)
    v_mfma_f32_32x32x16_bf16 v[80:95], v[60:63], v[136:139], v[80:95]
    ds_read_b64_tr_b16 v[60:61], v35 offset:20480
    ds_read_b64_tr_b16 v[62:63], v35 offset:21504
    s_waitcnt lgkmcnt(10)
    v_mfma_f32_32x32x16_bf16 v[64:79], v[40:43], v[140:143], v[64:79]
    ds_read_b64_tr_b16 v[40:41], v34 offset:24576
    ds_read_b64_tr_b16 v[42:43], v34 offset:25600
    s_waitcnt lgkmcnt(10)
    v_mfma_f32_32x32x16_bf16 v[80:95], v[44:47], v[140:143], v[80:95]
    ds_read_b64_tr_b16 v[44:45], v35 offset:24576
    ds_read_b64_tr_b16 v[46:47], v35 offset:25600
    s_waitcnt lgkmcnt(10)
    v_mfma_f32_32x32x16_bf16 v[64:79], v[48:51], v[144:147], v[64:79]
    ds_read_b64_tr_b16 v[48:49], v34 offset:28672
    ds_read_b64_tr_b16 v[50:51], v34 offset:29696
    s_waitcnt lgkmcnt(10)
    v_mfma_f32_32x32x16_bf16 v[80:95], v[52:55], v[144:147], v[80:95]
    ds_read_b64_tr_b16 v[52:53], v35 offset:28672
    ds_read_b64_tr_b16 v[54:55], v35 offset:29696
    s_waitcnt lgkmcnt(10)
    v_mfma_f32_32x32x16_bf16 v[64:79], v[56:59], v[148:151], v[64:79]
    s_waitcnt lgkmcnt(8)
    v_mfma_f32_32x32x16_bf16 v[80:95], v[60:63], v[148:151], v[80:95]
    s_waitcnt lgkmcnt(6)
    v_mfma_f32_32x32x16_bf16 v[64:79], v[40:43], v[152:155], v[64:79]
    s_waitcnt lgkmcnt(4)
    v_mfma_f32_32x32x16_bf16 v[80:95], v[44:47], v[152:155], v[80:95]
    s_waitcnt lgkmcnt(2)
    v_mfma_f32_32x32x16_bf16 v[64:79], v[48:51], v[156:159], v[64:79]
    s_waitcnt lgkmcnt(0)
    v_mfma_f32_32x32x16_bf16 v[80:95], v[52:55], v[156:159], v[80:95]
    s_waitcnt vmcnt(12)
    s_waitcnt lgkmcnt(0)
    s_barrier
    v_add_u32 v34, 0, v16
    v_add_u32 v35, 0, v17
    ds_read_b64_tr_b16 v[40:41], v34 offset:0
    ds_read_b64_tr_b16 v[42:43], v34 offset:1024
    ds_read_b64_tr_b16 v[44:45], v35 offset:0
    ds_read_b64_tr_b16 v[46:47], v35 offset:1024
    ds_read_b64_tr_b16 v[48:49], v34 offset:4096
    ds_read_b64_tr_b16 v[50:51], v34 offset:5120
    ds_read_b64_tr_b16 v[52:53], v35 offset:4096
    ds_read_b64_tr_b16 v[54:55], v35 offset:5120
    ds_read_b64_tr_b16 v[56:57], v34 offset:8192
    ds_read_b64_tr_b16 v[58:59], v34 offset:9216
    ds_read_b64_tr_b16 v[60:61], v35 offset:8192
    ds_read_b64_tr_b16 v[62:63], v35 offset:9216
    s_waitcnt lgkmcnt(10)
    v_mfma_f32_32x32x16_bf16 v[64:79], v[40:43], v[160:163], v[64:79]
    ds_read_b64_tr_b16 v[40:41], v34 offset:12288
    ds_read_b64_tr_b16 v[42:43], v34 offset:13312
    s_waitcnt lgkmcnt(10)
    v_mfma_f32_32x32x16_bf16 v[80:95], v[44:47], v[160:163], v[80:95]
    s_mul_i32 s56, s34, 3072
    s_lshl_b32 s57, s14, 9
    s_add_u32 s56, s56, s57
    s_add_u32 s56, s56, 256
    s_add_u32 s57, s33, 131072
    s_mov_b32 m0, s57
    s_nop 0
    buffer_load_dwordx4 v9, s[36:39], s56 offen lds

    ds_read_b64_tr_b16 v[44:45], v35 offset:12288
    ds_read_b64_tr_b16 v[46:47], v35 offset:13312
    s_waitcnt lgkmcnt(10)
    v_mfma_f32_32x32x16_bf16 v[64:79], v[48:51], v[164:167], v[64:79]
    ds_read_b64_tr_b16 v[48:49], v34 offset:16384
    ds_read_b64_tr_b16 v[50:51], v34 offset:17408
    s_waitcnt lgkmcnt(10)
    v_mfma_f32_32x32x16_bf16 v[80:95], v[52:55], v[164:167], v[80:95]
    ds_read_b64_tr_b16 v[52:53], v35 offset:16384
    ds_read_b64_tr_b16 v[54:55], v35 offset:17408
    s_waitcnt lgkmcnt(10)
    v_mfma_f32_32x32x16_bf16 v[64:79], v[56:59], v[168:171], v[64:79]
    ds_read_b64_tr_b16 v[56:57], v34 offset:20480
    ds_read_b64_tr_b16 v[58:59], v34 offset:21504
    s_waitcnt lgkmcnt(10)
    v_mfma_f32_32x32x16_bf16 v[80:95], v[60:63], v[168:171], v[80:95]
    s_mul_i32 s56, s34, 3072
    s_lshl_b32 s57, s14, 9
    s_add_u32 s56, s56, s57
    s_add_u32 s56, s56, 12544
    s_add_u32 s57, s33, 132096
    s_mov_b32 m0, s57
    s_nop 0
    buffer_load_dwordx4 v9, s[36:39], s56 offen lds

    ds_read_b64_tr_b16 v[60:61], v35 offset:20480
    ds_read_b64_tr_b16 v[62:63], v35 offset:21504
    s_waitcnt lgkmcnt(10)
    v_mfma_f32_32x32x16_bf16 v[64:79], v[40:43], v[172:175], v[64:79]
    ds_read_b64_tr_b16 v[40:41], v34 offset:24576
    ds_read_b64_tr_b16 v[42:43], v34 offset:25600
    s_waitcnt lgkmcnt(10)
    v_mfma_f32_32x32x16_bf16 v[80:95], v[44:47], v[172:175], v[80:95]
    ds_read_b64_tr_b16 v[44:45], v35 offset:24576
    ds_read_b64_tr_b16 v[46:47], v35 offset:25600
    s_waitcnt lgkmcnt(10)
    v_mfma_f32_32x32x16_bf16 v[64:79], v[48:51], v[176:179], v[64:79]
    ds_read_b64_tr_b16 v[48:49], v34 offset:28672
    ds_read_b64_tr_b16 v[50:51], v34 offset:29696
    s_waitcnt lgkmcnt(10)
    v_mfma_f32_32x32x16_bf16 v[80:95], v[52:55], v[176:179], v[80:95]
    s_mul_i32 s56, s34, 3072
    s_lshl_b32 s57, s14, 9
    s_add_u32 s56, s56, s57
    s_add_u32 s56, s56, 24832
    s_add_u32 s57, s33, 133120
    s_mov_b32 m0, s57
    s_nop 0
    buffer_load_dwordx4 v9, s[36:39], s56 offen lds

    ds_read_b64_tr_b16 v[52:53], v35 offset:28672
    ds_read_b64_tr_b16 v[54:55], v35 offset:29696
    s_waitcnt lgkmcnt(10)
    v_mfma_f32_32x32x16_bf16 v[64:79], v[56:59], v[180:183], v[64:79]
    s_waitcnt lgkmcnt(8)
    v_mfma_f32_32x32x16_bf16 v[80:95], v[60:63], v[180:183], v[80:95]
    s_waitcnt lgkmcnt(6)
    v_mfma_f32_32x32x16_bf16 v[64:79], v[40:43], v[184:187], v[64:79]
    s_waitcnt lgkmcnt(4)
    v_mfma_f32_32x32x16_bf16 v[80:95], v[44:47], v[184:187], v[80:95]
    s_mul_i32 s56, s34, 3072
    s_lshl_b32 s57, s14, 9
    s_add_u32 s56, s56, s57
    s_add_u32 s56, s56, 37120
    s_add_u32 s57, s33, 134144
    s_mov_b32 m0, s57
    s_nop 0
    buffer_load_dwordx4 v9, s[36:39], s56 offen lds

    s_waitcnt lgkmcnt(2)
    v_mfma_f32_32x32x16_bf16 v[64:79], v[48:51], v[188:191], v[64:79]
    s_waitcnt lgkmcnt(0)
    v_mfma_f32_32x32x16_bf16 v[80:95], v[52:55], v[188:191], v[80:95]
    s_waitcnt vmcnt(12)
    s_waitcnt lgkmcnt(0)
    s_barrier
    v_add_u32 v34, 32768, v16
    v_add_u32 v35, 32768, v17
    ds_read_b64_tr_b16 v[40:41], v34 offset:0
    ds_read_b64_tr_b16 v[42:43], v34 offset:1024
    ds_read_b64_tr_b16 v[44:45], v35 offset:0
    ds_read_b64_tr_b16 v[46:47], v35 offset:1024
    ds_read_b64_tr_b16 v[48:49], v34 offset:4096
    ds_read_b64_tr_b16 v[50:51], v34 offset:5120
    ds_read_b64_tr_b16 v[52:53], v35 offset:4096
    ds_read_b64_tr_b16 v[54:55], v35 offset:5120
    ds_read_b64_tr_b16 v[56:57], v34 offset:8192
    ds_read_b64_tr_b16 v[58:59], v34 offset:9216
    ds_read_b64_tr_b16 v[60:61], v35 offset:8192
    ds_read_b64_tr_b16 v[62:63], v35 offset:9216
    s_waitcnt lgkmcnt(10)
    v_mfma_f32_32x32x16_bf16 v[64:79], v[40:43], v[192:195], v[64:79]
    ds_read_b64_tr_b16 v[40:41], v34 offset:12288
    ds_read_b64_tr_b16 v[42:43], v34 offset:13312
    s_waitcnt lgkmcnt(10)
    v_mfma_f32_32x32x16_bf16 v[80:95], v[44:47], v[192:195], v[80:95]
    s_mul_i32 s56, s34, 3072
    s_lshl_b32 s57, s14, 9
    s_add_u32 s56, s56, s57
    s_add_u32 s56, s56, 393472
    s_add_u32 s57, s33, 0
    s_mov_b32 m0, s57
    s_nop 0
    buffer_load_dwordx4 v9, s[36:39], s56 offen lds

    ds_read_b64_tr_b16 v[44:45], v35 offset:12288
    ds_read_b64_tr_b16 v[46:47], v35 offset:13312
    s_waitcnt lgkmcnt(10)
    v_mfma_f32_32x32x16_bf16 v[64:79], v[48:51], v[196:199], v[64:79]
    ds_read_b64_tr_b16 v[48:49], v34 offset:16384
    ds_read_b64_tr_b16 v[50:51], v34 offset:17408
    s_waitcnt lgkmcnt(10)
    v_mfma_f32_32x32x16_bf16 v[80:95], v[52:55], v[196:199], v[80:95]
    ds_read_b64_tr_b16 v[52:53], v35 offset:16384
    ds_read_b64_tr_b16 v[54:55], v35 offset:17408
    s_waitcnt lgkmcnt(10)
    v_mfma_f32_32x32x16_bf16 v[64:79], v[56:59], v[200:203], v[64:79]
    ds_read_b64_tr_b16 v[56:57], v34 offset:20480
    ds_read_b64_tr_b16 v[58:59], v34 offset:21504
    s_waitcnt lgkmcnt(10)
    v_mfma_f32_32x32x16_bf16 v[80:95], v[60:63], v[200:203], v[80:95]
    s_mul_i32 s56, s34, 3072
    s_lshl_b32 s57, s14, 9
    s_add_u32 s56, s56, s57
    s_add_u32 s56, s56, 405760
    s_add_u32 s57, s33, 1024
    s_mov_b32 m0, s57
    s_nop 0
    buffer_load_dwordx4 v9, s[36:39], s56 offen lds

    ds_read_b64_tr_b16 v[60:61], v35 offset:20480
    ds_read_b64_tr_b16 v[62:63], v35 offset:21504
    s_waitcnt lgkmcnt(10)
    v_mfma_f32_32x32x16_bf16 v[64:79], v[40:43], v[204:207], v[64:79]
    ds_read_b64_tr_b16 v[40:41], v34 offset:24576
    ds_read_b64_tr_b16 v[42:43], v34 offset:25600
    s_waitcnt lgkmcnt(10)
    v_mfma_f32_32x32x16_bf16 v[80:95], v[44:47], v[204:207], v[80:95]
    ds_read_b64_tr_b16 v[44:45], v35 offset:24576
    ds_read_b64_tr_b16 v[46:47], v35 offset:25600
    s_waitcnt lgkmcnt(10)
    v_mfma_f32_32x32x16_bf16 v[64:79], v[48:51], v[208:211], v[64:79]
    ds_read_b64_tr_b16 v[48:49], v34 offset:28672
    ds_read_b64_tr_b16 v[50:51], v34 offset:29696
    s_waitcnt lgkmcnt(10)
    v_mfma_f32_32x32x16_bf16 v[80:95], v[52:55], v[208:211], v[80:95]
    s_mul_i32 s56, s34, 3072
    s_lshl_b32 s57, s14, 9
    s_add_u32 s56, s56, s57
    s_add_u32 s56, s56, 418048
    s_add_u32 s57, s33, 2048
    s_mov_b32 m0, s57
    s_nop 0
    buffer_load_dwordx4 v9, s[36:39], s56 offen lds

    ds_read_b64_tr_b16 v[52:53], v35 offset:28672
    ds_read_b64_tr_b16 v[54:55], v35 offset:29696
    s_waitcnt lgkmcnt(10)
    v_mfma_f32_32x32x16_bf16 v[64:79], v[56:59], v[212:215], v[64:79]
    s_waitcnt lgkmcnt(8)
    v_mfma_f32_32x32x16_bf16 v[80:95], v[60:63], v[212:215], v[80:95]
    s_waitcnt lgkmcnt(6)
    v_mfma_f32_32x32x16_bf16 v[64:79], v[40:43], v[216:219], v[64:79]
    s_waitcnt lgkmcnt(4)
    v_mfma_f32_32x32x16_bf16 v[80:95], v[44:47], v[216:219], v[80:95]
    s_mul_i32 s56, s34, 3072
    s_lshl_b32 s57, s14, 9
    s_add_u32 s56, s56, s57
    s_add_u32 s56, s56, 430336
    s_add_u32 s57, s33, 3072
    s_mov_b32 m0, s57
    s_nop 0
    buffer_load_dwordx4 v9, s[36:39], s56 offen lds

    s_waitcnt lgkmcnt(2)
    v_mfma_f32_32x32x16_bf16 v[64:79], v[48:51], v[220:223], v[64:79]
    s_waitcnt lgkmcnt(0)
    v_mfma_f32_32x32x16_bf16 v[80:95], v[52:55], v[220:223], v[80:95]
    s_waitcnt vmcnt(12)
    s_waitcnt lgkmcnt(0)
    s_barrier
    v_add_u32 v34, 65536, v16
    v_add_u32 v35, 65536, v17
    ds_read_b64_tr_b16 v[40:41], v34 offset:0
    ds_read_b64_tr_b16 v[42:43], v34 offset:1024
    ds_read_b64_tr_b16 v[44:45], v35 offset:0
    ds_read_b64_tr_b16 v[46:47], v35 offset:1024
    ds_read_b64_tr_b16 v[48:49], v34 offset:4096
    ds_read_b64_tr_b16 v[50:51], v34 offset:5120
    ds_read_b64_tr_b16 v[52:53], v35 offset:4096
    ds_read_b64_tr_b16 v[54:55], v35 offset:5120
    ds_read_b64_tr_b16 v[56:57], v34 offset:8192
    ds_read_b64_tr_b16 v[58:59], v34 offset:9216
    ds_read_b64_tr_b16 v[60:61], v35 offset:8192
    ds_read_b64_tr_b16 v[62:63], v35 offset:9216
    s_waitcnt lgkmcnt(10)
    v_mfma_f32_32x32x16_bf16 v[64:79], v[40:43], v[224:227], v[64:79]
    ds_read_b64_tr_b16 v[40:41], v34 offset:12288
    ds_read_b64_tr_b16 v[42:43], v34 offset:13312
    s_waitcnt lgkmcnt(10)
    v_mfma_f32_32x32x16_bf16 v[80:95], v[44:47], v[224:227], v[80:95]
    s_mul_i32 s56, s34, 3072
    s_lshl_b32 s57, s14, 9
    s_add_u32 s56, s56, s57
    s_add_u32 s56, s56, 786688
    s_add_u32 s57, s33, 32768
    s_mov_b32 m0, s57
    s_nop 0
    buffer_load_dwordx4 v9, s[36:39], s56 offen lds

    ds_read_b64_tr_b16 v[44:45], v35 offset:12288
    ds_read_b64_tr_b16 v[46:47], v35 offset:13312
    s_waitcnt lgkmcnt(10)
    v_mfma_f32_32x32x16_bf16 v[64:79], v[48:51], v[228:231], v[64:79]
    ds_read_b64_tr_b16 v[48:49], v34 offset:16384
    ds_read_b64_tr_b16 v[50:51], v34 offset:17408
    s_waitcnt lgkmcnt(10)
    v_mfma_f32_32x32x16_bf16 v[80:95], v[52:55], v[228:231], v[80:95]
    ds_read_b64_tr_b16 v[52:53], v35 offset:16384
    ds_read_b64_tr_b16 v[54:55], v35 offset:17408
    s_waitcnt lgkmcnt(10)
    v_mfma_f32_32x32x16_bf16 v[64:79], v[56:59], v[232:235], v[64:79]
    ds_read_b64_tr_b16 v[56:57], v34 offset:20480
    ds_read_b64_tr_b16 v[58:59], v34 offset:21504
    s_waitcnt lgkmcnt(10)
    v_mfma_f32_32x32x16_bf16 v[80:95], v[60:63], v[232:235], v[80:95]
    s_mul_i32 s56, s34, 3072
    s_lshl_b32 s57, s14, 9
    s_add_u32 s56, s56, s57
    s_add_u32 s56, s56, 798976
    s_add_u32 s57, s33, 33792
    s_mov_b32 m0, s57
    s_nop 0
    buffer_load_dwordx4 v9, s[36:39], s56 offen lds

    ds_read_b64_tr_b16 v[60:61], v35 offset:20480
    ds_read_b64_tr_b16 v[62:63], v35 offset:21504
    s_waitcnt lgkmcnt(10)
    v_mfma_f32_32x32x16_bf16 v[64:79], v[40:43], v[236:239], v[64:79]
    ds_read_b64_tr_b16 v[40:41], v34 offset:24576
    ds_read_b64_tr_b16 v[42:43], v34 offset:25600
    s_waitcnt lgkmcnt(10)
    v_mfma_f32_32x32x16_bf16 v[80:95], v[44:47], v[236:239], v[80:95]
    ds_read_b64_tr_b16 v[44:45], v35 offset:24576
    ds_read_b64_tr_b16 v[46:47], v35 offset:25600
    s_waitcnt lgkmcnt(10)
    v_mfma_f32_32x32x16_bf16 v[64:79], v[48:51], v[240:243], v[64:79]
    ds_read_b64_tr_b16 v[48:49], v34 offset:28672
    ds_read_b64_tr_b16 v[50:51], v34 offset:29696
    s_waitcnt lgkmcnt(10)
    v_mfma_f32_32x32x16_bf16 v[80:95], v[52:55], v[240:243], v[80:95]
    s_mul_i32 s56, s34, 3072
    s_lshl_b32 s57, s14, 9
    s_add_u32 s56, s56, s57
    s_add_u32 s56, s56, 811264
    s_add_u32 s57, s33, 34816
    s_mov_b32 m0, s57
    s_nop 0
    buffer_load_dwordx4 v9, s[36:39], s56 offen lds

    ds_read_b64_tr_b16 v[52:53], v35 offset:28672
    ds_read_b64_tr_b16 v[54:55], v35 offset:29696
    s_waitcnt lgkmcnt(10)
    v_mfma_f32_32x32x16_bf16 v[64:79], v[56:59], v[244:247], v[64:79]
    s_waitcnt lgkmcnt(8)
    v_mfma_f32_32x32x16_bf16 v[80:95], v[60:63], v[244:247], v[80:95]
    s_waitcnt lgkmcnt(6)
    v_mfma_f32_32x32x16_bf16 v[64:79], v[40:43], v[248:251], v[64:79]
    s_waitcnt lgkmcnt(4)
    v_mfma_f32_32x32x16_bf16 v[80:95], v[44:47], v[248:251], v[80:95]
    s_mul_i32 s56, s34, 3072
    s_lshl_b32 s57, s14, 9
    s_add_u32 s56, s56, s57
    s_add_u32 s56, s56, 823552
    s_add_u32 s57, s33, 35840
    s_mov_b32 m0, s57
    s_nop 0
    buffer_load_dwordx4 v9, s[36:39], s56 offen lds

    s_waitcnt lgkmcnt(2)
    v_mfma_f32_32x32x16_bf16 v[64:79], v[48:51], v[252:255], v[64:79]
    s_waitcnt lgkmcnt(0)
    v_mfma_f32_32x32x16_bf16 v[80:95], v[52:55], v[252:255], v[80:95]
    s_nop 15
    s_sub_u32 s30, s14, 0
    s_lshl_b32 s30, s30, 3
    s_add_u32 s30, s30, 0
    s_add_u32 s30, s30, s43
    s_cmp_lt_u32 s14, 2
    s_cselect_b32 s31, 0x3eb8aa3b, 1.0
    v_mul_f32 v38, s31, v24
    s_lshl_b32 s30, s30, 17

    v_mul_f32 v64, v38, v64
    v_mul_f32 v65, v38, v65
    v_mul_f32 v66, v38, v66
    v_mul_f32 v67, v38, v67
    v_mul_f32 v68, v38, v68
    v_mul_f32 v69, v38, v69
    v_mul_f32 v70, v38, v70
    v_mul_f32 v71, v38, v71
    v_mul_f32 v72, v38, v72
    v_mul_f32 v73, v38, v73
    v_mul_f32 v74, v38, v74
    v_mul_f32 v75, v38, v75
    v_mul_f32 v76, v38, v76
    v_mul_f32 v77, v38, v77
    v_mul_f32 v78, v38, v78
    v_mul_f32 v79, v38, v79
    v_cvt_pk_bf16_f32 v64, v64, v65
    v_cvt_pk_bf16_f32 v65, v66, v67
    v_cvt_pk_bf16_f32 v66, v68, v69
    v_cvt_pk_bf16_f32 v67, v70, v71
    v_cvt_pk_bf16_f32 v68, v72, v73
    v_cvt_pk_bf16_f32 v69, v74, v75
    v_cvt_pk_bf16_f32 v70, v76, v77
    v_cvt_pk_bf16_f32 v71, v78, v79
    s_add_u32 s31, s30, 0
    s_add_u32 s32, s30, 65536
    s_nop 1
    v_permlane32_swap_b32 v64, v66
    v_permlane32_swap_b32 v65, v67
    buffer_store_dwordx4 v[64:67], v21, s[20:23], s31 offen sc0 sc1

    s_nop 1
    v_permlane32_swap_b32 v68, v70
    v_permlane32_swap_b32 v69, v71
    buffer_store_dwordx4 v[68:71], v21, s[20:23], s32 offen sc0 sc1

    v_mul_f32 v80, v38, v80
    v_mul_f32 v81, v38, v81
    v_mul_f32 v82, v38, v82
    v_mul_f32 v83, v38, v83
    v_mul_f32 v84, v38, v84
    v_mul_f32 v85, v38, v85
    v_mul_f32 v86, v38, v86
    v_mul_f32 v87, v38, v87
    v_mul_f32 v88, v38, v88
    v_mul_f32 v89, v38, v89
    v_mul_f32 v90, v38, v90
    v_mul_f32 v91, v38, v91
    v_mul_f32 v92, v38, v92
    v_mul_f32 v93, v38, v93
    v_mul_f32 v94, v38, v94
    v_mul_f32 v95, v38, v95
    v_cvt_pk_bf16_f32 v80, v80, v81
    v_cvt_pk_bf16_f32 v81, v82, v83
    v_cvt_pk_bf16_f32 v82, v84, v85
    v_cvt_pk_bf16_f32 v83, v86, v87
    v_cvt_pk_bf16_f32 v84, v88, v89
    v_cvt_pk_bf16_f32 v85, v90, v91
    v_cvt_pk_bf16_f32 v86, v92, v93
    v_cvt_pk_bf16_f32 v87, v94, v95
    s_add_u32 s31, s30, 131072
    s_add_u32 s32, s30, 196608
    s_nop 1
    v_permlane32_swap_b32 v80, v82
    v_permlane32_swap_b32 v81, v83
    buffer_store_dwordx4 v[80:83], v21, s[20:23], s31 offen sc0 sc1

    s_nop 1
    v_permlane32_swap_b32 v84, v86
    v_permlane32_swap_b32 v85, v87
    buffer_store_dwordx4 v[84:87], v21, s[20:23], s32 offen sc0 sc1

    s_nop 1
    s_waitcnt vmcnt(12)
    s_waitcnt lgkmcnt(0)
    s_barrier
    s_cmp_ge_u32 s52, 1888
    s_cbranch_scc1 K1q_wts
    v_lshlrev_b32 v6, 4, v2
    v_lshl_or_b32 v26, v27, 16, v26
    v_lshl_or_b32 v27, v29, 16, v28
    v_lshl_or_b32 v28, v31, 16, v30
    v_lshl_or_b32 v29, v33, 16, v32
    buffer_store_dwordx4 v[26:29], v6, s[20:23], s55 offen sc0 sc1

K1q_wts:
    v_add_u32 v34, 131072, v16
    v_add_u32 v35, 131072, v17
    ds_read_b64_tr_b16 v[40:41], v34 offset:0
    ds_read_b64_tr_b16 v[42:43], v34 offset:1024
    ds_read_b64_tr_b16 v[44:45], v35 offset:0
    ds_read_b64_tr_b16 v[46:47], v35 offset:1024
    ds_read_b64_tr_b16 v[48:49], v34 offset:4096
    ds_read_b64_tr_b16 v[50:51], v34 offset:5120
    ds_read_b64_tr_b16 v[52:53], v35 offset:4096
    ds_read_b64_tr_b16 v[54:55], v35 offset:5120
    ds_read_b64_tr_b16 v[56:57], v34 offset:8192
    ds_read_b64_tr_b16 v[58:59], v34 offset:9216
    ds_read_b64_tr_b16 v[60:61], v35 offset:8192
    ds_read_b64_tr_b16 v[62:63], v35 offset:9216
    s_waitcnt lgkmcnt(10)
    v_mfma_f32_32x32x16_bf16 v[64:79], v[40:43], v[128:131], 0
    ds_read_b64_tr_b16 v[40:41], v34 offset:12288
    ds_read_b64_tr_b16 v[42:43], v34 offset:13312
    s_waitcnt lgkmcnt(10)
    v_mfma_f32_32x32x16_bf16 v[80:95], v[44:47], v[128:131], 0
    s_mul_i32 s56, s34, 3072
    s_lshl_b32 s57, s14, 9
    s_add_u32 s56, s56, s57
    s_add_u32 s56, s56, 1179904
    s_add_u32 s57, s33, 65536
    s_mov_b32 m0, s57
    s_nop 0
    buffer_load_dwordx4 v9, s[36:39], s56 offen lds

    ds_read_b64_tr_b16 v[44:45], v35 offset:12288
    ds_read_b64_tr_b16 v[46:47], v35 offset:13312
    s_waitcnt lgkmcnt(10)
    v_mfma_f32_32x32x16_bf16 v[64:79], v[48:51], v[132:135], v[64:79]
    ds_read_b64_tr_b16 v[48:49], v34 offset:16384
    ds_read_b64_tr_b16 v[50:51], v34 offset:17408
    s_waitcnt lgkmcnt(10)
    v_mfma_f32_32x32x16_bf16 v[80:95], v[52:55], v[132:135], v[80:95]
    ds_read_b64_tr_b16 v[52:53], v35 offset:16384
    ds_read_b64_tr_b16 v[54:55], v35 offset:17408
    s_waitcnt lgkmcnt(10)
    v_mfma_f32_32x32x16_bf16 v[64:79], v[56:59], v[136:139], v[64:79]
    ds_read_b64_tr_b16 v[56:57], v34 offset:20480
    ds_read_b64_tr_b16 v[58:59], v34 offset:21504
    s_waitcnt lgkmcnt(10)
    v_mfma_f32_32x32x16_bf16 v[80:95], v[60:63], v[136:139], v[80:95]
    s_mul_i32 s56, s34, 3072
    s_lshl_b32 s57, s14, 9
    s_add_u32 s56, s56, s57
    s_add_u32 s56, s56, 1192192
    s_add_u32 s57, s33, 66560
    s_mov_b32 m0, s57
    s_nop 0
    buffer_load_dwordx4 v9, s[36:39], s56 offen lds

    ds_read_b64_tr_b16 v[60:61], v35 offset:20480
    ds_read_b64_tr_b16 v[62:63], v35 offset:21504
    s_waitcnt lgkmcnt(10)
    v_mfma_f32_32x32x16_bf16 v[64:79], v[40:43], v[140:143], v[64:79]
    ds_read_b64_tr_b16 v[40:41], v34 offset:24576
    ds_read_b64_tr_b16 v[42:43], v34 offset:25600
    s_waitcnt lgkmcnt(10)
    v_mfma_f32_32x32x16_bf16 v[80:95], v[44:47], v[140:143], v[80:95]
    ds_read_b64_tr_b16 v[44:45], v35 offset:24576
    ds_read_b64_tr_b16 v[46:47], v35 offset:25600
    s_waitcnt lgkmcnt(10)
    v_mfma_f32_32x32x16_bf16 v[64:79], v[48:51], v[144:147], v[64:79]
    ds_read_b64_tr_b16 v[48:49], v34 offset:28672
    ds_read_b64_tr_b16 v[50:51], v34 offset:29696
    s_waitcnt lgkmcnt(10)
    v_mfma_f32_32x32x16_bf16 v[80:95], v[52:55], v[144:147], v[80:95]
    s_mul_i32 s56, s34, 3072
    s_lshl_b32 s57, s14, 9
    s_add_u32 s56, s56, s57
    s_add_u32 s56, s56, 1204480
    s_add_u32 s57, s33, 67584
    s_mov_b32 m0, s57
    s_nop 0
    buffer_load_dwordx4 v9, s[36:39], s56 offen lds

    ds_read_b64_tr_b16 v[52:53], v35 offset:28672
    ds_read_b64_tr_b16 v[54:55], v35 offset:29696
    s_waitcnt lgkmcnt(10)
    v_mfma_f32_32x32x16_bf16 v[64:79], v[56:59], v[148:151], v[64:79]
    s_waitcnt lgkmcnt(8)
    v_mfma_f32_32x32x16_bf16 v[80:95], v[60:63], v[148:151], v[80:95]
    s_waitcnt lgkmcnt(6)
    v_mfma_f32_32x32x16_bf16 v[64:79], v[40:43], v[152:155], v[64:79]
    s_waitcnt lgkmcnt(4)
    v_mfma_f32_32x32x16_bf16 v[80:95], v[44:47], v[152:155], v[80:95]
    s_mul_i32 s56, s34, 3072
    s_lshl_b32 s57, s14, 9
    s_add_u32 s56, s56, s57
    s_add_u32 s56, s56, 1216768
    s_add_u32 s57, s33, 68608
    s_mov_b32 m0, s57
    s_nop 0
    buffer_load_dwordx4 v9, s[36:39], s56 offen lds

    s_waitcnt lgkmcnt(2)
    v_mfma_f32_32x32x16_bf16 v[64:79], v[48:51], v[156:159], v[64:79]
    s_waitcnt lgkmcnt(0)
    v_mfma_f32_32x32x16_bf16 v[80:95], v[52:55], v[156:159], v[80:95]
    s_cmp_lg_u32 s41, 0
    s_cbranch_scc1 K1q_sk4
    ds_read_b64_tr_b16 v[40:41], v36 offset:0
    ds_read_b64_tr_b16 v[42:43], v36 offset:256
    ds_read_b64_tr_b16 v[44:45], v36 offset:1024
    ds_read_b64_tr_b16 v[46:47], v36 offset:1280
    ds_read_b64_tr_b16 v[48:49], v36 offset:2048
    ds_read_b64_tr_b16 v[50:51], v36 offset:2304
    ds_read_b64_tr_b16 v[52:53], v36 offset:3072
    ds_read_b64_tr_b16 v[54:55], v36 offset:3328
    ds_read_b64_tr_b16 v[56:57], v36 offset:4096
    ds_read_b64_tr_b16 v[58:59], v36 offset:4352
    ds_read_b64_tr_b16 v[60:61], v36 offset:5120
    ds_read_b64_tr_b16 v[62:63], v36 offset:5376
    s_waitcnt lgkmcnt(10)
    v_mfma_f32_32x32x16_bf16 v[112:127], v[40:43], v[128:131], 0
    ds_read_b64_tr_b16 v[40:41], v36 offset:6144
    ds_read_b64_tr_b16 v[42:43], v36 offset:6400
    s_waitcnt lgkmcnt(10)
    v_mfma_f32_32x32x16_bf16 v[112:127], v[44:47], v[132:135], v[112:127]
    ds_read_b64_tr_b16 v[44:45], v36 offset:7168
    ds_read_b64_tr_b16 v[46:47], v36 offset:7424
    s_waitcnt lgkmcnt(10)
    v_mfma_f32_32x32x16_bf16 v[112:127], v[48:51], v[136:139], v[112:127]
    s_waitcnt lgkmcnt(8)
    v_mfma_f32_32x32x16_bf16 v[112:127], v[52:55], v[140:143], v[112:127]
    s_waitcnt lgkmcnt(6)
    v_mfma_f32_32x32x16_bf16 v[112:127], v[56:59], v[144:147], v[112:127]
    s_waitcnt lgkmcnt(4)
    v_mfma_f32_32x32x16_bf16 v[112:127], v[60:63], v[148:151], v[112:127]
    s_waitcnt lgkmcnt(2)
    v_mfma_f32_32x32x16_bf16 v[112:127], v[40:43], v[152:155], v[112:127]
    s_waitcnt lgkmcnt(0)
    v_mfma_f32_32x32x16_bf16 v[112:127], v[44:47], v[156:159], v[112:127]
K1q_sk4:
    s_waitcnt vmcnt(12)
    s_waitcnt lgkmcnt(0)
    s_barrier
    v_add_u32 v34, 0, v16
    v_add_u32 v35, 0, v17
    ds_read_b64_tr_b16 v[40:41], v34 offset:0
    ds_read_b64_tr_b16 v[42:43], v34 offset:1024
    ds_read_b64_tr_b16 v[44:45], v35 offset:0
    ds_read_b64_tr_b16 v[46:47], v35 offset:1024
    ds_read_b64_tr_b16 v[48:49], v34 offset:4096
    ds_read_b64_tr_b16 v[50:51], v34 offset:5120
    ds_read_b64_tr_b16 v[52:53], v35 offset:4096
    ds_read_b64_tr_b16 v[54:55], v35 offset:5120
    ds_read_b64_tr_b16 v[56:57], v34 offset:8192
    ds_read_b64_tr_b16 v[58:59], v34 offset:9216
    ds_read_b64_tr_b16 v[60:61], v35 offset:8192
    ds_read_b64_tr_b16 v[62:63], v35 offset:9216
    s_waitcnt lgkmcnt(10)
    v_mfma_f32_32x32x16_bf16 v[64:79], v[40:43], v[160:163], v[64:79]
    ds_read_b64_tr_b16 v[40:41], v34 offset:12288
    ds_read_b64_tr_b16 v[42:43], v34 offset:13312
    s_waitcnt lgkmcnt(10)
    v_mfma_f32_32x32x16_bf16 v[80:95], v[44:47], v[160:163], v[80:95]
    ds_read_b64_tr_b16 v[44:45], v35 offset:12288
    ds_read_b64_tr_b16 v[46:47], v35 offset:13312
    s_waitcnt lgkmcnt(10)
    v_mfma_f32_32x32x16_bf16 v[64:79], v[48:51], v[164:167], v[64:79]
    ds_read_b64_tr_b16 v[48:49], v34 offset:16384
    ds_read_b64_tr_b16 v[50:51], v34 offset:17408
    s_waitcnt lgkmcnt(10)
    v_mfma_f32_32x32x16_bf16 v[80:95], v[52:55], v[164:167], v[80:95]
    ds_read_b64_tr_b16 v[52:53], v35 offset:16384
    ds_read_b64_tr_b16 v[54:55], v35 offset:17408
    s_waitcnt lgkmcnt(10)
    v_mfma_f32_32x32x16_bf16 v[64:79], v[56:59], v[168:171], v[64:79]
    ds_read_b64_tr_b16 v[56:57], v34 offset:20480
    ds_read_b64_tr_b16 v[58:59], v34 offset:21504
    s_waitcnt lgkmcnt(10)
    v_mfma_f32_32x32x16_bf16 v[80:95], v[60:63], v[168:171], v[80:95]
    ds_read_b64_tr_b16 v[60:61], v35 offset:20480
    ds_read_b64_tr_b16 v[62:63], v35 offset:21504
    s_waitcnt lgkmcnt(10)
    v_mfma_f32_32x32x16_bf16 v[64:79], v[40:43], v[172:175], v[64:79]
    ds_read_b64_tr_b16 v[40:41], v34 offset:24576
    ds_read_b64_tr_b16 v[42:43], v34 offset:25600
    s_waitcnt lgkmcnt(10)
    v_mfma_f32_32x32x16_bf16 v[80:95], v[44:47], v[172:175], v[80:95]
    ds_read_b64_tr_b16 v[44:45], v35 offset:24576
    ds_read_b64_tr_b16 v[46:47], v35 offset:25600
    s_waitcnt lgkmcnt(10)
    v_mfma_f32_32x32x16_bf16 v[64:79], v[48:51], v[176:179], v[64:79]
    ds_read_b64_tr_b16 v[48:49], v34 offset:28672
    ds_read_b64_tr_b16 v[50:51], v34 offset:29696
    s_waitcnt lgkmcnt(10)
    v_mfma_f32_32x32x16_bf16 v[80:95], v[52:55], v[176:179], v[80:95]
    ds_read_b64_tr_b16 v[52:53], v35 offset:28672
    ds_read_b64_tr_b16 v[54:55], v35 offset:29696
    s_waitcnt lgkmcnt(10)
    v_mfma_f32_32x32x16_bf16 v[64:79], v[56:59], v[180:183], v[64:79]
    s_waitcnt lgkmcnt(8)
    v_mfma_f32_32x32x16_bf16 v[80:95], v[60:63], v[180:183], v[80:95]
    s_waitcnt lgkmcnt(6)
    v_mfma_f32_32x32x16_bf16 v[64:79], v[40:43], v[184:187], v[64:79]
    s_waitcnt lgkmcnt(4)
    v_mfma_f32_32x32x16_bf16 v[80:95], v[44:47], v[184:187], v[80:95]
    s_waitcnt lgkmcnt(2)
    v_mfma_f32_32x32x16_bf16 v[64:79], v[48:51], v[188:191], v[64:79]
    s_waitcnt lgkmcnt(0)
    v_mfma_f32_32x32x16_bf16 v[80:95], v[52:55], v[188:191], v[80:95]
    s_cmp_lg_u32 s41, 0
    s_cbranch_scc1 K1q_sk5
    ds_read_b64_tr_b16 v[40:41], v36 offset:8192
    ds_read_b64_tr_b16 v[42:43], v36 offset:8448
    ds_read_b64_tr_b16 v[44:45], v36 offset:9216
    ds_read_b64_tr_b16 v[46:47], v36 offset:9472
    ds_read_b64_tr_b16 v[48:49], v36 offset:10240
    ds_read_b64_tr_b16 v[50:51], v36 offset:10496
    ds_read_b64_tr_b16 v[52:53], v36 offset:11264
    ds_read_b64_tr_b16 v[54:55], v36 offset:11520
    ds_read_b64_tr_b16 v[56:57], v36 offset:12288
    ds_read_b64_tr_b16 v[58:59], v36 offset:12544
    ds_read_b64_tr_b16 v[60:61], v36 offset:13312
    ds_read_b64_tr_b16 v[62:63], v36 offset:13568
    s_waitcnt lgkmcnt(10)
    v_mfma_f32_32x32x16_bf16 v[112:127], v[40:43], v[160:163], v[112:127]
    ds_read_b64_tr_b16 v[40:41], v36 offset:14336
    ds_read_b64_tr_b16 v[42:43], v36 offset:14592
    s_waitcnt lgkmcnt(10)
    v_mfma_f32_32x32x16_bf16 v[112:127], v[44:47], v[164:167], v[112:127]
    ds_read_b64_tr_b16 v[44:45], v36 offset:15360
    ds_read_b64_tr_b16 v[46:47], v36 offset:15616
    s_waitcnt lgkmcnt(10)
    v_mfma_f32_32x32x16_bf16 v[112:127], v[48:51], v[168:171], v[112:127]
    s_waitcnt lgkmcnt(8)
    v_mfma_f32_32x32x16_bf16 v[112:127], v[52:55], v[172:175], v[112:127]
    s_waitcnt lgkmcnt(6)
    v_mfma_f32_32x32x16_bf16 v[112:127], v[56:59], v[176:179], v[112:127]
    s_waitcnt lgkmcnt(4)
    v_mfma_f32_32x32x16_bf16 v[112:127], v[60:63], v[180:183], v[112:127]
    s_waitcnt lgkmcnt(2)
    v_mfma_f32_32x32x16_bf16 v[112:127], v[40:43], v[184:187], v[112:127]
    s_waitcnt lgkmcnt(0)
    v_mfma_f32_32x32x16_bf16 v[112:127], v[44:47], v[188:191], v[112:127]
K1q_sk5:
    s_waitcnt vmcnt(8)
    s_waitcnt lgkmcnt(0)
    s_barrier
    v_add_u32 v34, 32768, v16
    v_add_u32 v35, 32768, v17
    ds_read_b64_tr_b16 v[40:41], v34 offset:0
    ds_read_b64_tr_b16 v[42:43], v34 offset:1024
    ds_read_b64_tr_b16 v[44:45], v35 offset:0
    ds_read_b64_tr_b16 v[46:47], v35 offset:1024
    ds_read_b64_tr_b16 v[48:49], v34 offset:4096
    ds_read_b64_tr_b16 v[50:51], v34 offset:5120
    ds_read_b64_tr_b16 v[52:53], v35 offset:4096
    ds_read_b64_tr_b16 v[54:55], v35 offset:5120
    ds_read_b64_tr_b16 v[56:57], v34 offset:8192
    ds_read_b64_tr_b16 v[58:59], v34 offset:9216
    ds_read_b64_tr_b16 v[60:61], v35 offset:8192
    ds_read_b64_tr_b16 v[62:63], v35 offset:9216
    s_waitcnt lgkmcnt(10)
    v_mfma_f32_32x32x16_bf16 v[64:79], v[40:43], v[192:195], v[64:79]
    ds_read_b64_tr_b16 v[40:41], v34 offset:12288
    ds_read_b64_tr_b16 v[42:43], v34 offset:13312
    s_waitcnt lgkmcnt(10)
    v_mfma_f32_32x32x16_bf16 v[80:95], v[44:47], v[192:195], v[80:95]
    ds_read_b64_tr_b16 v[44:45], v35 offset:12288
    ds_read_b64_tr_b16 v[46:47], v35 offset:13312
    s_waitcnt lgkmcnt(10)
    v_mfma_f32_32x32x16_bf16 v[64:79], v[48:51], v[196:199], v[64:79]
    ds_read_b64_tr_b16 v[48:49], v34 offset:16384
    ds_read_b64_tr_b16 v[50:51], v34 offset:17408
    s_waitcnt lgkmcnt(10)
    v_mfma_f32_32x32x16_bf16 v[80:95], v[52:55], v[196:199], v[80:95]
    ds_read_b64_tr_b16 v[52:53], v35 offset:16384
    ds_read_b64_tr_b16 v[54:55], v35 offset:17408
    s_waitcnt lgkmcnt(10)
    v_mfma_f32_32x32x16_bf16 v[64:79], v[56:59], v[200:203], v[64:79]
    ds_read_b64_tr_b16 v[56:57], v34 offset:20480
    ds_read_b64_tr_b16 v[58:59], v34 offset:21504
    s_waitcnt lgkmcnt(10)
    v_mfma_f32_32x32x16_bf16 v[80:95], v[60:63], v[200:203], v[80:95]
    ds_read_b64_tr_b16 v[60:61], v35 offset:20480
    ds_read_b64_tr_b16 v[62:63], v35 offset:21504
    s_waitcnt lgkmcnt(10)
    v_mfma_f32_32x32x16_bf16 v[64:79], v[40:43], v[204:207], v[64:79]
    ds_read_b64_tr_b16 v[40:41], v34 offset:24576
    ds_read_b64_tr_b16 v[42:43], v34 offset:25600
    s_waitcnt lgkmcnt(10)
    v_mfma_f32_32x32x16_bf16 v[80:95], v[44:47], v[204:207], v[80:95]
    ds_read_b64_tr_b16 v[44:45], v35 offset:24576
    ds_read_b64_tr_b16 v[46:47], v35 offset:25600
    s_waitcnt lgkmcnt(10)
    v_mfma_f32_32x32x16_bf16 v[64:79], v[48:51], v[208:211], v[64:79]
    ds_read_b64_tr_b16 v[48:49], v34 offset:28672
    ds_read_b64_tr_b16 v[50:51], v34 offset:29696
    s_waitcnt lgkmcnt(10)
    v_mfma_f32_32x32x16_bf16 v[80:95], v[52:55], v[208:211], v[80:95]
    ds_read_b64_tr_b16 v[52:53], v35 offset:28672
    ds_read_b64_tr_b16 v[54:55], v35 offset:29696
    s_waitcnt lgkmcnt(10)
    v_mfma_f32_32x32x16_bf16 v[64:79], v[56:59], v[212:215], v[64:79]
    s_waitcnt lgkmcnt(8)
    v_mfma_f32_32x32x16_bf16 v[80:95], v[60:63], v[212:215], v[80:95]
    s_waitcnt lgkmcnt(6)
    v_mfma_f32_32x32x16_bf16 v[64:79], v[40:43], v[216:219], v[64:79]
    s_waitcnt lgkmcnt(4)
    v_mfma_f32_32x32x16_bf16 v[80:95], v[44:47], v[216:219], v[80:95]
    s_waitcnt lgkmcnt(2)
    v_mfma_f32_32x32x16_bf16 v[64:79], v[48:51], v[220:223], v[64:79]
    s_waitcnt lgkmcnt(0)
    v_mfma_f32_32x32x16_bf16 v[80:95], v[52:55], v[220:223], v[80:95]
    s_cmp_lg_u32 s41, 0
    s_cbranch_scc1 K1q_sk6
    ds_read_b64_tr_b16 v[40:41], v36 offset:16384
    ds_read_b64_tr_b16 v[42:43], v36 offset:16640
    ds_read_b64_tr_b16 v[44:45], v36 offset:17408
    ds_read_b64_tr_b16 v[46:47], v36 offset:17664
    ds_read_b64_tr_b16 v[48:49], v36 offset:18432
    ds_read_b64_tr_b16 v[50:51], v36 offset:18688
    ds_read_b64_tr_b16 v[52:53], v36 offset:19456
    ds_read_b64_tr_b16 v[54:55], v36 offset:19712
    ds_read_b64_tr_b16 v[56:57], v36 offset:20480
    ds_read_b64_tr_b16 v[58:59], v36 offset:20736
    ds_read_b64_tr_b16 v[60:61], v36 offset:21504
    ds_read_b64_tr_b16 v[62:63], v36 offset:21760
    s_waitcnt lgkmcnt(10)
    v_mfma_f32_32x32x16_bf16 v[112:127], v[40:43], v[192:195], v[112:127]
    ds_read_b64_tr_b16 v[40:41], v36 offset:22528
    ds_read_b64_tr_b16 v[42:43], v36 offset:22784
    s_waitcnt lgkmcnt(10)
    v_mfma_f32_32x32x16_bf16 v[112:127], v[44:47], v[196:199], v[112:127]
    ds_read_b64_tr_b16 v[44:45], v36 offset:23552
    ds_read_b64_tr_b16 v[46:47], v36 offset:23808
    s_waitcnt lgkmcnt(10)
    v_mfma_f32_32x32x16_bf16 v[112:127], v[48:51], v[200:203], v[112:127]
    s_waitcnt lgkmcnt(8)
    v_mfma_f32_32x32x16_bf16 v[112:127], v[52:55], v[204:207], v[112:127]
    s_waitcnt lgkmcnt(6)
    v_mfma_f32_32x32x16_bf16 v[112:127], v[56:59], v[208:211], v[112:127]
    s_waitcnt lgkmcnt(4)
    v_mfma_f32_32x32x16_bf16 v[112:127], v[60:63], v[212:215], v[112:127]
    s_waitcnt lgkmcnt(2)
    v_mfma_f32_32x32x16_bf16 v[112:127], v[40:43], v[216:219], v[112:127]
    s_waitcnt lgkmcnt(0)
    v_mfma_f32_32x32x16_bf16 v[112:127], v[44:47], v[220:223], v[112:127]
K1q_sk6:
    s_waitcnt vmcnt(0)
    s_waitcnt lgkmcnt(0)
    s_barrier
    v_add_u32 v34, 65536, v16
    v_add_u32 v35, 65536, v17
    ds_read_b64_tr_b16 v[40:41], v34 offset:0
    ds_read_b64_tr_b16 v[42:43], v34 offset:1024
    ds_read_b64_tr_b16 v[44:45], v35 offset:0
    ds_read_b64_tr_b16 v[46:47], v35 offset:1024
    ds_read_b64_tr_b16 v[48:49], v34 offset:4096
    ds_read_b64_tr_b16 v[50:51], v34 offset:5120
    ds_read_b64_tr_b16 v[52:53], v35 offset:4096
    ds_read_b64_tr_b16 v[54:55], v35 offset:5120
    ds_read_b64_tr_b16 v[56:57], v34 offset:8192
    ds_read_b64_tr_b16 v[58:59], v34 offset:9216
    ds_read_b64_tr_b16 v[60:61], v35 offset:8192
    ds_read_b64_tr_b16 v[62:63], v35 offset:9216
    s_waitcnt lgkmcnt(10)
    v_mfma_f32_32x32x16_bf16 v[64:79], v[40:43], v[224:227], v[64:79]
    ds_read_b64_tr_b16 v[40:41], v34 offset:12288
    ds_read_b64_tr_b16 v[42:43], v34 offset:13312
    s_waitcnt lgkmcnt(10)
    v_mfma_f32_32x32x16_bf16 v[80:95], v[44:47], v[224:227], v[80:95]
    ds_read_b64_tr_b16 v[44:45], v35 offset:12288
    ds_read_b64_tr_b16 v[46:47], v35 offset:13312
    s_waitcnt lgkmcnt(10)
    v_mfma_f32_32x32x16_bf16 v[64:79], v[48:51], v[228:231], v[64:79]
    ds_read_b64_tr_b16 v[48:49], v34 offset:16384
    ds_read_b64_tr_b16 v[50:51], v34 offset:17408
    s_waitcnt lgkmcnt(10)
    v_mfma_f32_32x32x16_bf16 v[80:95], v[52:55], v[228:231], v[80:95]
    ds_read_b64_tr_b16 v[52:53], v35 offset:16384
    ds_read_b64_tr_b16 v[54:55], v35 offset:17408
    s_waitcnt lgkmcnt(10)
    v_mfma_f32_32x32x16_bf16 v[64:79], v[56:59], v[232:235], v[64:79]
    ds_read_b64_tr_b16 v[56:57], v34 offset:20480
    ds_read_b64_tr_b16 v[58:59], v34 offset:21504
    s_waitcnt lgkmcnt(10)
    v_mfma_f32_32x32x16_bf16 v[80:95], v[60:63], v[232:235], v[80:95]
    ds_read_b64_tr_b16 v[60:61], v35 offset:20480
    ds_read_b64_tr_b16 v[62:63], v35 offset:21504
    s_waitcnt lgkmcnt(10)
    v_mfma_f32_32x32x16_bf16 v[64:79], v[40:43], v[236:239], v[64:79]
    ds_read_b64_tr_b16 v[40:41], v34 offset:24576
    ds_read_b64_tr_b16 v[42:43], v34 offset:25600
    s_waitcnt lgkmcnt(10)
    v_mfma_f32_32x32x16_bf16 v[80:95], v[44:47], v[236:239], v[80:95]
    ds_read_b64_tr_b16 v[44:45], v35 offset:24576
    ds_read_b64_tr_b16 v[46:47], v35 offset:25600
    s_waitcnt lgkmcnt(10)
    v_mfma_f32_32x32x16_bf16 v[64:79], v[48:51], v[240:243], v[64:79]
    ds_read_b64_tr_b16 v[48:49], v34 offset:28672
    ds_read_b64_tr_b16 v[50:51], v34 offset:29696
    s_waitcnt lgkmcnt(10)
    v_mfma_f32_32x32x16_bf16 v[80:95], v[52:55], v[240:243], v[80:95]
    ds_read_b64_tr_b16 v[52:53], v35 offset:28672
    ds_read_b64_tr_b16 v[54:55], v35 offset:29696
    s_waitcnt lgkmcnt(10)
    v_mfma_f32_32x32x16_bf16 v[64:79], v[56:59], v[244:247], v[64:79]
    s_waitcnt lgkmcnt(8)
    v_mfma_f32_32x32x16_bf16 v[80:95], v[60:63], v[244:247], v[80:95]
    s_waitcnt lgkmcnt(6)
    v_mfma_f32_32x32x16_bf16 v[64:79], v[40:43], v[248:251], v[64:79]
    s_waitcnt lgkmcnt(4)
    v_mfma_f32_32x32x16_bf16 v[80:95], v[44:47], v[248:251], v[80:95]
    s_waitcnt lgkmcnt(2)
    v_mfma_f32_32x32x16_bf16 v[64:79], v[48:51], v[252:255], v[64:79]
    s_waitcnt lgkmcnt(0)
    v_mfma_f32_32x32x16_bf16 v[80:95], v[52:55], v[252:255], v[80:95]
    s_cmp_lg_u32 s41, 0
    s_cbranch_scc1 K1q_sk7
    ds_read_b64_tr_b16 v[40:41], v36 offset:24576
    ds_read_b64_tr_b16 v[42:43], v36 offset:24832
    ds_read_b64_tr_b16 v[44:45], v36 offset:25600
    ds_read_b64_tr_b16 v[46:47], v36 offset:25856
    ds_read_b64_tr_b16 v[48:49], v36 offset:26624
    ds_read_b64_tr_b16 v[50:51], v36 offset:26880
    ds_read_b64_tr_b16 v[52:53], v36 offset:27648
    ds_read_b64_tr_b16 v[54:55], v36 offset:27904
    ds_read_b64_tr_b16 v[56:57], v36 offset:28672
    ds_read_b64_tr_b16 v[58:59], v36 offset:28928
    ds_read_b64_tr_b16 v[60:61], v36 offset:29696
    ds_read_b64_tr_b16 v[62:63], v36 offset:29952
    s_waitcnt lgkmcnt(10)
    v_mfma_f32_32x32x16_bf16 v[112:127], v[40:43], v[224:227], v[112:127]
    ds_read_b64_tr_b16 v[40:41], v36 offset:30720
    ds_read_b64_tr_b16 v[42:43], v36 offset:30976
    s_waitcnt lgkmcnt(10)
    v_mfma_f32_32x32x16_bf16 v[112:127], v[44:47], v[228:231], v[112:127]
    ds_read_b64_tr_b16 v[44:45], v36 offset:31744
    ds_read_b64_tr_b16 v[46:47], v36 offset:32000
    s_waitcnt lgkmcnt(10)
    v_mfma_f32_32x32x16_bf16 v[112:127], v[48:51], v[232:235], v[112:127]
    s_waitcnt lgkmcnt(8)
    v_mfma_f32_32x32x16_bf16 v[112:127], v[52:55], v[236:239], v[112:127]
    s_waitcnt lgkmcnt(6)
    v_mfma_f32_32x32x16_bf16 v[112:127], v[56:59], v[240:243], v[112:127]
    s_waitcnt lgkmcnt(4)
    v_mfma_f32_32x32x16_bf16 v[112:127], v[60:63], v[244:247], v[112:127]
    s_waitcnt lgkmcnt(2)
    v_mfma_f32_32x32x16_bf16 v[112:127], v[40:43], v[248:251], v[112:127]
    s_waitcnt lgkmcnt(0)
    v_mfma_f32_32x32x16_bf16 v[112:127], v[44:47], v[252:255], v[112:127]
K1q_sk7:
    s_nop 15
    s_sub_u32 s30, s14, 0
    s_lshl_b32 s30, s30, 3
    s_add_u32 s30, s30, 4
    s_add_u32 s30, s30, s43
    s_cmp_lt_u32 s14, 2
    s_cselect_b32 s31, 0x3eb8aa3b, 1.0
    v_mul_f32 v38, s31, v24
    s_lshl_b32 s30, s30, 17

    v_mul_f32 v64, v38, v64
    v_mul_f32 v65, v38, v65
    v_mul_f32 v66, v38, v66
    v_mul_f32 v67, v38, v67
    v_mul_f32 v68, v38, v68
    v_mul_f32 v69, v38, v69
    v_mul_f32 v70, v38, v70
    v_mul_f32 v71, v38, v71
    v_mul_f32 v72, v38, v72
    v_mul_f32 v73, v38, v73
    v_mul_f32 v74, v38, v74
    v_mul_f32 v75, v38, v75
    v_mul_f32 v76, v38, v76
    v_mul_f32 v77, v38, v77
    v_mul_f32 v78, v38, v78
    v_mul_f32 v79, v38, v79
    v_cvt_pk_bf16_f32 v64, v64, v65
    v_cvt_pk_bf16_f32 v65, v66, v67
    v_cvt_pk_bf16_f32 v66, v68, v69
    v_cvt_pk_bf16_f32 v67, v70, v71
    v_cvt_pk_bf16_f32 v68, v72, v73
    v_cvt_pk_bf16_f32 v69, v74, v75
    v_cvt_pk_bf16_f32 v70, v76, v77
    v_cvt_pk_bf16_f32 v71, v78, v79
    s_add_u32 s31, s30, 0
    s_add_u32 s32, s30, 65536
    s_nop 1
    v_permlane32_swap_b32 v64, v66
    v_permlane32_swap_b32 v65, v67
    buffer_store_dwordx4 v[64:67], v21, s[20:23], s31 offen sc0 sc1

    s_nop 1
    v_permlane32_swap_b32 v68, v70
    v_permlane32_swap_b32 v69, v71
    buffer_store_dwordx4 v[68:71], v21, s[20:23], s32 offen sc0 sc1

    v_mul_f32 v80, v38, v80
    v_mul_f32 v81, v38, v81
    v_mul_f32 v82, v38, v82
    v_mul_f32 v83, v38, v83
    v_mul_f32 v84, v38, v84
    v_mul_f32 v85, v38, v85
    v_mul_f32 v86, v38, v86
    v_mul_f32 v87, v38, v87
    v_mul_f32 v88, v38, v88
    v_mul_f32 v89, v38, v89
    v_mul_f32 v90, v38, v90
    v_mul_f32 v91, v38, v91
    v_mul_f32 v92, v38, v92
    v_mul_f32 v93, v38, v93
    v_mul_f32 v94, v38, v94
    v_mul_f32 v95, v38, v95
    v_cvt_pk_bf16_f32 v80, v80, v81
    v_cvt_pk_bf16_f32 v81, v82, v83
    v_cvt_pk_bf16_f32 v82, v84, v85
    v_cvt_pk_bf16_f32 v83, v86, v87
    v_cvt_pk_bf16_f32 v84, v88, v89
    v_cvt_pk_bf16_f32 v85, v90, v91
    v_cvt_pk_bf16_f32 v86, v92, v93
    v_cvt_pk_bf16_f32 v87, v94, v95
    s_add_u32 s31, s30, 131072
    s_add_u32 s32, s30, 196608
    s_nop 1
    v_permlane32_swap_b32 v80, v82
    v_permlane32_swap_b32 v81, v83
    buffer_store_dwordx4 v[80:83], v21, s[20:23], s31 offen sc0 sc1

    s_nop 1
    v_permlane32_swap_b32 v84, v86
    v_permlane32_swap_b32 v85, v87
    buffer_store_dwordx4 v[84:87], v21, s[20:23], s32 offen sc0 sc1

    s_nop 1
    s_cmp_lg_u32 s41, 0
    s_cbranch_scc1 K1_done
    s_nop 15
    s_add_u32 s30, s14, 80
    s_lshl_b32 s30, s30, 16
    s_add_u32 s30, s30, 8388608
    v_mul_f32 v38, 0xbfb8aa3b, v24
    v_mul_f32 v39, v24, v24

    v_mul_f32 v40, v38, v112
    v_mul_f32 v41, v38, v113
    v_mul_f32 v42, v38, v114
    v_mul_f32 v43, v38, v115
    v_mul_f32 v44, v38, v116
    v_mul_f32 v45, v38, v117
    v_mul_f32 v46, v38, v118
    v_mul_f32 v47, v38, v119
    v_exp_f32 v40, v40
    v_exp_f32 v41, v41
    v_exp_f32 v42, v42
    v_exp_f32 v43, v43
    v_exp_f32 v44, v44
    v_exp_f32 v45, v45
    v_exp_f32 v46, v46
    v_exp_f32 v47, v47
    v_mul_f32 v112, v112, v120
    v_mul_f32 v113, v113, v121
    v_mul_f32 v114, v114, v122
    v_mul_f32 v115, v115, v123
    v_mul_f32 v116, v116, v124
    v_mul_f32 v117, v117, v125
    v_mul_f32 v118, v118, v126
    v_mul_f32 v119, v119, v127
    v_add_f32 v40, 1.0, v40
    v_add_f32 v41, 1.0, v41
    v_add_f32 v42, 1.0, v42
    v_add_f32 v43, 1.0, v43
    v_add_f32 v44, 1.0, v44
    v_add_f32 v45, 1.0, v45
    v_add_f32 v46, 1.0, v46
    v_add_f32 v47, 1.0, v47
    v_rcp_f32 v40, v40
    v_rcp_f32 v41, v41
    v_rcp_f32 v42, v42
    v_rcp_f32 v43, v43
    v_rcp_f32 v44, v44
    v_rcp_f32 v45, v45
    v_rcp_f32 v46, v46
    v_rcp_f32 v47, v47
    v_mul_f32 v112, v39, v112
    v_mul_f32 v113, v39, v113
    v_mul_f32 v114, v39, v114
    v_mul_f32 v115, v39, v115
    v_mul_f32 v116, v39, v116
    v_mul_f32 v117, v39, v117
    v_mul_f32 v118, v39, v118
    v_mul_f32 v119, v39, v119
    v_mul_f32 v112, v40, v112
    v_mul_f32 v113, v41, v113
    v_mul_f32 v114, v42, v114
    v_mul_f32 v115, v43, v115
    v_mul_f32 v116, v44, v116
    v_mul_f32 v117, v45, v117
    v_mul_f32 v118, v46, v118
    v_mul_f32 v119, v47, v119
    v_cvt_pk_bf16_f32 v112, v112, v113
    v_cvt_pk_bf16_f32 v113, v114, v115
    v_cvt_pk_bf16_f32 v114, v116, v117
    v_cvt_pk_bf16_f32 v115, v118, v119
    s_add_u32 s31, s30, 0
    s_nop 1
    v_permlane32_swap_b32 v112, v114
    v_permlane32_swap_b32 v113, v115
    buffer_store_dwordx4 v[112:115], v22, s[20:23], s31 offen sc0 sc1

    s_nop 1
    s_branch K1_done
K1_v:
    s_mul_i32 s30, s34, 3072
    s_lshl_b32 s31, s14, 9
    s_add_u32 s30, s30, s31
    s_add_u32 s30, s30, 0

    s_add_u32 s31, s33, 131072
    s_mov_b32 m0, s31
    s_add_u32 s32, s30, 0
    buffer_load_dwordx4 v9, s[36:39], s32 offen lds

    s_add_u32 s31, s33, 132096
    s_mov_b32 m0, s31
    s_add_u32 s32, s30, 12288
    buffer_load_dwordx4 v9, s[36:39], s32 offen lds

    s_add_u32 s31, s33, 133120
    s_mov_b32 m0, s31
    s_add_u32 s32, s30, 24576
    buffer_load_dwordx4 v9, s[36:39], s32 offen lds

    s_add_u32 s31, s33, 134144
    s_mov_b32 m0, s31
    s_add_u32 s32, s30, 36864
    buffer_load_dwordx4 v9, s[36:39], s32 offen lds

    v_and_b32 v6, 15, v3
    v_lshlrev_b32 v7, 10, v3
    v_add_u32 v7, s29, v7

    v_add_u32 v8, 0, v4
    v_xor_b32 v8, v8, v6
    v_lshl_add_u32 v16, v8, 4, v7

    v_add_u32 v8, 2, v4
    v_xor_b32 v8, v8, v6
    v_lshl_add_u32 v17, v8, 4, v7

    v_add_u32 v8, 4, v4
    v_xor_b32 v8, v8, v6
    v_lshl_add_u32 v18, v8, 4, v7

    v_add_u32 v8, 6, v4
    v_xor_b32 v8, v8, v6
    v_lshl_add_u32 v19, v8, 4, v7

    v_add_u32 v8, 8, v4
    v_xor_b32 v8, v8, v6
    v_lshl_add_u32 v20, v8, 4, v7

    v_add_u32 v8, 10, v4
    v_xor_b32 v8, v8, v6
    v_lshl_add_u32 v21, v8, 4, v7

    v_add_u32 v8, 12, v4
    v_xor_b32 v8, v8, v6
    v_lshl_add_u32 v22, v8, 4, v7

    v_add_u32 v8, 14, v4
    v_xor_b32 v8, v8, v6
    v_lshl_add_u32 v23, v8, 4, v7

    s_waitcnt vmcnt(4)
    s_barrier
    ds_read_b128 v[128:131], v16 offset:0
    ds_read_b128 v[132:135], v17 offset:0
    ds_read_b128 v[136:139], v18 offset:0
    ds_read_b128 v[140:143], v19 offset:0
    ds_read_b128 v[144:147], v20 offset:0
    ds_read_b128 v[148:151], v21 offset:0
    ds_read_b128 v[152:155], v22 offset:0
    ds_read_b128 v[156:159], v23 offset:0
    s_waitcnt lgkmcnt(0)
    ds_read_b128 v[160:163], v16 offset:256
    ds_read_b128 v[164:167], v17 offset:256
    ds_read_b128 v[168:171], v18 offset:256
    ds_read_b128 v[172:175], v19 offset:256
    ds_read_b128 v[176:179], v20 offset:256
    ds_read_b128 v[180:183], v21 offset:256
    ds_read_b128 v[184:187], v22 offset:256
    ds_read_b128 v[188:191], v23 offset:256
    s_waitcnt lgkmcnt(0)
    ds_read_b128 v[192:195], v16 offset:512
    ds_read_b128 v[196:199], v17 offset:512
    ds_read_b128 v[200:203], v18 offset:512
    ds_read_b128 v[204:207], v19 offset:512
    ds_read_b128 v[208:211], v20 offset:512
    ds_read_b128 v[212:215], v21 offset:512
    ds_read_b128 v[216:219], v22 offset:512
    ds_read_b128 v[220:223], v23 offset:512
    s_waitcnt lgkmcnt(0)
    ds_read_b128 v[224:227], v16 offset:768
    ds_read_b128 v[228:231], v17 offset:768
    ds_read_b128 v[232:235], v18 offset:768
    ds_read_b128 v[236:239], v19 offset:768
    ds_read_b128 v[240:243], v20 offset:768
    ds_read_b128 v[244:247], v21 offset:768
    ds_read_b128 v[248:251], v22 offset:768
    ds_read_b128 v[252:255], v23 offset:768
    s_waitcnt lgkmcnt(0)
    s_barrier
    v_mov_b32 v20, 0x3f803f80
    v_mov_b32 v21, 0
    v_mov_b32 v22, 0
    v_mov_b32 v25, 0x00003f80
    v_mov_b32 v26, 0x3f800000

    v_dot2_f32_bf16 v21, v128, v20, v21
    v_dot2_f32_bf16 v22, v129, v20, v22
    v_dot2_f32_bf16 v21, v130, v20, v21
    v_dot2_f32_bf16 v22, v131, v20, v22
    v_dot2_f32_bf16 v21, v132, v20, v21
    v_dot2_f32_bf16 v22, v133, v20, v22
    v_dot2_f32_bf16 v21, v134, v20, v21
    v_dot2_f32_bf16 v22, v135, v20, v22
    v_dot2_f32_bf16 v21, v136, v20, v21
    v_dot2_f32_bf16 v22, v137, v20, v22
    v_dot2_f32_bf16 v21, v138, v20, v21
    v_dot2_f32_bf16 v22, v139, v20, v22
    v_dot2_f32_bf16 v21, v140, v20, v21
    v_dot2_f32_bf16 v22, v141, v20, v22
    v_dot2_f32_bf16 v21, v142, v20, v21
    v_dot2_f32_bf16 v22, v143, v20, v22
    v_dot2_f32_bf16 v21, v144, v20, v21
    v_dot2_f32_bf16 v22, v145, v20, v22
    v_dot2_f32_bf16 v21, v146, v20, v21
    v_dot2_f32_bf16 v22, v147, v20, v22
    v_dot2_f32_bf16 v21, v148, v20, v21
    v_dot2_f32_bf16 v22, v149, v20, v22
    v_dot2_f32_bf16 v21, v150, v20, v21
    v_dot2_f32_bf16 v22, v151, v20, v22
    v_dot2_f32_bf16 v21, v152, v20, v21
    v_dot2_f32_bf16 v22, v153, v20, v22
    v_dot2_f32_bf16 v21, v154, v20, v21
    v_dot2_f32_bf16 v22, v155, v20, v22
    v_dot2_f32_bf16 v21, v156, v20, v21
    v_dot2_f32_bf16 v22, v157, v20, v22
    v_dot2_f32_bf16 v21, v158, v20, v21
    v_dot2_f32_bf16 v22, v159, v20, v22
    s_mul_i32 s56, s34, 3072
    s_lshl_b32 s57, s14, 9
    s_add_u32 s56, s56, s57
    s_add_u32 s56, s56, 393216
    s_add_u32 s57, s33, 0
    s_mov_b32 m0, s57
    s_nop 0
    buffer_load_dwordx4 v9, s[36:39], s56 offen lds

    v_dot2_f32_bf16 v21, v160, v20, v21
    v_dot2_f32_bf16 v22, v161, v20, v22
    v_dot2_f32_bf16 v21, v162, v20, v21
    v_dot2_f32_bf16 v22, v163, v20, v22
    v_dot2_f32_bf16 v21, v164, v20, v21
    v_dot2_f32_bf16 v22, v165, v20, v22
    v_dot2_f32_bf16 v21, v166, v20, v21
    v_dot2_f32_bf16 v22, v167, v20, v22
    v_dot2_f32_bf16 v21, v168, v20, v21
    v_dot2_f32_bf16 v22, v169, v20, v22
    v_dot2_f32_bf16 v21, v170, v20, v21
    v_dot2_f32_bf16 v22, v171, v20, v22
    v_dot2_f32_bf16 v21, v172, v20, v21
    v_dot2_f32_bf16 v22, v173, v20, v22
    v_dot2_f32_bf16 v21, v174, v20, v21
    v_dot2_f32_bf16 v22, v175, v20, v22
    v_dot2_f32_bf16 v21, v176, v20, v21
    v_dot2_f32_bf16 v22, v177, v20, v22
    v_dot2_f32_bf16 v21, v178, v20, v21
    v_dot2_f32_bf16 v22, v179, v20, v22
    v_dot2_f32_bf16 v21, v180, v20, v21
    v_dot2_f32_bf16 v22, v181, v20, v22
    v_dot2_f32_bf16 v21, v182, v20, v21
    v_dot2_f32_bf16 v22, v183, v20, v22
    v_dot2_f32_bf16 v21, v184, v20, v21
    v_dot2_f32_bf16 v22, v185, v20, v22
    v_dot2_f32_bf16 v21, v186, v20, v21
    v_dot2_f32_bf16 v22, v187, v20, v22
    v_dot2_f32_bf16 v21, v188, v20, v21
    v_dot2_f32_bf16 v22, v189, v20, v22
    v_dot2_f32_bf16 v21, v190, v20, v21
    v_dot2_f32_bf16 v22, v191, v20, v22
    s_mul_i32 s56, s34, 3072
    s_lshl_b32 s57, s14, 9
    s_add_u32 s56, s56, s57
    s_add_u32 s56, s56, 405504
    s_add_u32 s57, s33, 1024
    s_mov_b32 m0, s57
    s_nop 0
    buffer_load_dwordx4 v9, s[36:39], s56 offen lds

    v_dot2_f32_bf16 v21, v192, v20, v21
    v_dot2_f32_bf16 v22, v193, v20, v22
    v_dot2_f32_bf16 v21, v194, v20, v21
    v_dot2_f32_bf16 v22, v195, v20, v22
    v_dot2_f32_bf16 v21, v196, v20, v21
    v_dot2_f32_bf16 v22, v197, v20, v22
    v_dot2_f32_bf16 v21, v198, v20, v21
    v_dot2_f32_bf16 v22, v199, v20, v22
    v_dot2_f32_bf16 v21, v200, v20, v21
    v_dot2_f32_bf16 v22, v201, v20, v22
    v_dot2_f32_bf16 v21, v202, v20, v21
    v_dot2_f32_bf16 v22, v203, v20, v22
    v_dot2_f32_bf16 v21, v204, v20, v21
    v_dot2_f32_bf16 v22, v205, v20, v22
    v_dot2_f32_bf16 v21, v206, v20, v21
    v_dot2_f32_bf16 v22, v207, v20, v22
    v_dot2_f32_bf16 v21, v208, v20, v21
    v_dot2_f32_bf16 v22, v209, v20, v22
    v_dot2_f32_bf16 v21, v210, v20, v21
    v_dot2_f32_bf16 v22, v211, v20, v22
    v_dot2_f32_bf16 v21, v212, v20, v21
    v_dot2_f32_bf16 v22, v213, v20, v22
    v_dot2_f32_bf16 v21, v214, v20, v21
    v_dot2_f32_bf16 v22, v215, v20, v22
    v_dot2_f32_bf16 v21, v216, v20, v21
    v_dot2_f32_bf16 v22, v217, v20, v22
    v_dot2_f32_bf16 v21, v218, v20, v21
    v_dot2_f32_bf16 v22, v219, v20, v22
    v_dot2_f32_bf16 v21, v220, v20, v21
    v_dot2_f32_bf16 v22, v221, v20, v22
    v_dot2_f32_bf16 v21, v222, v20, v21
    v_dot2_f32_bf16 v22, v223, v20, v22
    s_mul_i32 s56, s34, 3072
    s_lshl_b32 s57, s14, 9
    s_add_u32 s56, s56, s57
    s_add_u32 s56, s56, 417792
    s_add_u32 s57, s33, 2048
    s_mov_b32 m0, s57
    s_nop 0
    buffer_load_dwordx4 v9, s[36:39], s56 offen lds

    v_dot2_f32_bf16 v21, v224, v20, v21
    v_dot2_f32_bf16 v22, v225, v20, v22
    v_dot2_f32_bf16 v21, v226, v20, v21
    v_dot2_f32_bf16 v22, v227, v20, v22
    v_dot2_f32_bf16 v21, v228, v20, v21
    v_dot2_f32_bf16 v22, v229, v20, v22
    v_dot2_f32_bf16 v21, v230, v20, v21
    v_dot2_f32_bf16 v22, v231, v20, v22
    v_dot2_f32_bf16 v21, v232, v20, v21
    v_dot2_f32_bf16 v22, v233, v20, v22
    v_dot2_f32_bf16 v21, v234, v20, v21
    v_dot2_f32_bf16 v22, v235, v20, v22
    v_dot2_f32_bf16 v21, v236, v20, v21
    v_dot2_f32_bf16 v22, v237, v20, v22
    v_dot2_f32_bf16 v21, v238, v20, v21
    v_dot2_f32_bf16 v22, v239, v20, v22
    v_dot2_f32_bf16 v21, v240, v20, v21
    v_dot2_f32_bf16 v22, v241, v20, v22
    v_dot2_f32_bf16 v21, v242, v20, v21
    v_dot2_f32_bf16 v22, v243, v20, v22
    v_dot2_f32_bf16 v21, v244, v20, v21
    v_dot2_f32_bf16 v22, v245, v20, v22
    v_dot2_f32_bf16 v21, v246, v20, v21
    v_dot2_f32_bf16 v22, v247, v20, v22
    v_dot2_f32_bf16 v21, v248, v20, v21
    v_dot2_f32_bf16 v22, v249, v20, v22
    v_dot2_f32_bf16 v21, v250, v20, v21
    v_dot2_f32_bf16 v22, v251, v20, v22
    v_dot2_f32_bf16 v21, v252, v20, v21
    v_dot2_f32_bf16 v22, v253, v20, v22
    v_dot2_f32_bf16 v21, v254, v20, v21
    v_dot2_f32_bf16 v22, v255, v20, v22
    s_mul_i32 s56, s34, 3072
    s_lshl_b32 s57, s14, 9
    s_add_u32 s56, s56, s57
    s_add_u32 s56, s56, 430080
    s_add_u32 s57, s33, 3072
    s_mov_b32 m0, s57
    s_nop 0
    buffer_load_dwordx4 v9, s[36:39], s56 offen lds

    s_nop 3
    v_add_f32 v21, v21, v22
    v_mov_b32 v22, v21
    s_nop 1
    v_permlane32_swap_b32 v21, v22
    s_nop 1
    v_add_f32 v21, v21, v22
    v_mul_f32 v21, 0x3b000000, v21
    v_cvt_pk_bf16_f32 v22, v21, v21
    v_and_b32 v22, 0xffff0000, v22
    v_sub_f32 v23, v21, v22
    v_sub_f32 v22, 0, v22
    v_mov_b32 v24, 0
    v_mov_b32 v27, 0

    v_dot2_f32_bf16 v28, v128, v25, v22
    v_dot2_f32_bf16 v29, v128, v26, v22
    v_dot2_f32_bf16 v30, v129, v25, v22
    v_dot2_f32_bf16 v31, v129, v26, v22
    v_dot2_f32_bf16 v32, v130, v25, v22
    v_dot2_f32_bf16 v33, v130, v26, v22
    v_dot2_f32_bf16 v34, v131, v25, v22
    v_dot2_f32_bf16 v35, v131, v26, v22
    v_cvt_pk_bf16_f32 v128, v28, v29
    v_cvt_pk_bf16_f32 v129, v30, v31
    v_cvt_pk_bf16_f32 v130, v32, v33
    v_cvt_pk_bf16_f32 v131, v34, v35
    v_fmac_f32 v24, v28, v28
    v_fmac_f32 v27, v29, v29
    v_fmac_f32 v24, v30, v30
    v_fmac_f32 v27, v31, v31
    v_fmac_f32 v24, v32, v32
    v_fmac_f32 v27, v33, v33
    v_fmac_f32 v24, v34, v34
    v_fmac_f32 v27, v35, v35
    v_dot2_f32_bf16 v28, v132, v25, v22
    v_dot2_f32_bf16 v29, v132, v26, v22
    v_dot2_f32_bf16 v30, v133, v25, v22
    v_dot2_f32_bf16 v31, v133, v26, v22
    v_dot2_f32_bf16 v32, v134, v25, v22
    v_dot2_f32_bf16 v33, v134, v26, v22
    v_dot2_f32_bf16 v34, v135, v25, v22
    v_dot2_f32_bf16 v35, v135, v26, v22
    v_cvt_pk_bf16_f32 v132, v28, v29
    v_cvt_pk_bf16_f32 v133, v30, v31
    v_cvt_pk_bf16_f32 v134, v32, v33
    v_cvt_pk_bf16_f32 v135, v34, v35
    v_fmac_f32 v24, v28, v28
    v_fmac_f32 v27, v29, v29
    v_fmac_f32 v24, v30, v30
    v_fmac_f32 v27, v31, v31
    v_fmac_f32 v24, v32, v32
    v_fmac_f32 v27, v33, v33
    v_fmac_f32 v24, v34, v34
    v_fmac_f32 v27, v35, v35
    v_dot2_f32_bf16 v28, v136, v25, v22
    v_dot2_f32_bf16 v29, v136, v26, v22
    v_dot2_f32_bf16 v30, v137, v25, v22
    v_dot2_f32_bf16 v31, v137, v26, v22
    v_dot2_f32_bf16 v32, v138, v25, v22
    v_dot2_f32_bf16 v33, v138, v26, v22
    v_dot2_f32_bf16 v34, v139, v25, v22
    v_dot2_f32_bf16 v35, v139, v26, v22
    v_cvt_pk_bf16_f32 v136, v28, v29
    v_cvt_pk_bf16_f32 v137, v30, v31
    v_cvt_pk_bf16_f32 v138, v32, v33
    v_cvt_pk_bf16_f32 v139, v34, v35
    v_fmac_f32 v24, v28, v28
    v_fmac_f32 v27, v29, v29
    v_fmac_f32 v24, v30, v30
    v_fmac_f32 v27, v31, v31
    v_fmac_f32 v24, v32, v32
    v_fmac_f32 v27, v33, v33
    v_fmac_f32 v24, v34, v34
    v_fmac_f32 v27, v35, v35
    v_dot2_f32_bf16 v28, v140, v25, v22
    v_dot2_f32_bf16 v29, v140, v26, v22
    v_dot2_f32_bf16 v30, v141, v25, v22
    v_dot2_f32_bf16 v31, v141, v26, v22
    v_dot2_f32_bf16 v32, v142, v25, v22
    v_dot2_f32_bf16 v33, v142, v26, v22
    v_dot2_f32_bf16 v34, v143, v25, v22
    v_dot2_f32_bf16 v35, v143, v26, v22
    v_cvt_pk_bf16_f32 v140, v28, v29
    v_cvt_pk_bf16_f32 v141, v30, v31
    v_cvt_pk_bf16_f32 v142, v32, v33
    v_cvt_pk_bf16_f32 v143, v34, v35
    v_fmac_f32 v24, v28, v28
    v_fmac_f32 v27, v29, v29
    v_fmac_f32 v24, v30, v30
    v_fmac_f32 v27, v31, v31
    v_fmac_f32 v24, v32, v32
    v_fmac_f32 v27, v33, v33
    v_fmac_f32 v24, v34, v34
    v_fmac_f32 v27, v35, v35
    s_mul_i32 s56, s34, 3072
    s_lshl_b32 s57, s14, 9
    s_add_u32 s56, s56, s57
    s_add_u32 s56, s56, 786432
    s_add_u32 s57, s33, 32768
    s_mov_b32 m0, s57
    s_nop 0
    buffer_load_dwordx4 v9, s[36:39], s56 offen lds

    v_dot2_f32_bf16 v28, v144, v25, v22
    v_dot2_f32_bf16 v29, v144, v26, v22
    v_dot2_f32_bf16 v30, v145, v25, v22
    v_dot2_f32_bf16 v31, v145, v26, v22
    v_dot2_f32_bf16 v32, v146, v25, v22
    v_dot2_f32_bf16 v33, v146, v26, v22
    v_dot2_f32_bf16 v34, v147, v25, v22
    v_dot2_f32_bf16 v35, v147, v26, v22
    v_cvt_pk_bf16_f32 v144, v28, v29
    v_cvt_pk_bf16_f32 v145, v30, v31
    v_cvt_pk_bf16_f32 v146, v32, v33
    v_cvt_pk_bf16_f32 v147, v34, v35
    v_fmac_f32 v24, v28, v28
    v_fmac_f32 v27, v29, v29
    v_fmac_f32 v24, v30, v30
    v_fmac_f32 v27, v31, v31
    v_fmac_f32 v24, v32, v32
    v_fmac_f32 v27, v33, v33
    v_fmac_f32 v24, v34, v34
    v_fmac_f32 v27, v35, v35
    v_dot2_f32_bf16 v28, v148, v25, v22
    v_dot2_f32_bf16 v29, v148, v26, v22
    v_dot2_f32_bf16 v30, v149, v25, v22
    v_dot2_f32_bf16 v31, v149, v26, v22
    v_dot2_f32_bf16 v32, v150, v25, v22
    v_dot2_f32_bf16 v33, v150, v26, v22
    v_dot2_f32_bf16 v34, v151, v25, v22
    v_dot2_f32_bf16 v35, v151, v26, v22
    v_cvt_pk_bf16_f32 v148, v28, v29
    v_cvt_pk_bf16_f32 v149, v30, v31
    v_cvt_pk_bf16_f32 v150, v32, v33
    v_cvt_pk_bf16_f32 v151, v34, v35
    v_fmac_f32 v24, v28, v28
    v_fmac_f32 v27, v29, v29
    v_fmac_f32 v24, v30, v30
    v_fmac_f32 v27, v31, v31
    v_fmac_f32 v24, v32, v32
    v_fmac_f32 v27, v33, v33
    v_fmac_f32 v24, v34, v34
    v_fmac_f32 v27, v35, v35
    v_dot2_f32_bf16 v28, v152, v25, v22
    v_dot2_f32_bf16 v29, v152, v26, v22
    v_dot2_f32_bf16 v30, v153, v25, v22
    v_dot2_f32_bf16 v31, v153, v26, v22
    v_dot2_f32_bf16 v32, v154, v25, v22
    v_dot2_f32_bf16 v33, v154, v26, v22
    v_dot2_f32_bf16 v34, v155, v25, v22
    v_dot2_f32_bf16 v35, v155, v26, v22
    v_cvt_pk_bf16_f32 v152, v28, v29
    v_cvt_pk_bf16_f32 v153, v30, v31
    v_cvt_pk_bf16_f32 v154, v32, v33
    v_cvt_pk_bf16_f32 v155, v34, v35
    v_fmac_f32 v24, v28, v28
    v_fmac_f32 v27, v29, v29
    v_fmac_f32 v24, v30, v30
    v_fmac_f32 v27, v31, v31
    v_fmac_f32 v24, v32, v32
    v_fmac_f32 v27, v33, v33
    v_fmac_f32 v24, v34, v34
    v_fmac_f32 v27, v35, v35
    v_dot2_f32_bf16 v28, v156, v25, v22
    v_dot2_f32_bf16 v29, v156, v26, v22
    v_dot2_f32_bf16 v30, v157, v25, v22
    v_dot2_f32_bf16 v31, v157, v26, v22
    v_dot2_f32_bf16 v32, v158, v25, v22
    v_dot2_f32_bf16 v33, v158, v26, v22
    v_dot2_f32_bf16 v34, v159, v25, v22
    v_dot2_f32_bf16 v35, v159, v26, v22
    v_cvt_pk_bf16_f32 v156, v28, v29
    v_cvt_pk_bf16_f32 v157, v30, v31
    v_cvt_pk_bf16_f32 v158, v32, v33
    v_cvt_pk_bf16_f32 v159, v34, v35
    v_fmac_f32 v24, v28, v28
    v_fmac_f32 v27, v29, v29
    v_fmac_f32 v24, v30, v30
    v_fmac_f32 v27, v31, v31
    v_fmac_f32 v24, v32, v32
    v_fmac_f32 v27, v33, v33
    v_fmac_f32 v24, v34, v34
    v_fmac_f32 v27, v35, v35
    s_mul_i32 s56, s34, 3072
    s_lshl_b32 s57, s14, 9
    s_add_u32 s56, s56, s57
    s_add_u32 s56, s56, 798720
    s_add_u32 s57, s33, 33792
    s_mov_b32 m0, s57
    s_nop 0
    buffer_load_dwordx4 v9, s[36:39], s56 offen lds

    v_dot2_f32_bf16 v28, v160, v25, v22
    v_dot2_f32_bf16 v29, v160, v26, v22
    v_dot2_f32_bf16 v30, v161, v25, v22
    v_dot2_f32_bf16 v31, v161, v26, v22
    v_dot2_f32_bf16 v32, v162, v25, v22
    v_dot2_f32_bf16 v33, v162, v26, v22
    v_dot2_f32_bf16 v34, v163, v25, v22
    v_dot2_f32_bf16 v35, v163, v26, v22
    v_cvt_pk_bf16_f32 v160, v28, v29
    v_cvt_pk_bf16_f32 v161, v30, v31
    v_cvt_pk_bf16_f32 v162, v32, v33
    v_cvt_pk_bf16_f32 v163, v34, v35
    v_fmac_f32 v24, v28, v28
    v_fmac_f32 v27, v29, v29
    v_fmac_f32 v24, v30, v30
    v_fmac_f32 v27, v31, v31
    v_fmac_f32 v24, v32, v32
    v_fmac_f32 v27, v33, v33
    v_fmac_f32 v24, v34, v34
    v_fmac_f32 v27, v35, v35
    v_dot2_f32_bf16 v28, v164, v25, v22
    v_dot2_f32_bf16 v29, v164, v26, v22
    v_dot2_f32_bf16 v30, v165, v25, v22
    v_dot2_f32_bf16 v31, v165, v26, v22
    v_dot2_f32_bf16 v32, v166, v25, v22
    v_dot2_f32_bf16 v33, v166, v26, v22
    v_dot2_f32_bf16 v34, v167, v25, v22
    v_dot2_f32_bf16 v35, v167, v26, v22
    v_cvt_pk_bf16_f32 v164, v28, v29
    v_cvt_pk_bf16_f32 v165, v30, v31
    v_cvt_pk_bf16_f32 v166, v32, v33
    v_cvt_pk_bf16_f32 v167, v34, v35
    v_fmac_f32 v24, v28, v28
    v_fmac_f32 v27, v29, v29
    v_fmac_f32 v24, v30, v30
    v_fmac_f32 v27, v31, v31
    v_fmac_f32 v24, v32, v32
    v_fmac_f32 v27, v33, v33
    v_fmac_f32 v24, v34, v34
    v_fmac_f32 v27, v35, v35
    v_dot2_f32_bf16 v28, v168, v25, v22
    v_dot2_f32_bf16 v29, v168, v26, v22
    v_dot2_f32_bf16 v30, v169, v25, v22
    v_dot2_f32_bf16 v31, v169, v26, v22
    v_dot2_f32_bf16 v32, v170, v25, v22
    v_dot2_f32_bf16 v33, v170, v26, v22
    v_dot2_f32_bf16 v34, v171, v25, v22
    v_dot2_f32_bf16 v35, v171, v26, v22
    v_cvt_pk_bf16_f32 v168, v28, v29
    v_cvt_pk_bf16_f32 v169, v30, v31
    v_cvt_pk_bf16_f32 v170, v32, v33
    v_cvt_pk_bf16_f32 v171, v34, v35
    v_fmac_f32 v24, v28, v28
    v_fmac_f32 v27, v29, v29
    v_fmac_f32 v24, v30, v30
    v_fmac_f32 v27, v31, v31
    v_fmac_f32 v24, v32, v32
    v_fmac_f32 v27, v33, v33
    v_fmac_f32 v24, v34, v34
    v_fmac_f32 v27, v35, v35
    v_dot2_f32_bf16 v28, v172, v25, v22
    v_dot2_f32_bf16 v29, v172, v26, v22
    v_dot2_f32_bf16 v30, v173, v25, v22
    v_dot2_f32_bf16 v31, v173, v26, v22
    v_dot2_f32_bf16 v32, v174, v25, v22
    v_dot2_f32_bf16 v33, v174, v26, v22
    v_dot2_f32_bf16 v34, v175, v25, v22
    v_dot2_f32_bf16 v35, v175, v26, v22
    v_cvt_pk_bf16_f32 v172, v28, v29
    v_cvt_pk_bf16_f32 v173, v30, v31
    v_cvt_pk_bf16_f32 v174, v32, v33
    v_cvt_pk_bf16_f32 v175, v34, v35
    v_fmac_f32 v24, v28, v28
    v_fmac_f32 v27, v29, v29
    v_fmac_f32 v24, v30, v30
    v_fmac_f32 v27, v31, v31
    v_fmac_f32 v24, v32, v32
    v_fmac_f32 v27, v33, v33
    v_fmac_f32 v24, v34, v34
    v_fmac_f32 v27, v35, v35
    s_mul_i32 s56, s34, 3072
    s_lshl_b32 s57, s14, 9
    s_add_u32 s56, s56, s57
    s_add_u32 s56, s56, 811008
    s_add_u32 s57, s33, 34816
    s_mov_b32 m0, s57
    s_nop 0
    buffer_load_dwordx4 v9, s[36:39], s56 offen lds

    v_dot2_f32_bf16 v28, v176, v25, v22
    v_dot2_f32_bf16 v29, v176, v26, v22
    v_dot2_f32_bf16 v30, v177, v25, v22
    v_dot2_f32_bf16 v31, v177, v26, v22
    v_dot2_f32_bf16 v32, v178, v25, v22
    v_dot2_f32_bf16 v33, v178, v26, v22
    v_dot2_f32_bf16 v34, v179, v25, v22
    v_dot2_f32_bf16 v35, v179, v26, v22
    v_cvt_pk_bf16_f32 v176, v28, v29
    v_cvt_pk_bf16_f32 v177, v30, v31
    v_cvt_pk_bf16_f32 v178, v32, v33
    v_cvt_pk_bf16_f32 v179, v34, v35
    v_fmac_f32 v24, v28, v28
    v_fmac_f32 v27, v29, v29
    v_fmac_f32 v24, v30, v30
    v_fmac_f32 v27, v31, v31
    v_fmac_f32 v24, v32, v32
    v_fmac_f32 v27, v33, v33
    v_fmac_f32 v24, v34, v34
    v_fmac_f32 v27, v35, v35
    v_dot2_f32_bf16 v28, v180, v25, v22
    v_dot2_f32_bf16 v29, v180, v26, v22
    v_dot2_f32_bf16 v30, v181, v25, v22
    v_dot2_f32_bf16 v31, v181, v26, v22
    v_dot2_f32_bf16 v32, v182, v25, v22
    v_dot2_f32_bf16 v33, v182, v26, v22
    v_dot2_f32_bf16 v34, v183, v25, v22
    v_dot2_f32_bf16 v35, v183, v26, v22
    v_cvt_pk_bf16_f32 v180, v28, v29
    v_cvt_pk_bf16_f32 v181, v30, v31
    v_cvt_pk_bf16_f32 v182, v32, v33
    v_cvt_pk_bf16_f32 v183, v34, v35
    v_fmac_f32 v24, v28, v28
    v_fmac_f32 v27, v29, v29
    v_fmac_f32 v24, v30, v30
    v_fmac_f32 v27, v31, v31
    v_fmac_f32 v24, v32, v32
    v_fmac_f32 v27, v33, v33
    v_fmac_f32 v24, v34, v34
    v_fmac_f32 v27, v35, v35
    v_dot2_f32_bf16 v28, v184, v25, v22
    v_dot2_f32_bf16 v29, v184, v26, v22
    v_dot2_f32_bf16 v30, v185, v25, v22
    v_dot2_f32_bf16 v31, v185, v26, v22
    v_dot2_f32_bf16 v32, v186, v25, v22
    v_dot2_f32_bf16 v33, v186, v26, v22
    v_dot2_f32_bf16 v34, v187, v25, v22
    v_dot2_f32_bf16 v35, v187, v26, v22
    v_cvt_pk_bf16_f32 v184, v28, v29
    v_cvt_pk_bf16_f32 v185, v30, v31
    v_cvt_pk_bf16_f32 v186, v32, v33
    v_cvt_pk_bf16_f32 v187, v34, v35
    v_fmac_f32 v24, v28, v28
    v_fmac_f32 v27, v29, v29
    v_fmac_f32 v24, v30, v30
    v_fmac_f32 v27, v31, v31
    v_fmac_f32 v24, v32, v32
    v_fmac_f32 v27, v33, v33
    v_fmac_f32 v24, v34, v34
    v_fmac_f32 v27, v35, v35
    v_dot2_f32_bf16 v28, v188, v25, v22
    v_dot2_f32_bf16 v29, v188, v26, v22
    v_dot2_f32_bf16 v30, v189, v25, v22
    v_dot2_f32_bf16 v31, v189, v26, v22
    v_dot2_f32_bf16 v32, v190, v25, v22
    v_dot2_f32_bf16 v33, v190, v26, v22
    v_dot2_f32_bf16 v34, v191, v25, v22
    v_dot2_f32_bf16 v35, v191, v26, v22
    v_cvt_pk_bf16_f32 v188, v28, v29
    v_cvt_pk_bf16_f32 v189, v30, v31
    v_cvt_pk_bf16_f32 v190, v32, v33
    v_cvt_pk_bf16_f32 v191, v34, v35
    v_fmac_f32 v24, v28, v28
    v_fmac_f32 v27, v29, v29
    v_fmac_f32 v24, v30, v30
    v_fmac_f32 v27, v31, v31
    v_fmac_f32 v24, v32, v32
    v_fmac_f32 v27, v33, v33
    v_fmac_f32 v24, v34, v34
    v_fmac_f32 v27, v35, v35
    s_mul_i32 s56, s34, 3072
    s_lshl_b32 s57, s14, 9
    s_add_u32 s56, s56, s57
    s_add_u32 s56, s56, 823296
    s_add_u32 s57, s33, 35840
    s_mov_b32 m0, s57
    s_nop 0
    buffer_load_dwordx4 v9, s[36:39], s56 offen lds

    v_dot2_f32_bf16 v28, v192, v25, v22
    v_dot2_f32_bf16 v29, v192, v26, v22
    v_dot2_f32_bf16 v30, v193, v25, v22
    v_dot2_f32_bf16 v31, v193, v26, v22
    v_dot2_f32_bf16 v32, v194, v25, v22
    v_dot2_f32_bf16 v33, v194, v26, v22
    v_dot2_f32_bf16 v34, v195, v25, v22
    v_dot2_f32_bf16 v35, v195, v26, v22
    v_cvt_pk_bf16_f32 v192, v28, v29
    v_cvt_pk_bf16_f32 v193, v30, v31
    v_cvt_pk_bf16_f32 v194, v32, v33
    v_cvt_pk_bf16_f32 v195, v34, v35
    v_fmac_f32 v24, v28, v28
    v_fmac_f32 v27, v29, v29
    v_fmac_f32 v24, v30, v30
    v_fmac_f32 v27, v31, v31
    v_fmac_f32 v24, v32, v32
    v_fmac_f32 v27, v33, v33
    v_fmac_f32 v24, v34, v34
    v_fmac_f32 v27, v35, v35
    v_dot2_f32_bf16 v28, v196, v25, v22
    v_dot2_f32_bf16 v29, v196, v26, v22
    v_dot2_f32_bf16 v30, v197, v25, v22
    v_dot2_f32_bf16 v31, v197, v26, v22
    v_dot2_f32_bf16 v32, v198, v25, v22
    v_dot2_f32_bf16 v33, v198, v26, v22
    v_dot2_f32_bf16 v34, v199, v25, v22
    v_dot2_f32_bf16 v35, v199, v26, v22
    v_cvt_pk_bf16_f32 v196, v28, v29
    v_cvt_pk_bf16_f32 v197, v30, v31
    v_cvt_pk_bf16_f32 v198, v32, v33
    v_cvt_pk_bf16_f32 v199, v34, v35
    v_fmac_f32 v24, v28, v28
    v_fmac_f32 v27, v29, v29
    v_fmac_f32 v24, v30, v30
    v_fmac_f32 v27, v31, v31
    v_fmac_f32 v24, v32, v32
    v_fmac_f32 v27, v33, v33
    v_fmac_f32 v24, v34, v34
    v_fmac_f32 v27, v35, v35
    v_dot2_f32_bf16 v28, v200, v25, v22
    v_dot2_f32_bf16 v29, v200, v26, v22
    v_dot2_f32_bf16 v30, v201, v25, v22
    v_dot2_f32_bf16 v31, v201, v26, v22
    v_dot2_f32_bf16 v32, v202, v25, v22
    v_dot2_f32_bf16 v33, v202, v26, v22
    v_dot2_f32_bf16 v34, v203, v25, v22
    v_dot2_f32_bf16 v35, v203, v26, v22
    v_cvt_pk_bf16_f32 v200, v28, v29
    v_cvt_pk_bf16_f32 v201, v30, v31
    v_cvt_pk_bf16_f32 v202, v32, v33
    v_cvt_pk_bf16_f32 v203, v34, v35
    v_fmac_f32 v24, v28, v28
    v_fmac_f32 v27, v29, v29
    v_fmac_f32 v24, v30, v30
    v_fmac_f32 v27, v31, v31
    v_fmac_f32 v24, v32, v32
    v_fmac_f32 v27, v33, v33
    v_fmac_f32 v24, v34, v34
    v_fmac_f32 v27, v35, v35
    v_dot2_f32_bf16 v28, v204, v25, v22
    v_dot2_f32_bf16 v29, v204, v26, v22
    v_dot2_f32_bf16 v30, v205, v25, v22
    v_dot2_f32_bf16 v31, v205, v26, v22
    v_dot2_f32_bf16 v32, v206, v25, v22
    v_dot2_f32_bf16 v33, v206, v26, v22
    v_dot2_f32_bf16 v34, v207, v25, v22
    v_dot2_f32_bf16 v35, v207, v26, v22
    v_cvt_pk_bf16_f32 v204, v28, v29
    v_cvt_pk_bf16_f32 v205, v30, v31
    v_cvt_pk_bf16_f32 v206, v32, v33
    v_cvt_pk_bf16_f32 v207, v34, v35
    v_fmac_f32 v24, v28, v28
    v_fmac_f32 v27, v29, v29
    v_fmac_f32 v24, v30, v30
    v_fmac_f32 v27, v31, v31
    v_fmac_f32 v24, v32, v32
    v_fmac_f32 v27, v33, v33
    v_fmac_f32 v24, v34, v34
    v_fmac_f32 v27, v35, v35
    s_mul_i32 s56, s34, 3072
    s_lshl_b32 s57, s14, 9
    s_add_u32 s56, s56, s57
    s_add_u32 s56, s56, 1179648
    s_add_u32 s57, s33, 65536
    s_mov_b32 m0, s57
    s_nop 0
    buffer_load_dwordx4 v9, s[36:39], s56 offen lds

    v_dot2_f32_bf16 v28, v208, v25, v22
    v_dot2_f32_bf16 v29, v208, v26, v22
    v_dot2_f32_bf16 v30, v209, v25, v22
    v_dot2_f32_bf16 v31, v209, v26, v22
    v_dot2_f32_bf16 v32, v210, v25, v22
    v_dot2_f32_bf16 v33, v210, v26, v22
    v_dot2_f32_bf16 v34, v211, v25, v22
    v_dot2_f32_bf16 v35, v211, v26, v22
    v_cvt_pk_bf16_f32 v208, v28, v29
    v_cvt_pk_bf16_f32 v209, v30, v31
    v_cvt_pk_bf16_f32 v210, v32, v33
    v_cvt_pk_bf16_f32 v211, v34, v35
    v_fmac_f32 v24, v28, v28
    v_fmac_f32 v27, v29, v29
    v_fmac_f32 v24, v30, v30
    v_fmac_f32 v27, v31, v31
    v_fmac_f32 v24, v32, v32
    v_fmac_f32 v27, v33, v33
    v_fmac_f32 v24, v34, v34
    v_fmac_f32 v27, v35, v35
    v_dot2_f32_bf16 v28, v212, v25, v22
    v_dot2_f32_bf16 v29, v212, v26, v22
    v_dot2_f32_bf16 v30, v213, v25, v22
    v_dot2_f32_bf16 v31, v213, v26, v22
    v_dot2_f32_bf16 v32, v214, v25, v22
    v_dot2_f32_bf16 v33, v214, v26, v22
    v_dot2_f32_bf16 v34, v215, v25, v22
    v_dot2_f32_bf16 v35, v215, v26, v22
    v_cvt_pk_bf16_f32 v212, v28, v29
    v_cvt_pk_bf16_f32 v213, v30, v31
    v_cvt_pk_bf16_f32 v214, v32, v33
    v_cvt_pk_bf16_f32 v215, v34, v35
    v_fmac_f32 v24, v28, v28
    v_fmac_f32 v27, v29, v29
    v_fmac_f32 v24, v30, v30
    v_fmac_f32 v27, v31, v31
    v_fmac_f32 v24, v32, v32
    v_fmac_f32 v27, v33, v33
    v_fmac_f32 v24, v34, v34
    v_fmac_f32 v27, v35, v35
    v_dot2_f32_bf16 v28, v216, v25, v22
    v_dot2_f32_bf16 v29, v216, v26, v22
    v_dot2_f32_bf16 v30, v217, v25, v22
    v_dot2_f32_bf16 v31, v217, v26, v22
    v_dot2_f32_bf16 v32, v218, v25, v22
    v_dot2_f32_bf16 v33, v218, v26, v22
    v_dot2_f32_bf16 v34, v219, v25, v22
    v_dot2_f32_bf16 v35, v219, v26, v22
    v_cvt_pk_bf16_f32 v216, v28, v29
    v_cvt_pk_bf16_f32 v217, v30, v31
    v_cvt_pk_bf16_f32 v218, v32, v33
    v_cvt_pk_bf16_f32 v219, v34, v35
    v_fmac_f32 v24, v28, v28
    v_fmac_f32 v27, v29, v29
    v_fmac_f32 v24, v30, v30
    v_fmac_f32 v27, v31, v31
    v_fmac_f32 v24, v32, v32
    v_fmac_f32 v27, v33, v33
    v_fmac_f32 v24, v34, v34
    v_fmac_f32 v27, v35, v35
    v_dot2_f32_bf16 v28, v220, v25, v22
    v_dot2_f32_bf16 v29, v220, v26, v22
    v_dot2_f32_bf16 v30, v221, v25, v22
    v_dot2_f32_bf16 v31, v221, v26, v22
    v_dot2_f32_bf16 v32, v222, v25, v22
    v_dot2_f32_bf16 v33, v222, v26, v22
    v_dot2_f32_bf16 v34, v223, v25, v22
    v_dot2_f32_bf16 v35, v223, v26, v22
    v_cvt_pk_bf16_f32 v220, v28, v29
    v_cvt_pk_bf16_f32 v221, v30, v31
    v_cvt_pk_bf16_f32 v222, v32, v33
    v_cvt_pk_bf16_f32 v223, v34, v35
    v_fmac_f32 v24, v28, v28
    v_fmac_f32 v27, v29, v29
    v_fmac_f32 v24, v30, v30
    v_fmac_f32 v27, v31, v31
    v_fmac_f32 v24, v32, v32
    v_fmac_f32 v27, v33, v33
    v_fmac_f32 v24, v34, v34
    v_fmac_f32 v27, v35, v35
    s_mul_i32 s56, s34, 3072
    s_lshl_b32 s57, s14, 9
    s_add_u32 s56, s56, s57
    s_add_u32 s56, s56, 1191936
    s_add_u32 s57, s33, 66560
    s_mov_b32 m0, s57
    s_nop 0
    buffer_load_dwordx4 v9, s[36:39], s56 offen lds

    v_dot2_f32_bf16 v28, v224, v25, v22
    v_dot2_f32_bf16 v29, v224, v26, v22
    v_dot2_f32_bf16 v30, v225, v25, v22
    v_dot2_f32_bf16 v31, v225, v26, v22
    v_dot2_f32_bf16 v32, v226, v25, v22
    v_dot2_f32_bf16 v33, v226, v26, v22
    v_dot2_f32_bf16 v34, v227, v25, v22
    v_dot2_f32_bf16 v35, v227, v26, v22
    v_cvt_pk_bf16_f32 v224, v28, v29
    v_cvt_pk_bf16_f32 v225, v30, v31
    v_cvt_pk_bf16_f32 v226, v32, v33
    v_cvt_pk_bf16_f32 v227, v34, v35
    v_fmac_f32 v24, v28, v28
    v_fmac_f32 v27, v29, v29
    v_fmac_f32 v24, v30, v30
    v_fmac_f32 v27, v31, v31
    v_fmac_f32 v24, v32, v32
    v_fmac_f32 v27, v33, v33
    v_fmac_f32 v24, v34, v34
    v_fmac_f32 v27, v35, v35
    v_dot2_f32_bf16 v28, v228, v25, v22
    v_dot2_f32_bf16 v29, v228, v26, v22
    v_dot2_f32_bf16 v30, v229, v25, v22
    v_dot2_f32_bf16 v31, v229, v26, v22
    v_dot2_f32_bf16 v32, v230, v25, v22
    v_dot2_f32_bf16 v33, v230, v26, v22
    v_dot2_f32_bf16 v34, v231, v25, v22
    v_dot2_f32_bf16 v35, v231, v26, v22
    v_cvt_pk_bf16_f32 v228, v28, v29
    v_cvt_pk_bf16_f32 v229, v30, v31
    v_cvt_pk_bf16_f32 v230, v32, v33
    v_cvt_pk_bf16_f32 v231, v34, v35
    v_fmac_f32 v24, v28, v28
    v_fmac_f32 v27, v29, v29
    v_fmac_f32 v24, v30, v30
    v_fmac_f32 v27, v31, v31
    v_fmac_f32 v24, v32, v32
    v_fmac_f32 v27, v33, v33
    v_fmac_f32 v24, v34, v34
    v_fmac_f32 v27, v35, v35
    v_dot2_f32_bf16 v28, v232, v25, v22
    v_dot2_f32_bf16 v29, v232, v26, v22
    v_dot2_f32_bf16 v30, v233, v25, v22
    v_dot2_f32_bf16 v31, v233, v26, v22
    v_dot2_f32_bf16 v32, v234, v25, v22
    v_dot2_f32_bf16 v33, v234, v26, v22
    v_dot2_f32_bf16 v34, v235, v25, v22
    v_dot2_f32_bf16 v35, v235, v26, v22
    v_cvt_pk_bf16_f32 v232, v28, v29
    v_cvt_pk_bf16_f32 v233, v30, v31
    v_cvt_pk_bf16_f32 v234, v32, v33
    v_cvt_pk_bf16_f32 v235, v34, v35
    v_fmac_f32 v24, v28, v28
    v_fmac_f32 v27, v29, v29
    v_fmac_f32 v24, v30, v30
    v_fmac_f32 v27, v31, v31
    v_fmac_f32 v24, v32, v32
    v_fmac_f32 v27, v33, v33
    v_fmac_f32 v24, v34, v34
    v_fmac_f32 v27, v35, v35
    v_dot2_f32_bf16 v28, v236, v25, v22
    v_dot2_f32_bf16 v29, v236, v26, v22
    v_dot2_f32_bf16 v30, v237, v25, v22
    v_dot2_f32_bf16 v31, v237, v26, v22
    v_dot2_f32_bf16 v32, v238, v25, v22
    v_dot2_f32_bf16 v33, v238, v26, v22
    v_dot2_f32_bf16 v34, v239, v25, v22
    v_dot2_f32_bf16 v35, v239, v26, v22
    v_cvt_pk_bf16_f32 v236, v28, v29
    v_cvt_pk_bf16_f32 v237, v30, v31
    v_cvt_pk_bf16_f32 v238, v32, v33
    v_cvt_pk_bf16_f32 v239, v34, v35
    v_fmac_f32 v24, v28, v28
    v_fmac_f32 v27, v29, v29
    v_fmac_f32 v24, v30, v30
    v_fmac_f32 v27, v31, v31
    v_fmac_f32 v24, v32, v32
    v_fmac_f32 v27, v33, v33
    v_fmac_f32 v24, v34, v34
    v_fmac_f32 v27, v35, v35
    s_mul_i32 s56, s34, 3072
    s_lshl_b32 s57, s14, 9
    s_add_u32 s56, s56, s57
    s_add_u32 s56, s56, 1204224
    s_add_u32 s57, s33, 67584
    s_mov_b32 m0, s57
    s_nop 0
    buffer_load_dwordx4 v9, s[36:39], s56 offen lds

    v_dot2_f32_bf16 v28, v240, v25, v22
    v_dot2_f32_bf16 v29, v240, v26, v22
    v_dot2_f32_bf16 v30, v241, v25, v22
    v_dot2_f32_bf16 v31, v241, v26, v22
    v_dot2_f32_bf16 v32, v242, v25, v22
    v_dot2_f32_bf16 v33, v242, v26, v22
    v_dot2_f32_bf16 v34, v243, v25, v22
    v_dot2_f32_bf16 v35, v243, v26, v22
    v_cvt_pk_bf16_f32 v240, v28, v29
    v_cvt_pk_bf16_f32 v241, v30, v31
    v_cvt_pk_bf16_f32 v242, v32, v33
    v_cvt_pk_bf16_f32 v243, v34, v35
    v_fmac_f32 v24, v28, v28
    v_fmac_f32 v27, v29, v29
    v_fmac_f32 v24, v30, v30
    v_fmac_f32 v27, v31, v31
    v_fmac_f32 v24, v32, v32
    v_fmac_f32 v27, v33, v33
    v_fmac_f32 v24, v34, v34
    v_fmac_f32 v27, v35, v35
    v_dot2_f32_bf16 v28, v244, v25, v22
    v_dot2_f32_bf16 v29, v244, v26, v22
    v_dot2_f32_bf16 v30, v245, v25, v22
    v_dot2_f32_bf16 v31, v245, v26, v22
    v_dot2_f32_bf16 v32, v246, v25, v22
    v_dot2_f32_bf16 v33, v246, v26, v22
    v_dot2_f32_bf16 v34, v247, v25, v22
    v_dot2_f32_bf16 v35, v247, v26, v22
    v_cvt_pk_bf16_f32 v244, v28, v29
    v_cvt_pk_bf16_f32 v245, v30, v31
    v_cvt_pk_bf16_f32 v246, v32, v33
    v_cvt_pk_bf16_f32 v247, v34, v35
    v_fmac_f32 v24, v28, v28
    v_fmac_f32 v27, v29, v29
    v_fmac_f32 v24, v30, v30
    v_fmac_f32 v27, v31, v31
    v_fmac_f32 v24, v32, v32
    v_fmac_f32 v27, v33, v33
    v_fmac_f32 v24, v34, v34
    v_fmac_f32 v27, v35, v35
    v_dot2_f32_bf16 v28, v248, v25, v22
    v_dot2_f32_bf16 v29, v248, v26, v22
    v_dot2_f32_bf16 v30, v249, v25, v22
    v_dot2_f32_bf16 v31, v249, v26, v22
    v_dot2_f32_bf16 v32, v250, v25, v22
    v_dot2_f32_bf16 v33, v250, v26, v22
    v_dot2_f32_bf16 v34, v251, v25, v22
    v_dot2_f32_bf16 v35, v251, v26, v22
    v_cvt_pk_bf16_f32 v248, v28, v29
    v_cvt_pk_bf16_f32 v249, v30, v31
    v_cvt_pk_bf16_f32 v250, v32, v33
    v_cvt_pk_bf16_f32 v251, v34, v35
    v_fmac_f32 v24, v28, v28
    v_fmac_f32 v27, v29, v29
    v_fmac_f32 v24, v30, v30
    v_fmac_f32 v27, v31, v31
    v_fmac_f32 v24, v32, v32
    v_fmac_f32 v27, v33, v33
    v_fmac_f32 v24, v34, v34
    v_fmac_f32 v27, v35, v35
    v_dot2_f32_bf16 v28, v252, v25, v22
    v_dot2_f32_bf16 v29, v252, v26, v22
    v_dot2_f32_bf16 v30, v253, v25, v22
    v_dot2_f32_bf16 v31, v253, v26, v22
    v_dot2_f32_bf16 v32, v254, v25, v22
    v_dot2_f32_bf16 v33, v254, v26, v22
    v_dot2_f32_bf16 v34, v255, v25, v22
    v_dot2_f32_bf16 v35, v255, v26, v22
    v_cvt_pk_bf16_f32 v252, v28, v29
    v_cvt_pk_bf16_f32 v253, v30, v31
    v_cvt_pk_bf16_f32 v254, v32, v33
    v_cvt_pk_bf16_f32 v255, v34, v35
    v_fmac_f32 v24, v28, v28
    v_fmac_f32 v27, v29, v29
    v_fmac_f32 v24, v30, v30
    v_fmac_f32 v27, v31, v31
    v_fmac_f32 v24, v32, v32
    v_fmac_f32 v27, v33, v33
    v_fmac_f32 v24, v34, v34
    v_fmac_f32 v27, v35, v35
    s_mul_i32 s56, s34, 3072
    s_lshl_b32 s57, s14, 9
    s_add_u32 s56, s56, s57
    s_add_u32 s56, s56, 1216512
    s_add_u32 s57, s33, 68608
    s_mov_b32 m0, s57
    s_nop 0
    buffer_load_dwordx4 v9, s[36:39], s56 offen lds

    s_mul_i32 s30, s3, 176128
    s_lshl_b32 s31, s14, 5
    s_add_u32 s30, s30, s31
    s_add_u32 s30, s30, 2560

    s_add_u32 s31, s33, 98304
    s_mov_b32 m0, s31
    v_add_co_u32 v14, vcc, s30, v12
    s_add_u32 s30, s30, 44032
    s_nop 0
    v_addc_co_u32 v15, vcc, 0, v13, vcc
    global_load_lds_dwordx4 v[14:15], off

    s_add_u32 s31, s33, 99328
    s_mov_b32 m0, s31
    v_add_co_u32 v14, vcc, s30, v12
    s_add_u32 s30, s30, 44032
    s_nop 0
    v_addc_co_u32 v15, vcc, 0, v13, vcc
    global_load_lds_dwordx4 v[14:15], off

    s_add_u32 s31, s33, 100352
    s_mov_b32 m0, s31
    v_add_co_u32 v14, vcc, s30, v12
    s_add_u32 s30, s30, 44032
    s_nop 0
    v_addc_co_u32 v15, vcc, 0, v13, vcc
    global_load_lds_dwordx4 v[14:15], off

    s_add_u32 s31, s33, 101376
    s_mov_b32 m0, s31
    v_add_co_u32 v14, vcc, s30, v12
    s_add_u32 s30, s30, 44032
    s_nop 0
    v_addc_co_u32 v15, vcc, 0, v13, vcc
    global_load_lds_dwordx4 v[14:15], off

    s_nop 3
    v_add_f32 v24, v24, v27
    v_mov_b32 v27, v24
    s_nop 1
    v_permlane32_swap_b32 v24, v27
    s_nop 1
    v_add_f32 v24, v24, v27
    v_mul_f32 v24, 0x3b000000, v24
    v_fma_f32 v24, -v23, v23, v24
    v_max_f32 v24, 0, v24
    v_cvt_pk_bf16_f32 v24, v24, v24
    v_and_b32 v24, 0xffff0000, v24
    v_add_f32 v24, 0x3727c5ac, v24
    v_cvt_pk_bf16_f32 v24, v24, v24
    v_and_b32 v24, 0xffff0000, v24
    v_sqrt_f32 v24, v24
    s_nop 0
    v_cvt_pk_bf16_f32 v24, v24, v24
    v_and_b32 v24, 0xffff0000, v24
    v_rcp_f32 v24, v24

    s_nop 1
    v_lshlrev_b32 v25, 4, v4
    v_add_u32 v25, 0, v25
    ds_bpermute_b32 v96, v25, v24
    v_lshlrev_b32 v25, 4, v4
    v_add_u32 v25, 4, v25
    ds_bpermute_b32 v97, v25, v24
    v_lshlrev_b32 v25, 4, v4
    v_add_u32 v25, 8, v25
    ds_bpermute_b32 v98, v25, v24
    v_lshlrev_b32 v25, 4, v4
    v_add_u32 v25, 12, v25
    ds_bpermute_b32 v99, v25, v24
    v_lshlrev_b32 v25, 4, v4
    v_add_u32 v25, 32, v25
    ds_bpermute_b32 v100, v25, v24
    v_lshlrev_b32 v25, 4, v4
    v_add_u32 v25, 36, v25
    ds_bpermute_b32 v101, v25, v24
    v_lshlrev_b32 v25, 4, v4
    v_add_u32 v25, 40, v25
    ds_bpermute_b32 v102, v25, v24
    v_lshlrev_b32 v25, 4, v4
    v_add_u32 v25, 44, v25
    ds_bpermute_b32 v103, v25, v24
    v_lshlrev_b32 v25, 4, v4
    v_add_u32 v25, 64, v25
    ds_bpermute_b32 v104, v25, v24
    v_lshlrev_b32 v25, 4, v4
    v_add_u32 v25, 68, v25
    ds_bpermute_b32 v105, v25, v24
    v_lshlrev_b32 v25, 4, v4
    v_add_u32 v25, 72, v25
    ds_bpermute_b32 v106, v25, v24
    v_lshlrev_b32 v25, 4, v4
    v_add_u32 v25, 76, v25
    ds_bpermute_b32 v107, v25, v24
    v_lshlrev_b32 v25, 4, v4
    v_add_u32 v25, 96, v25
    ds_bpermute_b32 v108, v25, v24
    v_lshlrev_b32 v25, 4, v4
    v_add_u32 v25, 100, v25
    ds_bpermute_b32 v109, v25, v24
    v_lshlrev_b32 v25, 4, v4
    v_add_u32 v25, 104, v25
    ds_bpermute_b32 v110, v25, v24
    v_lshlrev_b32 v25, 4, v4
    v_add_u32 v25, 108, v25
    ds_bpermute_b32 v111, v25, v24
    v_lshlrev_b32 v26, 3, v4
    v_and_b32 v27, 15, v2
    v_lshrrev_b32 v27, 2, v27
    v_add_u32 v26, v26, v27
    v_and_b32 v27, 3, v27
    v_lshrrev_b32 v28, 4, v2
    v_and_b32 v28, 1, v28
    v_and_b32 v29, 3, v2
    v_lshlrev_b32 v29, 3, v29
    v_lshl_add_u32 v29, v26, 8, v29
    s_lshl_b32 s43, s41, 1

    s_add_u32 s30, s43, 0
    v_xor_b32 v30, s30, v27
    v_lshl_add_u32 v30, v30, 6, v29
    v_lshl_add_u32 v16, v28, 5, v30

    s_add_u32 s30, s43, 1
    v_xor_b32 v30, s30, v27
    v_lshl_add_u32 v30, v30, 6, v29
    v_lshl_add_u32 v17, v28, 5, v30

    v_lshlrev_b32 v20, 6, v26
    v_lshl_add_u32 v20, v28, 5, v20
    v_and_b32 v30, 3, v2
    v_lshl_add_u32 v20, v30, 3, v20
    v_lshlrev_b32 v22, 5, v5
    v_lshl_add_u32 v22, v4, 4, v22
    v_add_u32 v36, 98304, v20

    v_lshlrev_b32 v21, 4, v2
    s_lshl_b32 s30, s26, 10
    v_add_u32 v21, s30, v21

    v_lshlrev_b32 v6, 13, v4
    v_lshl_add_u32 v6, v3, 1, v6
    v_add_u32 v6, s35, v6
    s_cmp_ge_u32 s52, 1888
    s_cbranch_scc1 K1v_wtd
    s_cmp_ge_u32 s53, 32
    s_cbranch_scc1 K1v_wtb
    s_lshl_b32 s54, s53, 14
    s_add_u32 s27, s54, 4096

    buffer_load_ushort v26, v6, s[44:47], s54 offen offset:0
    buffer_load_ushort v27, v6, s[44:47], s54 offen offset:1024
    buffer_load_ushort v28, v6, s[44:47], s54 offen offset:2048
    buffer_load_ushort v29, v6, s[44:47], s54 offen offset:3072
    buffer_load_ushort v30, v6, s[44:47], s27 offen offset:0
    buffer_load_ushort v31, v6, s[44:47], s27 offen offset:1024
    buffer_load_ushort v32, v6, s[44:47], s27 offen offset:2048
    buffer_load_ushort v33, v6, s[44:47], s27 offen offset:3072
    s_branch K1v_wtd
K1v_wtb:
    s_sub_u32 s54, s53, 32
    s_lshl_b32 s54, s54, 14
    s_add_u32 s27, s54, 4096

    buffer_load_ushort v26, v6, s[48:51], s54 offen offset:0
    buffer_load_ushort v27, v6, s[48:51], s54 offen offset:1024
    buffer_load_ushort v28, v6, s[48:51], s54 offen offset:2048
    buffer_load_ushort v29, v6, s[48:51], s54 offen offset:3072
    buffer_load_ushort v30, v6, s[48:51], s27 offen offset:0
    buffer_load_ushort v31, v6, s[48:51], s27 offen offset:1024
    buffer_load_ushort v32, v6, s[48:51], s27 offen offset:2048
    buffer_load_ushort v33, v6, s[48:51], s27 offen offset:3072
K1v_wtd:
    s_waitcnt vmcnt(16)
    s_waitcnt lgkmcnt(0)
    s_barrier
    v_add_u32 v34, 131072, v16
    v_add_u32 v35, 131072, v17
    ds_read_b64_tr_b16 v[40:41], v34 offset:0
    ds_read_b64_tr_b16 v[42:43], v34 offset:1024
    ds_read_b64_tr_b16 v[44:45], v35 offset:0
    ds_read_b64_tr_b16 v[46:47], v35 offset:1024
    ds_read_b64_tr_b16 v[48:49], v34 offset:4096
    ds_read_b64_tr_b16 v[50:51], v34 offset:5120
    ds_read_b64_tr_b16 v[52:53], v35 offset:4096
    ds_read_b64_tr_b16 v[54:55], v35 offset:5120
    ds_read_b64_tr_b16 v[56:57], v34 offset:8192
    ds_read_b64_tr_b16 v[58:59], v34 offset:9216
    ds_read_b64_tr_b16 v[60:61], v35 offset:8192
    ds_read_b64_tr_b16 v[62:63], v35 offset:9216
    s_waitcnt lgkmcnt(10)
    v_mfma_f32_32x32x16_bf16 v[64:79], v[128:131], v[40:43], 0
    ds_read_b64_tr_b16 v[40:41], v34 offset:12288
    ds_read_b64_tr_b16 v[42:43], v34 offset:13312
    s_waitcnt lgkmcnt(10)
    v_mfma_f32_32x32x16_bf16 v[80:95], v[128:131], v[44:47], 0
    ds_read_b64_tr_b16 v[44:45], v35 offset:12288
    ds_read_b64_tr_b16 v[46:47], v35 offset:13312
    s_waitcnt lgkmcnt(10)
    v_mfma_f32_32x32x16_bf16 v[64:79], v[132:135], v[48:51], v[64:79]
    ds_read_b64_tr_b16 v[48:49], v34 offset:16384
    ds_read_b64_tr_b16 v[50:51], v34 offset:17408
    s_waitcnt lgkmcnt(10)
    v_mfma_f32_32x32x16_bf16 v[80:95], v[132:135], v[52:55], v[80:95]
    ds_read_b64_tr_b16 v[52:53], v35 offset:16384
    ds_read_b64_tr_b16 v[54:55], v35 offset:17408
    s_waitcnt lgkmcnt(10)
    v_mfma_f32_32x32x16_bf16 v[64:79], v[136:139], v[56:59], v[64:79]
    ds_read_b64_tr_b16 v[56:57], v34 offset:20480
    ds_read_b64_tr_b16 v[58:59], v34 offset:21504
    s_waitcnt lgkmcnt(10)
    v_mfma_f32_32x32x16_bf16 v[80:95], v[136:139], v[60:63], v[80:95]
    ds_read_b64_tr_b16 v[60:61], v35 offset:20480
    ds_read_b64_tr_b16 v[62:63], v35 offset:21504
    s_waitcnt lgkmcnt(10)
    v_mfma_f32_32x32x16_bf16 v[64:79], v[140:143], v[40:43], v[64:79]
    ds_read_b64_tr_b16 v[40:41], v34 offset:24576
    ds_read_b64_tr_b16 v[42:43], v34 offset:25600
    s_waitcnt lgkmcnt(10)
    v_mfma_f32_32x32x16_bf16 v[80:95], v[140:143], v[44:47], v[80:95]
    ds_read_b64_tr_b16 v[44:45], v35 offset:24576
    ds_read_b64_tr_b16 v[46:47], v35 offset:25600
    s_waitcnt lgkmcnt(10)
    v_mfma_f32_32x32x16_bf16 v[64:79], v[144:147], v[48:51], v[64:79]
    ds_read_b64_tr_b16 v[48:49], v34 offset:28672
    ds_read_b64_tr_b16 v[50:51], v34 offset:29696
    s_waitcnt lgkmcnt(10)
    v_mfma_f32_32x32x16_bf16 v[80:95], v[144:147], v[52:55], v[80:95]
    ds_read_b64_tr_b16 v[52:53], v35 offset:28672
    ds_read_b64_tr_b16 v[54:55], v35 offset:29696
    s_waitcnt lgkmcnt(10)
    v_mfma_f32_32x32x16_bf16 v[64:79], v[148:151], v[56:59], v[64:79]
    s_waitcnt lgkmcnt(8)
    v_mfma_f32_32x32x16_bf16 v[80:95], v[148:151], v[60:63], v[80:95]
    s_waitcnt lgkmcnt(6)
    v_mfma_f32_32x32x16_bf16 v[64:79], v[152:155], v[40:43], v[64:79]
    s_waitcnt lgkmcnt(4)
    v_mfma_f32_32x32x16_bf16 v[80:95], v[152:155], v[44:47], v[80:95]
    s_waitcnt lgkmcnt(2)
    v_mfma_f32_32x32x16_bf16 v[64:79], v[156:159], v[48:51], v[64:79]
    s_waitcnt lgkmcnt(0)
    v_mfma_f32_32x32x16_bf16 v[80:95], v[156:159], v[52:55], v[80:95]
    s_waitcnt vmcnt(12)
    s_waitcnt lgkmcnt(0)
    s_barrier
    v_add_u32 v34, 0, v16
    v_add_u32 v35, 0, v17
    ds_read_b64_tr_b16 v[40:41], v34 offset:0
    ds_read_b64_tr_b16 v[42:43], v34 offset:1024
    ds_read_b64_tr_b16 v[44:45], v35 offset:0
    ds_read_b64_tr_b16 v[46:47], v35 offset:1024
    ds_read_b64_tr_b16 v[48:49], v34 offset:4096
    ds_read_b64_tr_b16 v[50:51], v34 offset:5120
    ds_read_b64_tr_b16 v[52:53], v35 offset:4096
    ds_read_b64_tr_b16 v[54:55], v35 offset:5120
    ds_read_b64_tr_b16 v[56:57], v34 offset:8192
    ds_read_b64_tr_b16 v[58:59], v34 offset:9216
    ds_read_b64_tr_b16 v[60:61], v35 offset:8192
    ds_read_b64_tr_b16 v[62:63], v35 offset:9216
    s_waitcnt lgkmcnt(10)
    v_mfma_f32_32x32x16_bf16 v[64:79], v[160:163], v[40:43], v[64:79]
    ds_read_b64_tr_b16 v[40:41], v34 offset:12288
    ds_read_b64_tr_b16 v[42:43], v34 offset:13312
    s_waitcnt lgkmcnt(10)
    v_mfma_f32_32x32x16_bf16 v[80:95], v[160:163], v[44:47], v[80:95]
    s_mul_i32 s56, s34, 3072
    s_lshl_b32 s57, s14, 9
    s_add_u32 s56, s56, s57
    s_add_u32 s56, s56, 256
    s_add_u32 s57, s33, 131072
    s_mov_b32 m0, s57
    s_nop 0
    buffer_load_dwordx4 v9, s[36:39], s56 offen lds

    ds_read_b64_tr_b16 v[44:45], v35 offset:12288
    ds_read_b64_tr_b16 v[46:47], v35 offset:13312
    s_waitcnt lgkmcnt(10)
    v_mfma_f32_32x32x16_bf16 v[64:79], v[164:167], v[48:51], v[64:79]
    ds_read_b64_tr_b16 v[48:49], v34 offset:16384
    ds_read_b64_tr_b16 v[50:51], v34 offset:17408
    s_waitcnt lgkmcnt(10)
    v_mfma_f32_32x32x16_bf16 v[80:95], v[164:167], v[52:55], v[80:95]
    ds_read_b64_tr_b16 v[52:53], v35 offset:16384
    ds_read_b64_tr_b16 v[54:55], v35 offset:17408
    s_waitcnt lgkmcnt(10)
    v_mfma_f32_32x32x16_bf16 v[64:79], v[168:171], v[56:59], v[64:79]
    ds_read_b64_tr_b16 v[56:57], v34 offset:20480
    ds_read_b64_tr_b16 v[58:59], v34 offset:21504
    s_waitcnt lgkmcnt(10)
    v_mfma_f32_32x32x16_bf16 v[80:95], v[168:171], v[60:63], v[80:95]
    s_mul_i32 s56, s34, 3072
    s_lshl_b32 s57, s14, 9
    s_add_u32 s56, s56, s57
    s_add_u32 s56, s56, 12544
    s_add_u32 s57, s33, 132096
    s_mov_b32 m0, s57
    s_nop 0
    buffer_load_dwordx4 v9, s[36:39], s56 offen lds

    ds_read_b64_tr_b16 v[60:61], v35 offset:20480
    ds_read_b64_tr_b16 v[62:63], v35 offset:21504
    s_waitcnt lgkmcnt(10)
    v_mfma_f32_32x32x16_bf16 v[64:79], v[172:175], v[40:43], v[64:79]
    ds_read_b64_tr_b16 v[40:41], v34 offset:24576
    ds_read_b64_tr_b16 v[42:43], v34 offset:25600
    s_waitcnt lgkmcnt(10)
    v_mfma_f32_32x32x16_bf16 v[80:95], v[172:175], v[44:47], v[80:95]
    ds_read_b64_tr_b16 v[44:45], v35 offset:24576
    ds_read_b64_tr_b16 v[46:47], v35 offset:25600
    s_waitcnt lgkmcnt(10)
    v_mfma_f32_32x32x16_bf16 v[64:79], v[176:179], v[48:51], v[64:79]
    ds_read_b64_tr_b16 v[48:49], v34 offset:28672
    ds_read_b64_tr_b16 v[50:51], v34 offset:29696
    s_waitcnt lgkmcnt(10)
    v_mfma_f32_32x32x16_bf16 v[80:95], v[176:179], v[52:55], v[80:95]
    s_mul_i32 s56, s34, 3072
    s_lshl_b32 s57, s14, 9
    s_add_u32 s56, s56, s57
    s_add_u32 s56, s56, 24832
    s_add_u32 s57, s33, 133120
    s_mov_b32 m0, s57
    s_nop 0
    buffer_load_dwordx4 v9, s[36:39], s56 offen lds

    ds_read_b64_tr_b16 v[52:53], v35 offset:28672
    ds_read_b64_tr_b16 v[54:55], v35 offset:29696
    s_waitcnt lgkmcnt(10)
    v_mfma_f32_32x32x16_bf16 v[64:79], v[180:183], v[56:59], v[64:79]
    s_waitcnt lgkmcnt(8)
    v_mfma_f32_32x32x16_bf16 v[80:95], v[180:183], v[60:63], v[80:95]
    s_waitcnt lgkmcnt(6)
    v_mfma_f32_32x32x16_bf16 v[64:79], v[184:187], v[40:43], v[64:79]
    s_waitcnt lgkmcnt(4)
    v_mfma_f32_32x32x16_bf16 v[80:95], v[184:187], v[44:47], v[80:95]
    s_mul_i32 s56, s34, 3072
    s_lshl_b32 s57, s14, 9
    s_add_u32 s56, s56, s57
    s_add_u32 s56, s56, 37120
    s_add_u32 s57, s33, 134144
    s_mov_b32 m0, s57
    s_nop 0
    buffer_load_dwordx4 v9, s[36:39], s56 offen lds

    s_waitcnt lgkmcnt(2)
    v_mfma_f32_32x32x16_bf16 v[64:79], v[188:191], v[48:51], v[64:79]
    s_waitcnt lgkmcnt(0)
    v_mfma_f32_32x32x16_bf16 v[80:95], v[188:191], v[52:55], v[80:95]
    s_waitcnt vmcnt(12)
    s_waitcnt lgkmcnt(0)
    s_barrier
    v_add_u32 v34, 32768, v16
    v_add_u32 v35, 32768, v17
    ds_read_b64_tr_b16 v[40:41], v34 offset:0
    ds_read_b64_tr_b16 v[42:43], v34 offset:1024
    ds_read_b64_tr_b16 v[44:45], v35 offset:0
    ds_read_b64_tr_b16 v[46:47], v35 offset:1024
    ds_read_b64_tr_b16 v[48:49], v34 offset:4096
    ds_read_b64_tr_b16 v[50:51], v34 offset:5120
    ds_read_b64_tr_b16 v[52:53], v35 offset:4096
    ds_read_b64_tr_b16 v[54:55], v35 offset:5120
    ds_read_b64_tr_b16 v[56:57], v34 offset:8192
    ds_read_b64_tr_b16 v[58:59], v34 offset:9216
    ds_read_b64_tr_b16 v[60:61], v35 offset:8192
    ds_read_b64_tr_b16 v[62:63], v35 offset:9216
    s_waitcnt lgkmcnt(10)
    v_mfma_f32_32x32x16_bf16 v[64:79], v[192:195], v[40:43], v[64:79]
    ds_read_b64_tr_b16 v[40:41], v34 offset:12288
    ds_read_b64_tr_b16 v[42:43], v34 offset:13312
    s_waitcnt lgkmcnt(10)
    v_mfma_f32_32x32x16_bf16 v[80:95], v[192:195], v[44:47], v[80:95]
    s_mul_i32 s56, s34, 3072
    s_lshl_b32 s57, s14, 9
    s_add_u32 s56, s56, s57
    s_add_u32 s56, s56, 393472
    s_add_u32 s57, s33, 0
    s_mov_b32 m0, s57
    s_nop 0
    buffer_load_dwordx4 v9, s[36:39], s56 offen lds

    ds_read_b64_tr_b16 v[44:45], v35 offset:12288
    ds_read_b64_tr_b16 v[46:47], v35 offset:13312
    s_waitcnt lgkmcnt(10)
    v_mfma_f32_32x32x16_bf16 v[64:79], v[196:199], v[48:51], v[64:79]
    ds_read_b64_tr_b16 v[48:49], v34 offset:16384
    ds_read_b64_tr_b16 v[50:51], v34 offset:17408
    s_waitcnt lgkmcnt(10)
    v_mfma_f32_32x32x16_bf16 v[80:95], v[196:199], v[52:55], v[80:95]
    ds_read_b64_tr_b16 v[52:53], v35 offset:16384
    ds_read_b64_tr_b16 v[54:55], v35 offset:17408
    s_waitcnt lgkmcnt(10)
    v_mfma_f32_32x32x16_bf16 v[64:79], v[200:203], v[56:59], v[64:79]
    ds_read_b64_tr_b16 v[56:57], v34 offset:20480
    ds_read_b64_tr_b16 v[58:59], v34 offset:21504
    s_waitcnt lgkmcnt(10)
    v_mfma_f32_32x32x16_bf16 v[80:95], v[200:203], v[60:63], v[80:95]
    s_mul_i32 s56, s34, 3072
    s_lshl_b32 s57, s14, 9
    s_add_u32 s56, s56, s57
    s_add_u32 s56, s56, 405760
    s_add_u32 s57, s33, 1024
    s_mov_b32 m0, s57
    s_nop 0
    buffer_load_dwordx4 v9, s[36:39], s56 offen lds

    ds_read_b64_tr_b16 v[60:61], v35 offset:20480
    ds_read_b64_tr_b16 v[62:63], v35 offset:21504
    s_waitcnt lgkmcnt(10)
    v_mfma_f32_32x32x16_bf16 v[64:79], v[204:207], v[40:43], v[64:79]
    ds_read_b64_tr_b16 v[40:41], v34 offset:24576
    ds_read_b64_tr_b16 v[42:43], v34 offset:25600
    s_waitcnt lgkmcnt(10)
    v_mfma_f32_32x32x16_bf16 v[80:95], v[204:207], v[44:47], v[80:95]
    ds_read_b64_tr_b16 v[44:45], v35 offset:24576
    ds_read_b64_tr_b16 v[46:47], v35 offset:25600
    s_waitcnt lgkmcnt(10)
    v_mfma_f32_32x32x16_bf16 v[64:79], v[208:211], v[48:51], v[64:79]
    ds_read_b64_tr_b16 v[48:49], v34 offset:28672
    ds_read_b64_tr_b16 v[50:51], v34 offset:29696
    s_waitcnt lgkmcnt(10)
    v_mfma_f32_32x32x16_bf16 v[80:95], v[208:211], v[52:55], v[80:95]
    s_mul_i32 s56, s34, 3072
    s_lshl_b32 s57, s14, 9
    s_add_u32 s56, s56, s57
    s_add_u32 s56, s56, 418048
    s_add_u32 s57, s33, 2048
    s_mov_b32 m0, s57
    s_nop 0
    buffer_load_dwordx4 v9, s[36:39], s56 offen lds

    ds_read_b64_tr_b16 v[52:53], v35 offset:28672
    ds_read_b64_tr_b16 v[54:55], v35 offset:29696
    s_waitcnt lgkmcnt(10)
    v_mfma_f32_32x32x16_bf16 v[64:79], v[212:215], v[56:59], v[64:79]
    s_waitcnt lgkmcnt(8)
    v_mfma_f32_32x32x16_bf16 v[80:95], v[212:215], v[60:63], v[80:95]
    s_waitcnt lgkmcnt(6)
    v_mfma_f32_32x32x16_bf16 v[64:79], v[216:219], v[40:43], v[64:79]
    s_waitcnt lgkmcnt(4)
    v_mfma_f32_32x32x16_bf16 v[80:95], v[216:219], v[44:47], v[80:95]
    s_mul_i32 s56, s34, 3072
    s_lshl_b32 s57, s14, 9
    s_add_u32 s56, s56, s57
    s_add_u32 s56, s56, 430336
    s_add_u32 s57, s33, 3072
    s_mov_b32 m0, s57
    s_nop 0
    buffer_load_dwordx4 v9, s[36:39], s56 offen lds

    s_waitcnt lgkmcnt(2)
    v_mfma_f32_32x32x16_bf16 v[64:79], v[220:223], v[48:51], v[64:79]
    s_waitcnt lgkmcnt(0)
    v_mfma_f32_32x32x16_bf16 v[80:95], v[220:223], v[52:55], v[80:95]
    s_waitcnt vmcnt(12)
    s_waitcnt lgkmcnt(0)
    s_barrier
    v_add_u32 v34, 65536, v16
    v_add_u32 v35, 65536, v17
    ds_read_b64_tr_b16 v[40:41], v34 offset:0
    ds_read_b64_tr_b16 v[42:43], v34 offset:1024
    ds_read_b64_tr_b16 v[44:45], v35 offset:0
    ds_read_b64_tr_b16 v[46:47], v35 offset:1024
    ds_read_b64_tr_b16 v[48:49], v34 offset:4096
    ds_read_b64_tr_b16 v[50:51], v34 offset:5120
    ds_read_b64_tr_b16 v[52:53], v35 offset:4096
    ds_read_b64_tr_b16 v[54:55], v35 offset:5120
    ds_read_b64_tr_b16 v[56:57], v34 offset:8192
    ds_read_b64_tr_b16 v[58:59], v34 offset:9216
    ds_read_b64_tr_b16 v[60:61], v35 offset:8192
    ds_read_b64_tr_b16 v[62:63], v35 offset:9216
    s_waitcnt lgkmcnt(10)
    v_mfma_f32_32x32x16_bf16 v[64:79], v[224:227], v[40:43], v[64:79]
    ds_read_b64_tr_b16 v[40:41], v34 offset:12288
    ds_read_b64_tr_b16 v[42:43], v34 offset:13312
    s_waitcnt lgkmcnt(10)
    v_mfma_f32_32x32x16_bf16 v[80:95], v[224:227], v[44:47], v[80:95]
    s_mul_i32 s56, s34, 3072
    s_lshl_b32 s57, s14, 9
    s_add_u32 s56, s56, s57
    s_add_u32 s56, s56, 786688
    s_add_u32 s57, s33, 32768
    s_mov_b32 m0, s57
    s_nop 0
    buffer_load_dwordx4 v9, s[36:39], s56 offen lds

    ds_read_b64_tr_b16 v[44:45], v35 offset:12288
    ds_read_b64_tr_b16 v[46:47], v35 offset:13312
    s_waitcnt lgkmcnt(10)
    v_mfma_f32_32x32x16_bf16 v[64:79], v[228:231], v[48:51], v[64:79]
    ds_read_b64_tr_b16 v[48:49], v34 offset:16384
    ds_read_b64_tr_b16 v[50:51], v34 offset:17408
    s_waitcnt lgkmcnt(10)
    v_mfma_f32_32x32x16_bf16 v[80:95], v[228:231], v[52:55], v[80:95]
    ds_read_b64_tr_b16 v[52:53], v35 offset:16384
    ds_read_b64_tr_b16 v[54:55], v35 offset:17408
    s_waitcnt lgkmcnt(10)
    v_mfma_f32_32x32x16_bf16 v[64:79], v[232:235], v[56:59], v[64:79]
    ds_read_b64_tr_b16 v[56:57], v34 offset:20480
    ds_read_b64_tr_b16 v[58:59], v34 offset:21504
    s_waitcnt lgkmcnt(10)
    v_mfma_f32_32x32x16_bf16 v[80:95], v[232:235], v[60:63], v[80:95]
    s_mul_i32 s56, s34, 3072
    s_lshl_b32 s57, s14, 9
    s_add_u32 s56, s56, s57
    s_add_u32 s56, s56, 798976
    s_add_u32 s57, s33, 33792
    s_mov_b32 m0, s57
    s_nop 0
    buffer_load_dwordx4 v9, s[36:39], s56 offen lds

    ds_read_b64_tr_b16 v[60:61], v35 offset:20480
    ds_read_b64_tr_b16 v[62:63], v35 offset:21504
    s_waitcnt lgkmcnt(10)
    v_mfma_f32_32x32x16_bf16 v[64:79], v[236:239], v[40:43], v[64:79]
    ds_read_b64_tr_b16 v[40:41], v34 offset:24576
    ds_read_b64_tr_b16 v[42:43], v34 offset:25600
    s_waitcnt lgkmcnt(10)
    v_mfma_f32_32x32x16_bf16 v[80:95], v[236:239], v[44:47], v[80:95]
    ds_read_b64_tr_b16 v[44:45], v35 offset:24576
    ds_read_b64_tr_b16 v[46:47], v35 offset:25600
    s_waitcnt lgkmcnt(10)
    v_mfma_f32_32x32x16_bf16 v[64:79], v[240:243], v[48:51], v[64:79]
    ds_read_b64_tr_b16 v[48:49], v34 offset:28672
    ds_read_b64_tr_b16 v[50:51], v34 offset:29696
    s_waitcnt lgkmcnt(10)
    v_mfma_f32_32x32x16_bf16 v[80:95], v[240:243], v[52:55], v[80:95]
    s_mul_i32 s56, s34, 3072
    s_lshl_b32 s57, s14, 9
    s_add_u32 s56, s56, s57
    s_add_u32 s56, s56, 811264
    s_add_u32 s57, s33, 34816
    s_mov_b32 m0, s57
    s_nop 0
    buffer_load_dwordx4 v9, s[36:39], s56 offen lds

    ds_read_b64_tr_b16 v[52:53], v35 offset:28672
    ds_read_b64_tr_b16 v[54:55], v35 offset:29696
    s_waitcnt lgkmcnt(10)
    v_mfma_f32_32x32x16_bf16 v[64:79], v[244:247], v[56:59], v[64:79]
    s_waitcnt lgkmcnt(8)
    v_mfma_f32_32x32x16_bf16 v[80:95], v[244:247], v[60:63], v[80:95]
    s_waitcnt lgkmcnt(6)
    v_mfma_f32_32x32x16_bf16 v[64:79], v[248:251], v[40:43], v[64:79]
    s_waitcnt lgkmcnt(4)
    v_mfma_f32_32x32x16_bf16 v[80:95], v[248:251], v[44:47], v[80:95]
    s_mul_i32 s56, s34, 3072
    s_lshl_b32 s57, s14, 9
    s_add_u32 s56, s56, s57
    s_add_u32 s56, s56, 823552
    s_add_u32 s57, s33, 35840
    s_mov_b32 m0, s57
    s_nop 0
    buffer_load_dwordx4 v9, s[36:39], s56 offen lds

    s_waitcnt lgkmcnt(2)
    v_mfma_f32_32x32x16_bf16 v[64:79], v[252:255], v[48:51], v[64:79]
    s_waitcnt lgkmcnt(0)
    v_mfma_f32_32x32x16_bf16 v[80:95], v[252:255], v[52:55], v[80:95]
    s_nop 15
    s_sub_u32 s30, s14, 4
    s_lshl_b32 s30, s30, 3
    s_add_u32 s30, s30, 0
    s_add_u32 s30, s30, s43
    s_lshl_b32 s30, s30, 11
    s_add_u32 s30, s30, 4194304
    s_waitcnt lgkmcnt(0)

    v_mul_f32 v64, v96, v64
    v_mul_f32 v65, v97, v65
    v_mul_f32 v66, v98, v66
    v_mul_f32 v67, v99, v67
    v_mul_f32 v68, v100, v68
    v_mul_f32 v69, v101, v69
    v_mul_f32 v70, v102, v70
    v_mul_f32 v71, v103, v71
    v_mul_f32 v72, v104, v72
    v_mul_f32 v73, v105, v73
    v_mul_f32 v74, v106, v74
    v_mul_f32 v75, v107, v75
    v_mul_f32 v76, v108, v76
    v_mul_f32 v77, v109, v77
    v_mul_f32 v78, v110, v78
    v_mul_f32 v79, v111, v79
    v_cvt_pk_bf16_f32 v64, v64, v65
    v_cvt_pk_bf16_f32 v65, v66, v67
    v_cvt_pk_bf16_f32 v66, v68, v69
    v_cvt_pk_bf16_f32 v67, v70, v71
    v_cvt_pk_bf16_f32 v68, v72, v73
    v_cvt_pk_bf16_f32 v69, v74, v75
    v_cvt_pk_bf16_f32 v70, v76, v77
    v_cvt_pk_bf16_f32 v71, v78, v79
    s_add_u32 s31, s30, 0
    buffer_store_dwordx4 v[64:67], v21, s[20:23], s31 offen sc0 sc1
    buffer_store_dwordx4 v[68:71], v21, s[20:23], s31 offen offset:1024 sc0 sc1

    v_mul_f32 v80, v96, v80
    v_mul_f32 v81, v97, v81
    v_mul_f32 v82, v98, v82
    v_mul_f32 v83, v99, v83
    v_mul_f32 v84, v100, v84
    v_mul_f32 v85, v101, v85
    v_mul_f32 v86, v102, v86
    v_mul_f32 v87, v103, v87
    v_mul_f32 v88, v104, v88
    v_mul_f32 v89, v105, v89
    v_mul_f32 v90, v106, v90
    v_mul_f32 v91, v107, v91
    v_mul_f32 v92, v108, v92
    v_mul_f32 v93, v109, v93
    v_mul_f32 v94, v110, v94
    v_mul_f32 v95, v111, v95
    v_cvt_pk_bf16_f32 v80, v80, v81
    v_cvt_pk_bf16_f32 v81, v82, v83
    v_cvt_pk_bf16_f32 v82, v84, v85
    v_cvt_pk_bf16_f32 v83, v86, v87
    v_cvt_pk_bf16_f32 v84, v88, v89
    v_cvt_pk_bf16_f32 v85, v90, v91
    v_cvt_pk_bf16_f32 v86, v92, v93
    v_cvt_pk_bf16_f32 v87, v94, v95
    s_add_u32 s31, s30, 2048
    buffer_store_dwordx4 v[80:83], v21, s[20:23], s31 offen sc0 sc1
    buffer_store_dwordx4 v[84:87], v21, s[20:23], s31 offen offset:1024 sc0 sc1

    s_nop 1
    s_waitcnt vmcnt(12)
    s_waitcnt lgkmcnt(0)
    s_barrier
    s_cmp_ge_u32 s52, 1888
    s_cbranch_scc1 K1v_wts
    v_lshlrev_b32 v6, 4, v2
    v_lshl_or_b32 v26, v27, 16, v26
    v_lshl_or_b32 v27, v29, 16, v28
    v_lshl_or_b32 v28, v31, 16, v30
    v_lshl_or_b32 v29, v33, 16, v32
    buffer_store_dwordx4 v[26:29], v6, s[20:23], s55 offen sc0 sc1

K1v_wts:
    v_add_u32 v34, 131072, v16
    v_add_u32 v35, 131072, v17
    ds_read_b64_tr_b16 v[40:41], v34 offset:0
    ds_read_b64_tr_b16 v[42:43], v34 offset:1024
    ds_read_b64_tr_b16 v[44:45], v35 offset:0
    ds_read_b64_tr_b16 v[46:47], v35 offset:1024
    ds_read_b64_tr_b16 v[48:49], v34 offset:4096
    ds_read_b64_tr_b16 v[50:51], v34 offset:5120
    ds_read_b64_tr_b16 v[52:53], v35 offset:4096
    ds_read_b64_tr_b16 v[54:55], v35 offset:5120
    ds_read_b64_tr_b16 v[56:57], v34 offset:8192
    ds_read_b64_tr_b16 v[58:59], v34 offset:9216
    ds_read_b64_tr_b16 v[60:61], v35 offset:8192
    ds_read_b64_tr_b16 v[62:63], v35 offset:9216
    s_waitcnt lgkmcnt(10)
    v_mfma_f32_32x32x16_bf16 v[64:79], v[128:131], v[40:43], 0
    ds_read_b64_tr_b16 v[40:41], v34 offset:12288
    ds_read_b64_tr_b16 v[42:43], v34 offset:13312
    s_waitcnt lgkmcnt(10)
    v_mfma_f32_32x32x16_bf16 v[80:95], v[128:131], v[44:47], 0
    s_mul_i32 s56, s34, 3072
    s_lshl_b32 s57, s14, 9
    s_add_u32 s56, s56, s57
    s_add_u32 s56, s56, 1179904
    s_add_u32 s57, s33, 65536
    s_mov_b32 m0, s57
    s_nop 0
    buffer_load_dwordx4 v9, s[36:39], s56 offen lds

    ds_read_b64_tr_b16 v[44:45], v35 offset:12288
    ds_read_b64_tr_b16 v[46:47], v35 offset:13312
    s_waitcnt lgkmcnt(10)
    v_mfma_f32_32x32x16_bf16 v[64:79], v[132:135], v[48:51], v[64:79]
    ds_read_b64_tr_b16 v[48:49], v34 offset:16384
    ds_read_b64_tr_b16 v[50:51], v34 offset:17408
    s_waitcnt lgkmcnt(10)
    v_mfma_f32_32x32x16_bf16 v[80:95], v[132:135], v[52:55], v[80:95]
    ds_read_b64_tr_b16 v[52:53], v35 offset:16384
    ds_read_b64_tr_b16 v[54:55], v35 offset:17408
    s_waitcnt lgkmcnt(10)
    v_mfma_f32_32x32x16_bf16 v[64:79], v[136:139], v[56:59], v[64:79]
    ds_read_b64_tr_b16 v[56:57], v34 offset:20480
    ds_read_b64_tr_b16 v[58:59], v34 offset:21504
    s_waitcnt lgkmcnt(10)
    v_mfma_f32_32x32x16_bf16 v[80:95], v[136:139], v[60:63], v[80:95]
    s_mul_i32 s56, s34, 3072
    s_lshl_b32 s57, s14, 9
    s_add_u32 s56, s56, s57
    s_add_u32 s56, s56, 1192192
    s_add_u32 s57, s33, 66560
    s_mov_b32 m0, s57
    s_nop 0
    buffer_load_dwordx4 v9, s[36:39], s56 offen lds

    ds_read_b64_tr_b16 v[60:61], v35 offset:20480
    ds_read_b64_tr_b16 v[62:63], v35 offset:21504
    s_waitcnt lgkmcnt(10)
    v_mfma_f32_32x32x16_bf16 v[64:79], v[140:143], v[40:43], v[64:79]
    ds_read_b64_tr_b16 v[40:41], v34 offset:24576
    ds_read_b64_tr_b16 v[42:43], v34 offset:25600
    s_waitcnt lgkmcnt(10)
    v_mfma_f32_32x32x16_bf16 v[80:95], v[140:143], v[44:47], v[80:95]
    ds_read_b64_tr_b16 v[44:45], v35 offset:24576
    ds_read_b64_tr_b16 v[46:47], v35 offset:25600
    s_waitcnt lgkmcnt(10)
    v_mfma_f32_32x32x16_bf16 v[64:79], v[144:147], v[48:51], v[64:79]
    ds_read_b64_tr_b16 v[48:49], v34 offset:28672
    ds_read_b64_tr_b16 v[50:51], v34 offset:29696
    s_waitcnt lgkmcnt(10)
    v_mfma_f32_32x32x16_bf16 v[80:95], v[144:147], v[52:55], v[80:95]
    s_mul_i32 s56, s34, 3072
    s_lshl_b32 s57, s14, 9
    s_add_u32 s56, s56, s57
    s_add_u32 s56, s56, 1204480
    s_add_u32 s57, s33, 67584
    s_mov_b32 m0, s57
    s_nop 0
    buffer_load_dwordx4 v9, s[36:39], s56 offen lds

    ds_read_b64_tr_b16 v[52:53], v35 offset:28672
    ds_read_b64_tr_b16 v[54:55], v35 offset:29696
    s_waitcnt lgkmcnt(10)
    v_mfma_f32_32x32x16_bf16 v[64:79], v[148:151], v[56:59], v[64:79]
    s_waitcnt lgkmcnt(8)
    v_mfma_f32_32x32x16_bf16 v[80:95], v[148:151], v[60:63], v[80:95]
    s_waitcnt lgkmcnt(6)
    v_mfma_f32_32x32x16_bf16 v[64:79], v[152:155], v[40:43], v[64:79]
    s_waitcnt lgkmcnt(4)
    v_mfma_f32_32x32x16_bf16 v[80:95], v[152:155], v[44:47], v[80:95]
    s_mul_i32 s56, s34, 3072
    s_lshl_b32 s57, s14, 9
    s_add_u32 s56, s56, s57
    s_add_u32 s56, s56, 1216768
    s_add_u32 s57, s33, 68608
    s_mov_b32 m0, s57
    s_nop 0
    buffer_load_dwordx4 v9, s[36:39], s56 offen lds

    s_waitcnt lgkmcnt(2)
    v_mfma_f32_32x32x16_bf16 v[64:79], v[156:159], v[48:51], v[64:79]
    s_waitcnt lgkmcnt(0)
    v_mfma_f32_32x32x16_bf16 v[80:95], v[156:159], v[52:55], v[80:95]
    s_cmp_lg_u32 s41, 0
    s_cbranch_scc1 K1v_sk4
    ds_read_b64_tr_b16 v[40:41], v36 offset:0
    ds_read_b64_tr_b16 v[42:43], v36 offset:256
    ds_read_b64_tr_b16 v[44:45], v36 offset:1024
    ds_read_b64_tr_b16 v[46:47], v36 offset:1280
    ds_read_b64_tr_b16 v[48:49], v36 offset:2048
    ds_read_b64_tr_b16 v[50:51], v36 offset:2304
    ds_read_b64_tr_b16 v[52:53], v36 offset:3072
    ds_read_b64_tr_b16 v[54:55], v36 offset:3328
    ds_read_b64_tr_b16 v[56:57], v36 offset:4096
    ds_read_b64_tr_b16 v[58:59], v36 offset:4352
    ds_read_b64_tr_b16 v[60:61], v36 offset:5120
    ds_read_b64_tr_b16 v[62:63], v36 offset:5376
    s_waitcnt lgkmcnt(10)
    v_mfma_f32_32x32x16_bf16 v[112:127], v[40:43], v[128:131], 0
    ds_read_b64_tr_b16 v[40:41], v36 offset:6144
    ds_read_b64_tr_b16 v[42:43], v36 offset:6400
    s_waitcnt lgkmcnt(10)
    v_mfma_f32_32x32x16_bf16 v[112:127], v[44:47], v[132:135], v[112:127]
    ds_read_b64_tr_b16 v[44:45], v36 offset:7168
    ds_read_b64_tr_b16 v[46:47], v36 offset:7424
    s_waitcnt lgkmcnt(10)
    v_mfma_f32_32x32x16_bf16 v[112:127], v[48:51], v[136:139], v[112:127]
    s_waitcnt lgkmcnt(8)
    v_mfma_f32_32x32x16_bf16 v[112:127], v[52:55], v[140:143], v[112:127]
    s_waitcnt lgkmcnt(6)
    v_mfma_f32_32x32x16_bf16 v[112:127], v[56:59], v[144:147], v[112:127]
    s_waitcnt lgkmcnt(4)
    v_mfma_f32_32x32x16_bf16 v[112:127], v[60:63], v[148:151], v[112:127]
    s_waitcnt lgkmcnt(2)
    v_mfma_f32_32x32x16_bf16 v[112:127], v[40:43], v[152:155], v[112:127]
    s_waitcnt lgkmcnt(0)
    v_mfma_f32_32x32x16_bf16 v[112:127], v[44:47], v[156:159], v[112:127]
K1v_sk4:
    s_waitcnt vmcnt(12)
    s_waitcnt lgkmcnt(0)
    s_barrier
    v_add_u32 v34, 0, v16
    v_add_u32 v35, 0, v17
    ds_read_b64_tr_b16 v[40:41], v34 offset:0
    ds_read_b64_tr_b16 v[42:43], v34 offset:1024
    ds_read_b64_tr_b16 v[44:45], v35 offset:0
    ds_read_b64_tr_b16 v[46:47], v35 offset:1024
    ds_read_b64_tr_b16 v[48:49], v34 offset:4096
    ds_read_b64_tr_b16 v[50:51], v34 offset:5120
    ds_read_b64_tr_b16 v[52:53], v35 offset:4096
    ds_read_b64_tr_b16 v[54:55], v35 offset:5120
    ds_read_b64_tr_b16 v[56:57], v34 offset:8192
    ds_read_b64_tr_b16 v[58:59], v34 offset:9216
    ds_read_b64_tr_b16 v[60:61], v35 offset:8192
    ds_read_b64_tr_b16 v[62:63], v35 offset:9216
    s_waitcnt lgkmcnt(10)
    v_mfma_f32_32x32x16_bf16 v[64:79], v[160:163], v[40:43], v[64:79]
    ds_read_b64_tr_b16 v[40:41], v34 offset:12288
    ds_read_b64_tr_b16 v[42:43], v34 offset:13312
    s_waitcnt lgkmcnt(10)
    v_mfma_f32_32x32x16_bf16 v[80:95], v[160:163], v[44:47], v[80:95]
    ds_read_b64_tr_b16 v[44:45], v35 offset:12288
    ds_read_b64_tr_b16 v[46:47], v35 offset:13312
    s_waitcnt lgkmcnt(10)
    v_mfma_f32_32x32x16_bf16 v[64:79], v[164:167], v[48:51], v[64:79]
    ds_read_b64_tr_b16 v[48:49], v34 offset:16384
    ds_read_b64_tr_b16 v[50:51], v34 offset:17408
    s_waitcnt lgkmcnt(10)
    v_mfma_f32_32x32x16_bf16 v[80:95], v[164:167], v[52:55], v[80:95]
    ds_read_b64_tr_b16 v[52:53], v35 offset:16384
    ds_read_b64_tr_b16 v[54:55], v35 offset:17408
    s_waitcnt lgkmcnt(10)
    v_mfma_f32_32x32x16_bf16 v[64:79], v[168:171], v[56:59], v[64:79]
    ds_read_b64_tr_b16 v[56:57], v34 offset:20480
    ds_read_b64_tr_b16 v[58:59], v34 offset:21504
    s_waitcnt lgkmcnt(10)
    v_mfma_f32_32x32x16_bf16 v[80:95], v[168:171], v[60:63], v[80:95]
    ds_read_b64_tr_b16 v[60:61], v35 offset:20480
    ds_read_b64_tr_b16 v[62:63], v35 offset:21504
    s_waitcnt lgkmcnt(10)
    v_mfma_f32_32x32x16_bf16 v[64:79], v[172:175], v[40:43], v[64:79]
    ds_read_b64_tr_b16 v[40:41], v34 offset:24576
    ds_read_b64_tr_b16 v[42:43], v34 offset:25600
    s_waitcnt lgkmcnt(10)
    v_mfma_f32_32x32x16_bf16 v[80:95], v[172:175], v[44:47], v[80:95]
    ds_read_b64_tr_b16 v[44:45], v35 offset:24576
    ds_read_b64_tr_b16 v[46:47], v35 offset:25600
    s_waitcnt lgkmcnt(10)
    v_mfma_f32_32x32x16_bf16 v[64:79], v[176:179], v[48:51], v[64:79]
    ds_read_b64_tr_b16 v[48:49], v34 offset:28672
    ds_read_b64_tr_b16 v[50:51], v34 offset:29696
    s_waitcnt lgkmcnt(10)
    v_mfma_f32_32x32x16_bf16 v[80:95], v[176:179], v[52:55], v[80:95]
    ds_read_b64_tr_b16 v[52:53], v35 offset:28672
    ds_read_b64_tr_b16 v[54:55], v35 offset:29696
    s_waitcnt lgkmcnt(10)
    v_mfma_f32_32x32x16_bf16 v[64:79], v[180:183], v[56:59], v[64:79]
    s_waitcnt lgkmcnt(8)
    v_mfma_f32_32x32x16_bf16 v[80:95], v[180:183], v[60:63], v[80:95]
    s_waitcnt lgkmcnt(6)
    v_mfma_f32_32x32x16_bf16 v[64:79], v[184:187], v[40:43], v[64:79]
    s_waitcnt lgkmcnt(4)
    v_mfma_f32_32x32x16_bf16 v[80:95], v[184:187], v[44:47], v[80:95]
    s_waitcnt lgkmcnt(2)
    v_mfma_f32_32x32x16_bf16 v[64:79], v[188:191], v[48:51], v[64:79]
    s_waitcnt lgkmcnt(0)
    v_mfma_f32_32x32x16_bf16 v[80:95], v[188:191], v[52:55], v[80:95]
    s_cmp_lg_u32 s41, 0
    s_cbranch_scc1 K1v_sk5
    ds_read_b64_tr_b16 v[40:41], v36 offset:8192
    ds_read_b64_tr_b16 v[42:43], v36 offset:8448
    ds_read_b64_tr_b16 v[44:45], v36 offset:9216
    ds_read_b64_tr_b16 v[46:47], v36 offset:9472
    ds_read_b64_tr_b16 v[48:49], v36 offset:10240
    ds_read_b64_tr_b16 v[50:51], v36 offset:10496
    ds_read_b64_tr_b16 v[52:53], v36 offset:11264
    ds_read_b64_tr_b16 v[54:55], v36 offset:11520
    ds_read_b64_tr_b16 v[56:57], v36 offset:12288
    ds_read_b64_tr_b16 v[58:59], v36 offset:12544
    ds_read_b64_tr_b16 v[60:61], v36 offset:13312
    ds_read_b64_tr_b16 v[62:63], v36 offset:13568
    s_waitcnt lgkmcnt(10)
    v_mfma_f32_32x32x16_bf16 v[112:127], v[40:43], v[160:163], v[112:127]
    ds_read_b64_tr_b16 v[40:41], v36 offset:14336
    ds_read_b64_tr_b16 v[42:43], v36 offset:14592
    s_waitcnt lgkmcnt(10)
    v_mfma_f32_32x32x16_bf16 v[112:127], v[44:47], v[164:167], v[112:127]
    ds_read_b64_tr_b16 v[44:45], v36 offset:15360
    ds_read_b64_tr_b16 v[46:47], v36 offset:15616
    s_waitcnt lgkmcnt(10)
    v_mfma_f32_32x32x16_bf16 v[112:127], v[48:51], v[168:171], v[112:127]
    s_waitcnt lgkmcnt(8)
    v_mfma_f32_32x32x16_bf16 v[112:127], v[52:55], v[172:175], v[112:127]
    s_waitcnt lgkmcnt(6)
    v_mfma_f32_32x32x16_bf16 v[112:127], v[56:59], v[176:179], v[112:127]
    s_waitcnt lgkmcnt(4)
    v_mfma_f32_32x32x16_bf16 v[112:127], v[60:63], v[180:183], v[112:127]
    s_waitcnt lgkmcnt(2)
    v_mfma_f32_32x32x16_bf16 v[112:127], v[40:43], v[184:187], v[112:127]
    s_waitcnt lgkmcnt(0)
    v_mfma_f32_32x32x16_bf16 v[112:127], v[44:47], v[188:191], v[112:127]
K1v_sk5:
    s_waitcnt vmcnt(8)
    s_waitcnt lgkmcnt(0)
    s_barrier
    v_add_u32 v34, 32768, v16
    v_add_u32 v35, 32768, v17
    ds_read_b64_tr_b16 v[40:41], v34 offset:0
    ds_read_b64_tr_b16 v[42:43], v34 offset:1024
    ds_read_b64_tr_b16 v[44:45], v35 offset:0
    ds_read_b64_tr_b16 v[46:47], v35 offset:1024
    ds_read_b64_tr_b16 v[48:49], v34 offset:4096
    ds_read_b64_tr_b16 v[50:51], v34 offset:5120
    ds_read_b64_tr_b16 v[52:53], v35 offset:4096
    ds_read_b64_tr_b16 v[54:55], v35 offset:5120
    ds_read_b64_tr_b16 v[56:57], v34 offset:8192
    ds_read_b64_tr_b16 v[58:59], v34 offset:9216
    ds_read_b64_tr_b16 v[60:61], v35 offset:8192
    ds_read_b64_tr_b16 v[62:63], v35 offset:9216
    s_waitcnt lgkmcnt(10)
    v_mfma_f32_32x32x16_bf16 v[64:79], v[192:195], v[40:43], v[64:79]
    ds_read_b64_tr_b16 v[40:41], v34 offset:12288
    ds_read_b64_tr_b16 v[42:43], v34 offset:13312
    s_waitcnt lgkmcnt(10)
    v_mfma_f32_32x32x16_bf16 v[80:95], v[192:195], v[44:47], v[80:95]
    ds_read_b64_tr_b16 v[44:45], v35 offset:12288
    ds_read_b64_tr_b16 v[46:47], v35 offset:13312
    s_waitcnt lgkmcnt(10)
    v_mfma_f32_32x32x16_bf16 v[64:79], v[196:199], v[48:51], v[64:79]
    ds_read_b64_tr_b16 v[48:49], v34 offset:16384
    ds_read_b64_tr_b16 v[50:51], v34 offset:17408
    s_waitcnt lgkmcnt(10)
    v_mfma_f32_32x32x16_bf16 v[80:95], v[196:199], v[52:55], v[80:95]
    ds_read_b64_tr_b16 v[52:53], v35 offset:16384
    ds_read_b64_tr_b16 v[54:55], v35 offset:17408
    s_waitcnt lgkmcnt(10)
    v_mfma_f32_32x32x16_bf16 v[64:79], v[200:203], v[56:59], v[64:79]
    ds_read_b64_tr_b16 v[56:57], v34 offset:20480
    ds_read_b64_tr_b16 v[58:59], v34 offset:21504
    s_waitcnt lgkmcnt(10)
    v_mfma_f32_32x32x16_bf16 v[80:95], v[200:203], v[60:63], v[80:95]
    ds_read_b64_tr_b16 v[60:61], v35 offset:20480
    ds_read_b64_tr_b16 v[62:63], v35 offset:21504
    s_waitcnt lgkmcnt(10)
    v_mfma_f32_32x32x16_bf16 v[64:79], v[204:207], v[40:43], v[64:79]
    ds_read_b64_tr_b16 v[40:41], v34 offset:24576
    ds_read_b64_tr_b16 v[42:43], v34 offset:25600
    s_waitcnt lgkmcnt(10)
    v_mfma_f32_32x32x16_bf16 v[80:95], v[204:207], v[44:47], v[80:95]
    ds_read_b64_tr_b16 v[44:45], v35 offset:24576
    ds_read_b64_tr_b16 v[46:47], v35 offset:25600
    s_waitcnt lgkmcnt(10)
    v_mfma_f32_32x32x16_bf16 v[64:79], v[208:211], v[48:51], v[64:79]
    ds_read_b64_tr_b16 v[48:49], v34 offset:28672
    ds_read_b64_tr_b16 v[50:51], v34 offset:29696
    s_waitcnt lgkmcnt(10)
    v_mfma_f32_32x32x16_bf16 v[80:95], v[208:211], v[52:55], v[80:95]
    ds_read_b64_tr_b16 v[52:53], v35 offset:28672
    ds_read_b64_tr_b16 v[54:55], v35 offset:29696
    s_waitcnt lgkmcnt(10)
    v_mfma_f32_32x32x16_bf16 v[64:79], v[212:215], v[56:59], v[64:79]
    s_waitcnt lgkmcnt(8)
    v_mfma_f32_32x32x16_bf16 v[80:95], v[212:215], v[60:63], v[80:95]
    s_waitcnt lgkmcnt(6)
    v_mfma_f32_32x32x16_bf16 v[64:79], v[216:219], v[40:43], v[64:79]
    s_waitcnt lgkmcnt(4)
    v_mfma_f32_32x32x16_bf16 v[80:95], v[216:219], v[44:47], v[80:95]
    s_waitcnt lgkmcnt(2)
    v_mfma_f32_32x32x16_bf16 v[64:79], v[220:223], v[48:51], v[64:79]
    s_waitcnt lgkmcnt(0)
    v_mfma_f32_32x32x16_bf16 v[80:95], v[220:223], v[52:55], v[80:95]
    s_cmp_lg_u32 s41, 0
    s_cbranch_scc1 K1v_sk6
    ds_read_b64_tr_b16 v[40:41], v36 offset:16384
    ds_read_b64_tr_b16 v[42:43], v36 offset:16640
    ds_read_b64_tr_b16 v[44:45], v36 offset:17408
    ds_read_b64_tr_b16 v[46:47], v36 offset:17664
    ds_read_b64_tr_b16 v[48:49], v36 offset:18432
    ds_read_b64_tr_b16 v[50:51], v36 offset:18688
    ds_read_b64_tr_b16 v[52:53], v36 offset:19456
    ds_read_b64_tr_b16 v[54:55], v36 offset:19712
    ds_read_b64_tr_b16 v[56:57], v36 offset:20480
    ds_read_b64_tr_b16 v[58:59], v36 offset:20736
    ds_read_b64_tr_b16 v[60:61], v36 offset:21504
    ds_read_b64_tr_b16 v[62:63], v36 offset:21760
    s_waitcnt lgkmcnt(10)
    v_mfma_f32_32x32x16_bf16 v[112:127], v[40:43], v[192:195], v[112:127]
    ds_read_b64_tr_b16 v[40:41], v36 offset:22528
    ds_read_b64_tr_b16 v[42:43], v36 offset:22784
    s_waitcnt lgkmcnt(10)
    v_mfma_f32_32x32x16_bf16 v[112:127], v[44:47], v[196:199], v[112:127]
    ds_read_b64_tr_b16 v[44:45], v36 offset:23552
    ds_read_b64_tr_b16 v[46:47], v36 offset:23808
    s_waitcnt lgkmcnt(10)
    v_mfma_f32_32x32x16_bf16 v[112:127], v[48:51], v[200:203], v[112:127]
    s_waitcnt lgkmcnt(8)
    v_mfma_f32_32x32x16_bf16 v[112:127], v[52:55], v[204:207], v[112:127]
    s_waitcnt lgkmcnt(6)
    v_mfma_f32_32x32x16_bf16 v[112:127], v[56:59], v[208:211], v[112:127]
    s_waitcnt lgkmcnt(4)
    v_mfma_f32_32x32x16_bf16 v[112:127], v[60:63], v[212:215], v[112:127]
    s_waitcnt lgkmcnt(2)
    v_mfma_f32_32x32x16_bf16 v[112:127], v[40:43], v[216:219], v[112:127]
    s_waitcnt lgkmcnt(0)
    v_mfma_f32_32x32x16_bf16 v[112:127], v[44:47], v[220:223], v[112:127]
K1v_sk6:
    s_waitcnt vmcnt(0)
    s_waitcnt lgkmcnt(0)
    s_barrier
    v_add_u32 v34, 65536, v16
    v_add_u32 v35, 65536, v17
    ds_read_b64_tr_b16 v[40:41], v34 offset:0
    ds_read_b64_tr_b16 v[42:43], v34 offset:1024
    ds_read_b64_tr_b16 v[44:45], v35 offset:0
    ds_read_b64_tr_b16 v[46:47], v35 offset:1024
    ds_read_b64_tr_b16 v[48:49], v34 offset:4096
    ds_read_b64_tr_b16 v[50:51], v34 offset:5120
    ds_read_b64_tr_b16 v[52:53], v35 offset:4096
    ds_read_b64_tr_b16 v[54:55], v35 offset:5120
    ds_read_b64_tr_b16 v[56:57], v34 offset:8192
    ds_read_b64_tr_b16 v[58:59], v34 offset:9216
    ds_read_b64_tr_b16 v[60:61], v35 offset:8192
    ds_read_b64_tr_b16 v[62:63], v35 offset:9216
    s_waitcnt lgkmcnt(10)
    v_mfma_f32_32x32x16_bf16 v[64:79], v[224:227], v[40:43], v[64:79]
    ds_read_b64_tr_b16 v[40:41], v34 offset:12288
    ds_read_b64_tr_b16 v[42:43], v34 offset:13312
    s_waitcnt lgkmcnt(10)
    v_mfma_f32_32x32x16_bf16 v[80:95], v[224:227], v[44:47], v[80:95]
    ds_read_b64_tr_b16 v[44:45], v35 offset:12288
    ds_read_b64_tr_b16 v[46:47], v35 offset:13312
    s_waitcnt lgkmcnt(10)
    v_mfma_f32_32x32x16_bf16 v[64:79], v[228:231], v[48:51], v[64:79]
    ds_read_b64_tr_b16 v[48:49], v34 offset:16384
    ds_read_b64_tr_b16 v[50:51], v34 offset:17408
    s_waitcnt lgkmcnt(10)
    v_mfma_f32_32x32x16_bf16 v[80:95], v[228:231], v[52:55], v[80:95]
    ds_read_b64_tr_b16 v[52:53], v35 offset:16384
    ds_read_b64_tr_b16 v[54:55], v35 offset:17408
    s_waitcnt lgkmcnt(10)
    v_mfma_f32_32x32x16_bf16 v[64:79], v[232:235], v[56:59], v[64:79]
    ds_read_b64_tr_b16 v[56:57], v34 offset:20480
    ds_read_b64_tr_b16 v[58:59], v34 offset:21504
    s_waitcnt lgkmcnt(10)
    v_mfma_f32_32x32x16_bf16 v[80:95], v[232:235], v[60:63], v[80:95]
    ds_read_b64_tr_b16 v[60:61], v35 offset:20480
    ds_read_b64_tr_b16 v[62:63], v35 offset:21504
    s_waitcnt lgkmcnt(10)
    v_mfma_f32_32x32x16_bf16 v[64:79], v[236:239], v[40:43], v[64:79]
    ds_read_b64_tr_b16 v[40:41], v34 offset:24576
    ds_read_b64_tr_b16 v[42:43], v34 offset:25600
    s_waitcnt lgkmcnt(10)
    v_mfma_f32_32x32x16_bf16 v[80:95], v[236:239], v[44:47], v[80:95]
    ds_read_b64_tr_b16 v[44:45], v35 offset:24576
    ds_read_b64_tr_b16 v[46:47], v35 offset:25600
    s_waitcnt lgkmcnt(10)
    v_mfma_f32_32x32x16_bf16 v[64:79], v[240:243], v[48:51], v[64:79]
    ds_read_b64_tr_b16 v[48:49], v34 offset:28672
    ds_read_b64_tr_b16 v[50:51], v34 offset:29696
    s_waitcnt lgkmcnt(10)
    v_mfma_f32_32x32x16_bf16 v[80:95], v[240:243], v[52:55], v[80:95]
    ds_read_b64_tr_b16 v[52:53], v35 offset:28672
    ds_read_b64_tr_b16 v[54:55], v35 offset:29696
    s_waitcnt lgkmcnt(10)
    v_mfma_f32_32x32x16_bf16 v[64:79], v[244:247], v[56:59], v[64:79]
    s_waitcnt lgkmcnt(8)
    v_mfma_f32_32x32x16_bf16 v[80:95], v[244:247], v[60:63], v[80:95]
    s_waitcnt lgkmcnt(6)
    v_mfma_f32_32x32x16_bf16 v[64:79], v[248:251], v[40:43], v[64:79]
    s_waitcnt lgkmcnt(4)
    v_mfma_f32_32x32x16_bf16 v[80:95], v[248:251], v[44:47], v[80:95]
    s_waitcnt lgkmcnt(2)
    v_mfma_f32_32x32x16_bf16 v[64:79], v[252:255], v[48:51], v[64:79]
    s_waitcnt lgkmcnt(0)
    v_mfma_f32_32x32x16_bf16 v[80:95], v[252:255], v[52:55], v[80:95]
    s_cmp_lg_u32 s41, 0
    s_cbranch_scc1 K1v_sk7
    ds_read_b64_tr_b16 v[40:41], v36 offset:24576
    ds_read_b64_tr_b16 v[42:43], v36 offset:24832
    ds_read_b64_tr_b16 v[44:45], v36 offset:25600
    ds_read_b64_tr_b16 v[46:47], v36 offset:25856
    ds_read_b64_tr_b16 v[48:49], v36 offset:26624
    ds_read_b64_tr_b16 v[50:51], v36 offset:26880
    ds_read_b64_tr_b16 v[52:53], v36 offset:27648
    ds_read_b64_tr_b16 v[54:55], v36 offset:27904
    ds_read_b64_tr_b16 v[56:57], v36 offset:28672
    ds_read_b64_tr_b16 v[58:59], v36 offset:28928
    ds_read_b64_tr_b16 v[60:61], v36 offset:29696
    ds_read_b64_tr_b16 v[62:63], v36 offset:29952
    s_waitcnt lgkmcnt(10)
    v_mfma_f32_32x32x16_bf16 v[112:127], v[40:43], v[224:227], v[112:127]
    ds_read_b64_tr_b16 v[40:41], v36 offset:30720
    ds_read_b64_tr_b16 v[42:43], v36 offset:30976
    s_waitcnt lgkmcnt(10)
    v_mfma_f32_32x32x16_bf16 v[112:127], v[44:47], v[228:231], v[112:127]
    ds_read_b64_tr_b16 v[44:45], v36 offset:31744
    ds_read_b64_tr_b16 v[46:47], v36 offset:32000
    s_waitcnt lgkmcnt(10)
    v_mfma_f32_32x32x16_bf16 v[112:127], v[48:51], v[232:235], v[112:127]
    s_waitcnt lgkmcnt(8)
    v_mfma_f32_32x32x16_bf16 v[112:127], v[52:55], v[236:239], v[112:127]
    s_waitcnt lgkmcnt(6)
    v_mfma_f32_32x32x16_bf16 v[112:127], v[56:59], v[240:243], v[112:127]
    s_waitcnt lgkmcnt(4)
    v_mfma_f32_32x32x16_bf16 v[112:127], v[60:63], v[244:247], v[112:127]
    s_waitcnt lgkmcnt(2)
    v_mfma_f32_32x32x16_bf16 v[112:127], v[40:43], v[248:251], v[112:127]
    s_waitcnt lgkmcnt(0)
    v_mfma_f32_32x32x16_bf16 v[112:127], v[44:47], v[252:255], v[112:127]
K1v_sk7:
    s_nop 15
    s_sub_u32 s30, s14, 4
    s_lshl_b32 s30, s30, 3
    s_add_u32 s30, s30, 4
    s_add_u32 s30, s30, s43
    s_lshl_b32 s30, s30, 11
    s_add_u32 s30, s30, 4194304
    s_waitcnt lgkmcnt(0)

    v_mul_f32 v64, v96, v64
    v_mul_f32 v65, v97, v65
    v_mul_f32 v66, v98, v66
    v_mul_f32 v67, v99, v67
    v_mul_f32 v68, v100, v68
    v_mul_f32 v69, v101, v69
    v_mul_f32 v70, v102, v70
    v_mul_f32 v71, v103, v71
    v_mul_f32 v72, v104, v72
    v_mul_f32 v73, v105, v73
    v_mul_f32 v74, v106, v74
    v_mul_f32 v75, v107, v75
    v_mul_f32 v76, v108, v76
    v_mul_f32 v77, v109, v77
    v_mul_f32 v78, v110, v78
    v_mul_f32 v79, v111, v79
    v_cvt_pk_bf16_f32 v64, v64, v65
    v_cvt_pk_bf16_f32 v65, v66, v67
    v_cvt_pk_bf16_f32 v66, v68, v69
    v_cvt_pk_bf16_f32 v67, v70, v71
    v_cvt_pk_bf16_f32 v68, v72, v73
    v_cvt_pk_bf16_f32 v69, v74, v75
    v_cvt_pk_bf16_f32 v70, v76, v77
    v_cvt_pk_bf16_f32 v71, v78, v79
    s_add_u32 s31, s30, 0
    buffer_store_dwordx4 v[64:67], v21, s[20:23], s31 offen sc0 sc1
    buffer_store_dwordx4 v[68:71], v21, s[20:23], s31 offen offset:1024 sc0 sc1

    v_mul_f32 v80, v96, v80
    v_mul_f32 v81, v97, v81
    v_mul_f32 v82, v98, v82
    v_mul_f32 v83, v99, v83
    v_mul_f32 v84, v100, v84
    v_mul_f32 v85, v101, v85
    v_mul_f32 v86, v102, v86
    v_mul_f32 v87, v103, v87
    v_mul_f32 v88, v104, v88
    v_mul_f32 v89, v105, v89
    v_mul_f32 v90, v106, v90
    v_mul_f32 v91, v107, v91
    v_mul_f32 v92, v108, v92
    v_mul_f32 v93, v109, v93
    v_mul_f32 v94, v110, v94
    v_mul_f32 v95, v111, v95
    v_cvt_pk_bf16_f32 v80, v80, v81
    v_cvt_pk_bf16_f32 v81, v82, v83
    v_cvt_pk_bf16_f32 v82, v84, v85
    v_cvt_pk_bf16_f32 v83, v86, v87
    v_cvt_pk_bf16_f32 v84, v88, v89
    v_cvt_pk_bf16_f32 v85, v90, v91
    v_cvt_pk_bf16_f32 v86, v92, v93
    v_cvt_pk_bf16_f32 v87, v94, v95
    s_add_u32 s31, s30, 2048
    buffer_store_dwordx4 v[80:83], v21, s[20:23], s31 offen sc0 sc1
    buffer_store_dwordx4 v[84:87], v21, s[20:23], s31 offen offset:1024 sc0 sc1

    s_nop 1
    s_cmp_lg_u32 s41, 0
    s_cbranch_scc1 K1_done
    s_nop 15
    s_add_u32 s30, s14, 80
    s_lshl_b32 s30, s30, 16
    s_add_u32 s30, s30, 8388608
    v_mul_f32 v38, 0xbfb8aa3b, v24
    v_mul_f32 v39, v24, v24

    v_mul_f32 v40, v38, v112
    v_mul_f32 v41, v38, v113
    v_mul_f32 v42, v38, v114
    v_mul_f32 v43, v38, v115
    v_mul_f32 v44, v38, v116
    v_mul_f32 v45, v38, v117
    v_mul_f32 v46, v38, v118
    v_mul_f32 v47, v38, v119
    v_exp_f32 v40, v40
    v_exp_f32 v41, v41
    v_exp_f32 v42, v42
    v_exp_f32 v43, v43
    v_exp_f32 v44, v44
    v_exp_f32 v45, v45
    v_exp_f32 v46, v46
    v_exp_f32 v47, v47
    v_mul_f32 v112, v112, v120
    v_mul_f32 v113, v113, v121
    v_mul_f32 v114, v114, v122
    v_mul_f32 v115, v115, v123
    v_mul_f32 v116, v116, v124
    v_mul_f32 v117, v117, v125
    v_mul_f32 v118, v118, v126
    v_mul_f32 v119, v119, v127
    v_add_f32 v40, 1.0, v40
    v_add_f32 v41, 1.0, v41
    v_add_f32 v42, 1.0, v42
    v_add_f32 v43, 1.0, v43
    v_add_f32 v44, 1.0, v44
    v_add_f32 v45, 1.0, v45
    v_add_f32 v46, 1.0, v46
    v_add_f32 v47, 1.0, v47
    v_rcp_f32 v40, v40
    v_rcp_f32 v41, v41
    v_rcp_f32 v42, v42
    v_rcp_f32 v43, v43
    v_rcp_f32 v44, v44
    v_rcp_f32 v45, v45
    v_rcp_f32 v46, v46
    v_rcp_f32 v47, v47
    v_mul_f32 v112, v39, v112
    v_mul_f32 v113, v39, v113
    v_mul_f32 v114, v39, v114
    v_mul_f32 v115, v39, v115
    v_mul_f32 v116, v39, v116
    v_mul_f32 v117, v39, v117
    v_mul_f32 v118, v39, v118
    v_mul_f32 v119, v39, v119
    v_mul_f32 v112, v40, v112
    v_mul_f32 v113, v41, v113
    v_mul_f32 v114, v42, v114
    v_mul_f32 v115, v43, v115
    v_mul_f32 v116, v44, v116
    v_mul_f32 v117, v45, v117
    v_mul_f32 v118, v46, v118
    v_mul_f32 v119, v47, v119
    v_cvt_pk_bf16_f32 v112, v112, v113
    v_cvt_pk_bf16_f32 v113, v114, v115
    v_cvt_pk_bf16_f32 v114, v116, v117
    v_cvt_pk_bf16_f32 v115, v118, v119
    s_add_u32 s31, s30, 0
    s_nop 1
    v_permlane32_swap_b32 v112, v114
    v_permlane32_swap_b32 v113, v115
    buffer_store_dwordx4 v[112:115], v22, s[20:23], s31 offen sc0 sc1

    s_nop 1
    s_branch K1_done
K1_ffn:
    s_mul_i32 s30, s34, 2752
    s_sub_u32 s31, s14, 6
    s_lshl_b32 s31, s31, 8
    s_add_u32 s30, s30, s31
    s_add_u32 s30, s30, 0

    s_add_u32 s31, s33, 131072
    s_mov_b32 m0, s31
    v_add_co_u32 v14, vcc, s30, v10
    s_add_u32 s30, s30, 11008
    s_nop 0
    v_addc_co_u32 v15, vcc, 0, v11, vcc
    global_load_lds_dwordx4 v[14:15], off

    s_add_u32 s31, s33, 132096
    s_mov_b32 m0, s31
    v_add_co_u32 v14, vcc, s30, v10
    s_add_u32 s30, s30, 11008
    s_nop 0
    v_addc_co_u32 v15, vcc, 0, v11, vcc
    global_load_lds_dwordx4 v[14:15], off

    s_add_u32 s31, s33, 133120
    s_mov_b32 m0, s31
    v_add_co_u32 v14, vcc, s30, v10
    s_add_u32 s30, s30, 11008
    s_nop 0
    v_addc_co_u32 v15, vcc, 0, v11, vcc
    global_load_lds_dwordx4 v[14:15], off

    s_add_u32 s31, s33, 134144
    s_mov_b32 m0, s31
    v_add_co_u32 v14, vcc, s30, v10
    s_add_u32 s30, s30, 11008
    s_nop 0
    v_addc_co_u32 v15, vcc, 0, v11, vcc
    global_load_lds_dwordx4 v[14:15], off

    v_and_b32 v6, 15, v3
    v_lshlrev_b32 v7, 10, v3
    v_add_u32 v7, s29, v7

    v_add_u32 v8, 0, v4
    v_xor_b32 v8, v8, v6
    v_lshl_add_u32 v16, v8, 4, v7

    v_add_u32 v8, 2, v4
    v_xor_b32 v8, v8, v6
    v_lshl_add_u32 v17, v8, 4, v7

    v_add_u32 v8, 4, v4
    v_xor_b32 v8, v8, v6
    v_lshl_add_u32 v18, v8, 4, v7

    v_add_u32 v8, 6, v4
    v_xor_b32 v8, v8, v6
    v_lshl_add_u32 v19, v8, 4, v7

    v_add_u32 v8, 8, v4
    v_xor_b32 v8, v8, v6
    v_lshl_add_u32 v20, v8, 4, v7

    v_add_u32 v8, 10, v4
    v_xor_b32 v8, v8, v6
    v_lshl_add_u32 v21, v8, 4, v7

    v_add_u32 v8, 12, v4
    v_xor_b32 v8, v8, v6
    v_lshl_add_u32 v22, v8, 4, v7

    v_add_u32 v8, 14, v4
    v_xor_b32 v8, v8, v6
    v_lshl_add_u32 v23, v8, 4, v7

    s_waitcnt vmcnt(4)
    s_barrier
    ds_read_b128 v[128:131], v16 offset:0
    ds_read_b128 v[132:135], v17 offset:0
    ds_read_b128 v[136:139], v18 offset:0
    ds_read_b128 v[140:143], v19 offset:0
    ds_read_b128 v[144:147], v20 offset:0
    ds_read_b128 v[148:151], v21 offset:0
    ds_read_b128 v[152:155], v22 offset:0
    ds_read_b128 v[156:159], v23 offset:0
    s_waitcnt lgkmcnt(0)
    ds_read_b128 v[160:163], v16 offset:256
    ds_read_b128 v[164:167], v17 offset:256
    ds_read_b128 v[168:171], v18 offset:256
    ds_read_b128 v[172:175], v19 offset:256
    ds_read_b128 v[176:179], v20 offset:256
    ds_read_b128 v[180:183], v21 offset:256
    ds_read_b128 v[184:187], v22 offset:256
    ds_read_b128 v[188:191], v23 offset:256
    s_waitcnt lgkmcnt(0)
    ds_read_b128 v[192:195], v16 offset:512
    ds_read_b128 v[196:199], v17 offset:512
    ds_read_b128 v[200:203], v18 offset:512
    ds_read_b128 v[204:207], v19 offset:512
    ds_read_b128 v[208:211], v20 offset:512
    ds_read_b128 v[212:215], v21 offset:512
    ds_read_b128 v[216:219], v22 offset:512
    ds_read_b128 v[220:223], v23 offset:512
    s_waitcnt lgkmcnt(0)
    ds_read_b128 v[224:227], v16 offset:768
    ds_read_b128 v[228:231], v17 offset:768
    ds_read_b128 v[232:235], v18 offset:768
    ds_read_b128 v[236:239], v19 offset:768
    ds_read_b128 v[240:243], v20 offset:768
    ds_read_b128 v[244:247], v21 offset:768
    ds_read_b128 v[248:251], v22 offset:768
    ds_read_b128 v[252:255], v23 offset:768
    s_waitcnt lgkmcnt(0)
    s_barrier
    v_mov_b32 v20, 0x3f803f80
    v_mov_b32 v21, 0
    v_mov_b32 v22, 0
    v_mov_b32 v25, 0x00003f80
    v_mov_b32 v26, 0x3f800000

    v_dot2_f32_bf16 v21, v128, v20, v21
    v_dot2_f32_bf16 v22, v129, v20, v22
    v_dot2_f32_bf16 v21, v130, v20, v21
    v_dot2_f32_bf16 v22, v131, v20, v22
    v_dot2_f32_bf16 v21, v132, v20, v21
    v_dot2_f32_bf16 v22, v133, v20, v22
    v_dot2_f32_bf16 v21, v134, v20, v21
    v_dot2_f32_bf16 v22, v135, v20, v22
    v_dot2_f32_bf16 v21, v136, v20, v21
    v_dot2_f32_bf16 v22, v137, v20, v22
    v_dot2_f32_bf16 v21, v138, v20, v21
    v_dot2_f32_bf16 v22, v139, v20, v22
    v_dot2_f32_bf16 v21, v140, v20, v21
    v_dot2_f32_bf16 v22, v141, v20, v22
    v_dot2_f32_bf16 v21, v142, v20, v21
    v_dot2_f32_bf16 v22, v143, v20, v22
    v_dot2_f32_bf16 v21, v144, v20, v21
    v_dot2_f32_bf16 v22, v145, v20, v22
    v_dot2_f32_bf16 v21, v146, v20, v21
    v_dot2_f32_bf16 v22, v147, v20, v22
    v_dot2_f32_bf16 v21, v148, v20, v21
    v_dot2_f32_bf16 v22, v149, v20, v22
    v_dot2_f32_bf16 v21, v150, v20, v21
    v_dot2_f32_bf16 v22, v151, v20, v22
    v_dot2_f32_bf16 v21, v152, v20, v21
    v_dot2_f32_bf16 v22, v153, v20, v22
    v_dot2_f32_bf16 v21, v154, v20, v21
    v_dot2_f32_bf16 v22, v155, v20, v22
    v_dot2_f32_bf16 v21, v156, v20, v21
    v_dot2_f32_bf16 v22, v157, v20, v22
    v_dot2_f32_bf16 v21, v158, v20, v21
    v_dot2_f32_bf16 v22, v159, v20, v22
    s_mul_i32 s56, s34, 2752
    s_sub_u32 s57, s14, 6
    s_lshl_b32 s57, s57, 8
    s_add_u32 s56, s56, s57
    s_add_u32 s56, s56, 352256
    s_add_u32 s57, s33, 0
    s_mov_b32 m0, s57
    v_add_co_u32 v14, vcc, s56, v10
    s_nop 1
    v_addc_co_u32 v15, vcc, 0, v11, vcc
    global_load_lds_dwordx4 v[14:15], off

    v_dot2_f32_bf16 v21, v160, v20, v21
    v_dot2_f32_bf16 v22, v161, v20, v22
    v_dot2_f32_bf16 v21, v162, v20, v21
    v_dot2_f32_bf16 v22, v163, v20, v22
    v_dot2_f32_bf16 v21, v164, v20, v21
    v_dot2_f32_bf16 v22, v165, v20, v22
    v_dot2_f32_bf16 v21, v166, v20, v21
    v_dot2_f32_bf16 v22, v167, v20, v22
    v_dot2_f32_bf16 v21, v168, v20, v21
    v_dot2_f32_bf16 v22, v169, v20, v22
    v_dot2_f32_bf16 v21, v170, v20, v21
    v_dot2_f32_bf16 v22, v171, v20, v22
    v_dot2_f32_bf16 v21, v172, v20, v21
    v_dot2_f32_bf16 v22, v173, v20, v22
    v_dot2_f32_bf16 v21, v174, v20, v21
    v_dot2_f32_bf16 v22, v175, v20, v22
    v_dot2_f32_bf16 v21, v176, v20, v21
    v_dot2_f32_bf16 v22, v177, v20, v22
    v_dot2_f32_bf16 v21, v178, v20, v21
    v_dot2_f32_bf16 v22, v179, v20, v22
    v_dot2_f32_bf16 v21, v180, v20, v21
    v_dot2_f32_bf16 v22, v181, v20, v22
    v_dot2_f32_bf16 v21, v182, v20, v21
    v_dot2_f32_bf16 v22, v183, v20, v22
    v_dot2_f32_bf16 v21, v184, v20, v21
    v_dot2_f32_bf16 v22, v185, v20, v22
    v_dot2_f32_bf16 v21, v186, v20, v21
    v_dot2_f32_bf16 v22, v187, v20, v22
    v_dot2_f32_bf16 v21, v188, v20, v21
    v_dot2_f32_bf16 v22, v189, v20, v22
    v_dot2_f32_bf16 v21, v190, v20, v21
    v_dot2_f32_bf16 v22, v191, v20, v22
    s_mul_i32 s56, s34, 2752
    s_sub_u32 s57, s14, 6
    s_lshl_b32 s57, s57, 8
    s_add_u32 s56, s56, s57
    s_add_u32 s56, s56, 363264
    s_add_u32 s57, s33, 1024
    s_mov_b32 m0, s57
    v_add_co_u32 v14, vcc, s56, v10
    s_nop 1
    v_addc_co_u32 v15, vcc, 0, v11, vcc
    global_load_lds_dwordx4 v[14:15], off

    v_dot2_f32_bf16 v21, v192, v20, v21
    v_dot2_f32_bf16 v22, v193, v20, v22
    v_dot2_f32_bf16 v21, v194, v20, v21
    v_dot2_f32_bf16 v22, v195, v20, v22
    v_dot2_f32_bf16 v21, v196, v20, v21
    v_dot2_f32_bf16 v22, v197, v20, v22
    v_dot2_f32_bf16 v21, v198, v20, v21
    v_dot2_f32_bf16 v22, v199, v20, v22
    v_dot2_f32_bf16 v21, v200, v20, v21
    v_dot2_f32_bf16 v22, v201, v20, v22
    v_dot2_f32_bf16 v21, v202, v20, v21
    v_dot2_f32_bf16 v22, v203, v20, v22
    v_dot2_f32_bf16 v21, v204, v20, v21
    v_dot2_f32_bf16 v22, v205, v20, v22
    v_dot2_f32_bf16 v21, v206, v20, v21
    v_dot2_f32_bf16 v22, v207, v20, v22
    v_dot2_f32_bf16 v21, v208, v20, v21
    v_dot2_f32_bf16 v22, v209, v20, v22
    v_dot2_f32_bf16 v21, v210, v20, v21
    v_dot2_f32_bf16 v22, v211, v20, v22
    v_dot2_f32_bf16 v21, v212, v20, v21
    v_dot2_f32_bf16 v22, v213, v20, v22
    v_dot2_f32_bf16 v21, v214, v20, v21
    v_dot2_f32_bf16 v22, v215, v20, v22
    v_dot2_f32_bf16 v21, v216, v20, v21
    v_dot2_f32_bf16 v22, v217, v20, v22
    v_dot2_f32_bf16 v21, v218, v20, v21
    v_dot2_f32_bf16 v22, v219, v20, v22
    v_dot2_f32_bf16 v21, v220, v20, v21
    v_dot2_f32_bf16 v22, v221, v20, v22
    v_dot2_f32_bf16 v21, v222, v20, v21
    v_dot2_f32_bf16 v22, v223, v20, v22
    s_mul_i32 s56, s34, 2752
    s_sub_u32 s57, s14, 6
    s_lshl_b32 s57, s57, 8
    s_add_u32 s56, s56, s57
    s_add_u32 s56, s56, 374272
    s_add_u32 s57, s33, 2048
    s_mov_b32 m0, s57
    v_add_co_u32 v14, vcc, s56, v10
    s_nop 1
    v_addc_co_u32 v15, vcc, 0, v11, vcc
    global_load_lds_dwordx4 v[14:15], off

    v_dot2_f32_bf16 v21, v224, v20, v21
    v_dot2_f32_bf16 v22, v225, v20, v22
    v_dot2_f32_bf16 v21, v226, v20, v21
    v_dot2_f32_bf16 v22, v227, v20, v22
    v_dot2_f32_bf16 v21, v228, v20, v21
    v_dot2_f32_bf16 v22, v229, v20, v22
    v_dot2_f32_bf16 v21, v230, v20, v21
    v_dot2_f32_bf16 v22, v231, v20, v22
    v_dot2_f32_bf16 v21, v232, v20, v21
    v_dot2_f32_bf16 v22, v233, v20, v22
    v_dot2_f32_bf16 v21, v234, v20, v21
    v_dot2_f32_bf16 v22, v235, v20, v22
    v_dot2_f32_bf16 v21, v236, v20, v21
    v_dot2_f32_bf16 v22, v237, v20, v22
    v_dot2_f32_bf16 v21, v238, v20, v21
    v_dot2_f32_bf16 v22, v239, v20, v22
    v_dot2_f32_bf16 v21, v240, v20, v21
    v_dot2_f32_bf16 v22, v241, v20, v22
    v_dot2_f32_bf16 v21, v242, v20, v21
    v_dot2_f32_bf16 v22, v243, v20, v22
    v_dot2_f32_bf16 v21, v244, v20, v21
    v_dot2_f32_bf16 v22, v245, v20, v22
    v_dot2_f32_bf16 v21, v246, v20, v21
    v_dot2_f32_bf16 v22, v247, v20, v22
    v_dot2_f32_bf16 v21, v248, v20, v21
    v_dot2_f32_bf16 v22, v249, v20, v22
    v_dot2_f32_bf16 v21, v250, v20, v21
    v_dot2_f32_bf16 v22, v251, v20, v22
    v_dot2_f32_bf16 v21, v252, v20, v21
    v_dot2_f32_bf16 v22, v253, v20, v22
    v_dot2_f32_bf16 v21, v254, v20, v21
    v_dot2_f32_bf16 v22, v255, v20, v22
    s_mul_i32 s56, s34, 2752
    s_sub_u32 s57, s14, 6
    s_lshl_b32 s57, s57, 8
    s_add_u32 s56, s56, s57
    s_add_u32 s56, s56, 385280
    s_add_u32 s57, s33, 3072
    s_mov_b32 m0, s57
    v_add_co_u32 v14, vcc, s56, v10
    s_nop 1
    v_addc_co_u32 v15, vcc, 0, v11, vcc
    global_load_lds_dwordx4 v[14:15], off

    s_nop 3
    v_add_f32 v21, v21, v22
    v_mov_b32 v22, v21
    s_nop 1
    v_permlane32_swap_b32 v21, v22
    s_nop 1
    v_add_f32 v21, v21, v22
    v_mul_f32 v21, 0x3b000000, v21
    v_cvt_pk_bf16_f32 v22, v21, v21
    v_and_b32 v22, 0xffff0000, v22
    v_sub_f32 v23, v21, v22
    v_sub_f32 v22, 0, v22
    v_mov_b32 v24, 0
    v_mov_b32 v27, 0

    v_dot2_f32_bf16 v28, v128, v25, v22
    v_dot2_f32_bf16 v29, v128, v26, v22
    v_dot2_f32_bf16 v30, v129, v25, v22
    v_dot2_f32_bf16 v31, v129, v26, v22
    v_dot2_f32_bf16 v32, v130, v25, v22
    v_dot2_f32_bf16 v33, v130, v26, v22
    v_dot2_f32_bf16 v34, v131, v25, v22
    v_dot2_f32_bf16 v35, v131, v26, v22
    v_cvt_pk_bf16_f32 v128, v28, v29
    v_cvt_pk_bf16_f32 v129, v30, v31
    v_cvt_pk_bf16_f32 v130, v32, v33
    v_cvt_pk_bf16_f32 v131, v34, v35
    v_fmac_f32 v24, v28, v28
    v_fmac_f32 v27, v29, v29
    v_fmac_f32 v24, v30, v30
    v_fmac_f32 v27, v31, v31
    v_fmac_f32 v24, v32, v32
    v_fmac_f32 v27, v33, v33
    v_fmac_f32 v24, v34, v34
    v_fmac_f32 v27, v35, v35
    v_dot2_f32_bf16 v28, v132, v25, v22
    v_dot2_f32_bf16 v29, v132, v26, v22
    v_dot2_f32_bf16 v30, v133, v25, v22
    v_dot2_f32_bf16 v31, v133, v26, v22
    v_dot2_f32_bf16 v32, v134, v25, v22
    v_dot2_f32_bf16 v33, v134, v26, v22
    v_dot2_f32_bf16 v34, v135, v25, v22
    v_dot2_f32_bf16 v35, v135, v26, v22
    v_cvt_pk_bf16_f32 v132, v28, v29
    v_cvt_pk_bf16_f32 v133, v30, v31
    v_cvt_pk_bf16_f32 v134, v32, v33
    v_cvt_pk_bf16_f32 v135, v34, v35
    v_fmac_f32 v24, v28, v28
    v_fmac_f32 v27, v29, v29
    v_fmac_f32 v24, v30, v30
    v_fmac_f32 v27, v31, v31
    v_fmac_f32 v24, v32, v32
    v_fmac_f32 v27, v33, v33
    v_fmac_f32 v24, v34, v34
    v_fmac_f32 v27, v35, v35
    v_dot2_f32_bf16 v28, v136, v25, v22
    v_dot2_f32_bf16 v29, v136, v26, v22
    v_dot2_f32_bf16 v30, v137, v25, v22
    v_dot2_f32_bf16 v31, v137, v26, v22
    v_dot2_f32_bf16 v32, v138, v25, v22
    v_dot2_f32_bf16 v33, v138, v26, v22
    v_dot2_f32_bf16 v34, v139, v25, v22
    v_dot2_f32_bf16 v35, v139, v26, v22
    v_cvt_pk_bf16_f32 v136, v28, v29
    v_cvt_pk_bf16_f32 v137, v30, v31
    v_cvt_pk_bf16_f32 v138, v32, v33
    v_cvt_pk_bf16_f32 v139, v34, v35
    v_fmac_f32 v24, v28, v28
    v_fmac_f32 v27, v29, v29
    v_fmac_f32 v24, v30, v30
    v_fmac_f32 v27, v31, v31
    v_fmac_f32 v24, v32, v32
    v_fmac_f32 v27, v33, v33
    v_fmac_f32 v24, v34, v34
    v_fmac_f32 v27, v35, v35
    v_dot2_f32_bf16 v28, v140, v25, v22
    v_dot2_f32_bf16 v29, v140, v26, v22
    v_dot2_f32_bf16 v30, v141, v25, v22
    v_dot2_f32_bf16 v31, v141, v26, v22
    v_dot2_f32_bf16 v32, v142, v25, v22
    v_dot2_f32_bf16 v33, v142, v26, v22
    v_dot2_f32_bf16 v34, v143, v25, v22
    v_dot2_f32_bf16 v35, v143, v26, v22
    v_cvt_pk_bf16_f32 v140, v28, v29
    v_cvt_pk_bf16_f32 v141, v30, v31
    v_cvt_pk_bf16_f32 v142, v32, v33
    v_cvt_pk_bf16_f32 v143, v34, v35
    v_fmac_f32 v24, v28, v28
    v_fmac_f32 v27, v29, v29
    v_fmac_f32 v24, v30, v30
    v_fmac_f32 v27, v31, v31
    v_fmac_f32 v24, v32, v32
    v_fmac_f32 v27, v33, v33
    v_fmac_f32 v24, v34, v34
    v_fmac_f32 v27, v35, v35
    s_mul_i32 s56, s34, 2752
    s_sub_u32 s57, s14, 6
    s_lshl_b32 s57, s57, 8
    s_add_u32 s56, s56, s57
    s_add_u32 s56, s56, 704512
    s_add_u32 s57, s33, 32768
    s_mov_b32 m0, s57
    v_add_co_u32 v14, vcc, s56, v10
    s_nop 1
    v_addc_co_u32 v15, vcc, 0, v11, vcc
    global_load_lds_dwordx4 v[14:15], off

    v_dot2_f32_bf16 v28, v144, v25, v22
    v_dot2_f32_bf16 v29, v144, v26, v22
    v_dot2_f32_bf16 v30, v145, v25, v22
    v_dot2_f32_bf16 v31, v145, v26, v22
    v_dot2_f32_bf16 v32, v146, v25, v22
    v_dot2_f32_bf16 v33, v146, v26, v22
    v_dot2_f32_bf16 v34, v147, v25, v22
    v_dot2_f32_bf16 v35, v147, v26, v22
    v_cvt_pk_bf16_f32 v144, v28, v29
    v_cvt_pk_bf16_f32 v145, v30, v31
    v_cvt_pk_bf16_f32 v146, v32, v33
    v_cvt_pk_bf16_f32 v147, v34, v35
    v_fmac_f32 v24, v28, v28
    v_fmac_f32 v27, v29, v29
    v_fmac_f32 v24, v30, v30
    v_fmac_f32 v27, v31, v31
    v_fmac_f32 v24, v32, v32
    v_fmac_f32 v27, v33, v33
    v_fmac_f32 v24, v34, v34
    v_fmac_f32 v27, v35, v35
    v_dot2_f32_bf16 v28, v148, v25, v22
    v_dot2_f32_bf16 v29, v148, v26, v22
    v_dot2_f32_bf16 v30, v149, v25, v22
    v_dot2_f32_bf16 v31, v149, v26, v22
    v_dot2_f32_bf16 v32, v150, v25, v22
    v_dot2_f32_bf16 v33, v150, v26, v22
    v_dot2_f32_bf16 v34, v151, v25, v22
    v_dot2_f32_bf16 v35, v151, v26, v22
    v_cvt_pk_bf16_f32 v148, v28, v29
    v_cvt_pk_bf16_f32 v149, v30, v31
    v_cvt_pk_bf16_f32 v150, v32, v33
    v_cvt_pk_bf16_f32 v151, v34, v35
    v_fmac_f32 v24, v28, v28
    v_fmac_f32 v27, v29, v29
    v_fmac_f32 v24, v30, v30
    v_fmac_f32 v27, v31, v31
    v_fmac_f32 v24, v32, v32
    v_fmac_f32 v27, v33, v33
    v_fmac_f32 v24, v34, v34
    v_fmac_f32 v27, v35, v35
    v_dot2_f32_bf16 v28, v152, v25, v22
    v_dot2_f32_bf16 v29, v152, v26, v22
    v_dot2_f32_bf16 v30, v153, v25, v22
    v_dot2_f32_bf16 v31, v153, v26, v22
    v_dot2_f32_bf16 v32, v154, v25, v22
    v_dot2_f32_bf16 v33, v154, v26, v22
    v_dot2_f32_bf16 v34, v155, v25, v22
    v_dot2_f32_bf16 v35, v155, v26, v22
    v_cvt_pk_bf16_f32 v152, v28, v29
    v_cvt_pk_bf16_f32 v153, v30, v31
    v_cvt_pk_bf16_f32 v154, v32, v33
    v_cvt_pk_bf16_f32 v155, v34, v35
    v_fmac_f32 v24, v28, v28
    v_fmac_f32 v27, v29, v29
    v_fmac_f32 v24, v30, v30
    v_fmac_f32 v27, v31, v31
    v_fmac_f32 v24, v32, v32
    v_fmac_f32 v27, v33, v33
    v_fmac_f32 v24, v34, v34
    v_fmac_f32 v27, v35, v35
    v_dot2_f32_bf16 v28, v156, v25, v22
    v_dot2_f32_bf16 v29, v156, v26, v22
    v_dot2_f32_bf16 v30, v157, v25, v22
    v_dot2_f32_bf16 v31, v157, v26, v22
    v_dot2_f32_bf16 v32, v158, v25, v22
    v_dot2_f32_bf16 v33, v158, v26, v22
    v_dot2_f32_bf16 v34, v159, v25, v22
    v_dot2_f32_bf16 v35, v159, v26, v22
    v_cvt_pk_bf16_f32 v156, v28, v29
    v_cvt_pk_bf16_f32 v157, v30, v31
    v_cvt_pk_bf16_f32 v158, v32, v33
    v_cvt_pk_bf16_f32 v159, v34, v35
    v_fmac_f32 v24, v28, v28
    v_fmac_f32 v27, v29, v29
    v_fmac_f32 v24, v30, v30
    v_fmac_f32 v27, v31, v31
    v_fmac_f32 v24, v32, v32
    v_fmac_f32 v27, v33, v33
    v_fmac_f32 v24, v34, v34
    v_fmac_f32 v27, v35, v35
    s_mul_i32 s56, s34, 2752
    s_sub_u32 s57, s14, 6
    s_lshl_b32 s57, s57, 8
    s_add_u32 s56, s56, s57
    s_add_u32 s56, s56, 715520
    s_add_u32 s57, s33, 33792
    s_mov_b32 m0, s57
    v_add_co_u32 v14, vcc, s56, v10
    s_nop 1
    v_addc_co_u32 v15, vcc, 0, v11, vcc
    global_load_lds_dwordx4 v[14:15], off

    v_dot2_f32_bf16 v28, v160, v25, v22
    v_dot2_f32_bf16 v29, v160, v26, v22
    v_dot2_f32_bf16 v30, v161, v25, v22
    v_dot2_f32_bf16 v31, v161, v26, v22
    v_dot2_f32_bf16 v32, v162, v25, v22
    v_dot2_f32_bf16 v33, v162, v26, v22
    v_dot2_f32_bf16 v34, v163, v25, v22
    v_dot2_f32_bf16 v35, v163, v26, v22
    v_cvt_pk_bf16_f32 v160, v28, v29
    v_cvt_pk_bf16_f32 v161, v30, v31
    v_cvt_pk_bf16_f32 v162, v32, v33
    v_cvt_pk_bf16_f32 v163, v34, v35
    v_fmac_f32 v24, v28, v28
    v_fmac_f32 v27, v29, v29
    v_fmac_f32 v24, v30, v30
    v_fmac_f32 v27, v31, v31
    v_fmac_f32 v24, v32, v32
    v_fmac_f32 v27, v33, v33
    v_fmac_f32 v24, v34, v34
    v_fmac_f32 v27, v35, v35
    v_dot2_f32_bf16 v28, v164, v25, v22
    v_dot2_f32_bf16 v29, v164, v26, v22
    v_dot2_f32_bf16 v30, v165, v25, v22
    v_dot2_f32_bf16 v31, v165, v26, v22
    v_dot2_f32_bf16 v32, v166, v25, v22
    v_dot2_f32_bf16 v33, v166, v26, v22
    v_dot2_f32_bf16 v34, v167, v25, v22
    v_dot2_f32_bf16 v35, v167, v26, v22
    v_cvt_pk_bf16_f32 v164, v28, v29
    v_cvt_pk_bf16_f32 v165, v30, v31
    v_cvt_pk_bf16_f32 v166, v32, v33
    v_cvt_pk_bf16_f32 v167, v34, v35
    v_fmac_f32 v24, v28, v28
    v_fmac_f32 v27, v29, v29
    v_fmac_f32 v24, v30, v30
    v_fmac_f32 v27, v31, v31
    v_fmac_f32 v24, v32, v32
    v_fmac_f32 v27, v33, v33
    v_fmac_f32 v24, v34, v34
    v_fmac_f32 v27, v35, v35
    v_dot2_f32_bf16 v28, v168, v25, v22
    v_dot2_f32_bf16 v29, v168, v26, v22
    v_dot2_f32_bf16 v30, v169, v25, v22
    v_dot2_f32_bf16 v31, v169, v26, v22
    v_dot2_f32_bf16 v32, v170, v25, v22
    v_dot2_f32_bf16 v33, v170, v26, v22
    v_dot2_f32_bf16 v34, v171, v25, v22
    v_dot2_f32_bf16 v35, v171, v26, v22
    v_cvt_pk_bf16_f32 v168, v28, v29
    v_cvt_pk_bf16_f32 v169, v30, v31
    v_cvt_pk_bf16_f32 v170, v32, v33
    v_cvt_pk_bf16_f32 v171, v34, v35
    v_fmac_f32 v24, v28, v28
    v_fmac_f32 v27, v29, v29
    v_fmac_f32 v24, v30, v30
    v_fmac_f32 v27, v31, v31
    v_fmac_f32 v24, v32, v32
    v_fmac_f32 v27, v33, v33
    v_fmac_f32 v24, v34, v34
    v_fmac_f32 v27, v35, v35
    v_dot2_f32_bf16 v28, v172, v25, v22
    v_dot2_f32_bf16 v29, v172, v26, v22
    v_dot2_f32_bf16 v30, v173, v25, v22
    v_dot2_f32_bf16 v31, v173, v26, v22
    v_dot2_f32_bf16 v32, v174, v25, v22
    v_dot2_f32_bf16 v33, v174, v26, v22
    v_dot2_f32_bf16 v34, v175, v25, v22
    v_dot2_f32_bf16 v35, v175, v26, v22
    v_cvt_pk_bf16_f32 v172, v28, v29
    v_cvt_pk_bf16_f32 v173, v30, v31
    v_cvt_pk_bf16_f32 v174, v32, v33
    v_cvt_pk_bf16_f32 v175, v34, v35
    v_fmac_f32 v24, v28, v28
    v_fmac_f32 v27, v29, v29
    v_fmac_f32 v24, v30, v30
    v_fmac_f32 v27, v31, v31
    v_fmac_f32 v24, v32, v32
    v_fmac_f32 v27, v33, v33
    v_fmac_f32 v24, v34, v34
    v_fmac_f32 v27, v35, v35
    s_mul_i32 s56, s34, 2752
    s_sub_u32 s57, s14, 6
    s_lshl_b32 s57, s57, 8
    s_add_u32 s56, s56, s57
    s_add_u32 s56, s56, 726528
    s_add_u32 s57, s33, 34816
    s_mov_b32 m0, s57
    v_add_co_u32 v14, vcc, s56, v10
    s_nop 1
    v_addc_co_u32 v15, vcc, 0, v11, vcc
    global_load_lds_dwordx4 v[14:15], off

    v_dot2_f32_bf16 v28, v176, v25, v22
    v_dot2_f32_bf16 v29, v176, v26, v22
    v_dot2_f32_bf16 v30, v177, v25, v22
    v_dot2_f32_bf16 v31, v177, v26, v22
    v_dot2_f32_bf16 v32, v178, v25, v22
    v_dot2_f32_bf16 v33, v178, v26, v22
    v_dot2_f32_bf16 v34, v179, v25, v22
    v_dot2_f32_bf16 v35, v179, v26, v22
    v_cvt_pk_bf16_f32 v176, v28, v29
    v_cvt_pk_bf16_f32 v177, v30, v31
    v_cvt_pk_bf16_f32 v178, v32, v33
    v_cvt_pk_bf16_f32 v179, v34, v35
    v_fmac_f32 v24, v28, v28
    v_fmac_f32 v27, v29, v29
    v_fmac_f32 v24, v30, v30
    v_fmac_f32 v27, v31, v31
    v_fmac_f32 v24, v32, v32
    v_fmac_f32 v27, v33, v33
    v_fmac_f32 v24, v34, v34
    v_fmac_f32 v27, v35, v35
    v_dot2_f32_bf16 v28, v180, v25, v22
    v_dot2_f32_bf16 v29, v180, v26, v22
    v_dot2_f32_bf16 v30, v181, v25, v22
    v_dot2_f32_bf16 v31, v181, v26, v22
    v_dot2_f32_bf16 v32, v182, v25, v22
    v_dot2_f32_bf16 v33, v182, v26, v22
    v_dot2_f32_bf16 v34, v183, v25, v22
    v_dot2_f32_bf16 v35, v183, v26, v22
    v_cvt_pk_bf16_f32 v180, v28, v29
    v_cvt_pk_bf16_f32 v181, v30, v31
    v_cvt_pk_bf16_f32 v182, v32, v33
    v_cvt_pk_bf16_f32 v183, v34, v35
    v_fmac_f32 v24, v28, v28
    v_fmac_f32 v27, v29, v29
    v_fmac_f32 v24, v30, v30
    v_fmac_f32 v27, v31, v31
    v_fmac_f32 v24, v32, v32
    v_fmac_f32 v27, v33, v33
    v_fmac_f32 v24, v34, v34
    v_fmac_f32 v27, v35, v35
    v_dot2_f32_bf16 v28, v184, v25, v22
    v_dot2_f32_bf16 v29, v184, v26, v22
    v_dot2_f32_bf16 v30, v185, v25, v22
    v_dot2_f32_bf16 v31, v185, v26, v22
    v_dot2_f32_bf16 v32, v186, v25, v22
    v_dot2_f32_bf16 v33, v186, v26, v22
    v_dot2_f32_bf16 v34, v187, v25, v22
    v_dot2_f32_bf16 v35, v187, v26, v22
    v_cvt_pk_bf16_f32 v184, v28, v29
    v_cvt_pk_bf16_f32 v185, v30, v31
    v_cvt_pk_bf16_f32 v186, v32, v33
    v_cvt_pk_bf16_f32 v187, v34, v35
    v_fmac_f32 v24, v28, v28
    v_fmac_f32 v27, v29, v29
    v_fmac_f32 v24, v30, v30
    v_fmac_f32 v27, v31, v31
    v_fmac_f32 v24, v32, v32
    v_fmac_f32 v27, v33, v33
    v_fmac_f32 v24, v34, v34
    v_fmac_f32 v27, v35, v35
    v_dot2_f32_bf16 v28, v188, v25, v22
    v_dot2_f32_bf16 v29, v188, v26, v22
    v_dot2_f32_bf16 v30, v189, v25, v22
    v_dot2_f32_bf16 v31, v189, v26, v22
    v_dot2_f32_bf16 v32, v190, v25, v22
    v_dot2_f32_bf16 v33, v190, v26, v22
    v_dot2_f32_bf16 v34, v191, v25, v22
    v_dot2_f32_bf16 v35, v191, v26, v22
    v_cvt_pk_bf16_f32 v188, v28, v29
    v_cvt_pk_bf16_f32 v189, v30, v31
    v_cvt_pk_bf16_f32 v190, v32, v33
    v_cvt_pk_bf16_f32 v191, v34, v35
    v_fmac_f32 v24, v28, v28
    v_fmac_f32 v27, v29, v29
    v_fmac_f32 v24, v30, v30
    v_fmac_f32 v27, v31, v31
    v_fmac_f32 v24, v32, v32
    v_fmac_f32 v27, v33, v33
    v_fmac_f32 v24, v34, v34
    v_fmac_f32 v27, v35, v35
    s_mul_i32 s56, s34, 2752
    s_sub_u32 s57, s14, 6
    s_lshl_b32 s57, s57, 8
    s_add_u32 s56, s56, s57
    s_add_u32 s56, s56, 737536
    s_add_u32 s57, s33, 35840
    s_mov_b32 m0, s57
    v_add_co_u32 v14, vcc, s56, v10
    s_nop 1
    v_addc_co_u32 v15, vcc, 0, v11, vcc
    global_load_lds_dwordx4 v[14:15], off

    v_dot2_f32_bf16 v28, v192, v25, v22
    v_dot2_f32_bf16 v29, v192, v26, v22
    v_dot2_f32_bf16 v30, v193, v25, v22
    v_dot2_f32_bf16 v31, v193, v26, v22
    v_dot2_f32_bf16 v32, v194, v25, v22
    v_dot2_f32_bf16 v33, v194, v26, v22
    v_dot2_f32_bf16 v34, v195, v25, v22
    v_dot2_f32_bf16 v35, v195, v26, v22
    v_cvt_pk_bf16_f32 v192, v28, v29
    v_cvt_pk_bf16_f32 v193, v30, v31
    v_cvt_pk_bf16_f32 v194, v32, v33
    v_cvt_pk_bf16_f32 v195, v34, v35
    v_fmac_f32 v24, v28, v28
    v_fmac_f32 v27, v29, v29
    v_fmac_f32 v24, v30, v30
    v_fmac_f32 v27, v31, v31
    v_fmac_f32 v24, v32, v32
    v_fmac_f32 v27, v33, v33
    v_fmac_f32 v24, v34, v34
    v_fmac_f32 v27, v35, v35
    v_dot2_f32_bf16 v28, v196, v25, v22
    v_dot2_f32_bf16 v29, v196, v26, v22
    v_dot2_f32_bf16 v30, v197, v25, v22
    v_dot2_f32_bf16 v31, v197, v26, v22
    v_dot2_f32_bf16 v32, v198, v25, v22
    v_dot2_f32_bf16 v33, v198, v26, v22
    v_dot2_f32_bf16 v34, v199, v25, v22
    v_dot2_f32_bf16 v35, v199, v26, v22
    v_cvt_pk_bf16_f32 v196, v28, v29
    v_cvt_pk_bf16_f32 v197, v30, v31
    v_cvt_pk_bf16_f32 v198, v32, v33
    v_cvt_pk_bf16_f32 v199, v34, v35
    v_fmac_f32 v24, v28, v28
    v_fmac_f32 v27, v29, v29
    v_fmac_f32 v24, v30, v30
    v_fmac_f32 v27, v31, v31
    v_fmac_f32 v24, v32, v32
    v_fmac_f32 v27, v33, v33
    v_fmac_f32 v24, v34, v34
    v_fmac_f32 v27, v35, v35
    v_dot2_f32_bf16 v28, v200, v25, v22
    v_dot2_f32_bf16 v29, v200, v26, v22
    v_dot2_f32_bf16 v30, v201, v25, v22
    v_dot2_f32_bf16 v31, v201, v26, v22
    v_dot2_f32_bf16 v32, v202, v25, v22
    v_dot2_f32_bf16 v33, v202, v26, v22
    v_dot2_f32_bf16 v34, v203, v25, v22
    v_dot2_f32_bf16 v35, v203, v26, v22
    v_cvt_pk_bf16_f32 v200, v28, v29
    v_cvt_pk_bf16_f32 v201, v30, v31
    v_cvt_pk_bf16_f32 v202, v32, v33
    v_cvt_pk_bf16_f32 v203, v34, v35
    v_fmac_f32 v24, v28, v28
    v_fmac_f32 v27, v29, v29
    v_fmac_f32 v24, v30, v30
    v_fmac_f32 v27, v31, v31
    v_fmac_f32 v24, v32, v32
    v_fmac_f32 v27, v33, v33
    v_fmac_f32 v24, v34, v34
    v_fmac_f32 v27, v35, v35
    v_dot2_f32_bf16 v28, v204, v25, v22
    v_dot2_f32_bf16 v29, v204, v26, v22
    v_dot2_f32_bf16 v30, v205, v25, v22
    v_dot2_f32_bf16 v31, v205, v26, v22
    v_dot2_f32_bf16 v32, v206, v25, v22
    v_dot2_f32_bf16 v33, v206, v26, v22
    v_dot2_f32_bf16 v34, v207, v25, v22
    v_dot2_f32_bf16 v35, v207, v26, v22
    v_cvt_pk_bf16_f32 v204, v28, v29
    v_cvt_pk_bf16_f32 v205, v30, v31
    v_cvt_pk_bf16_f32 v206, v32, v33
    v_cvt_pk_bf16_f32 v207, v34, v35
    v_fmac_f32 v24, v28, v28
    v_fmac_f32 v27, v29, v29
    v_fmac_f32 v24, v30, v30
    v_fmac_f32 v27, v31, v31
    v_fmac_f32 v24, v32, v32
    v_fmac_f32 v27, v33, v33
    v_fmac_f32 v24, v34, v34
    v_fmac_f32 v27, v35, v35
    s_mul_i32 s56, s34, 2752
    s_sub_u32 s57, s14, 6
    s_lshl_b32 s57, s57, 8
    s_add_u32 s56, s56, s57
    s_add_u32 s56, s56, 1056768
    s_add_u32 s57, s33, 65536
    s_mov_b32 m0, s57
    v_add_co_u32 v14, vcc, s56, v10
    s_nop 1
    v_addc_co_u32 v15, vcc, 0, v11, vcc
    global_load_lds_dwordx4 v[14:15], off

    v_dot2_f32_bf16 v28, v208, v25, v22
    v_dot2_f32_bf16 v29, v208, v26, v22
    v_dot2_f32_bf16 v30, v209, v25, v22
    v_dot2_f32_bf16 v31, v209, v26, v22
    v_dot2_f32_bf16 v32, v210, v25, v22
    v_dot2_f32_bf16 v33, v210, v26, v22
    v_dot2_f32_bf16 v34, v211, v25, v22
    v_dot2_f32_bf16 v35, v211, v26, v22
    v_cvt_pk_bf16_f32 v208, v28, v29
    v_cvt_pk_bf16_f32 v209, v30, v31
    v_cvt_pk_bf16_f32 v210, v32, v33
    v_cvt_pk_bf16_f32 v211, v34, v35
    v_fmac_f32 v24, v28, v28
    v_fmac_f32 v27, v29, v29
    v_fmac_f32 v24, v30, v30
    v_fmac_f32 v27, v31, v31
    v_fmac_f32 v24, v32, v32
    v_fmac_f32 v27, v33, v33
    v_fmac_f32 v24, v34, v34
    v_fmac_f32 v27, v35, v35
    v_dot2_f32_bf16 v28, v212, v25, v22
    v_dot2_f32_bf16 v29, v212, v26, v22
    v_dot2_f32_bf16 v30, v213, v25, v22
    v_dot2_f32_bf16 v31, v213, v26, v22
    v_dot2_f32_bf16 v32, v214, v25, v22
    v_dot2_f32_bf16 v33, v214, v26, v22
    v_dot2_f32_bf16 v34, v215, v25, v22
    v_dot2_f32_bf16 v35, v215, v26, v22
    v_cvt_pk_bf16_f32 v212, v28, v29
    v_cvt_pk_bf16_f32 v213, v30, v31
    v_cvt_pk_bf16_f32 v214, v32, v33
    v_cvt_pk_bf16_f32 v215, v34, v35
    v_fmac_f32 v24, v28, v28
    v_fmac_f32 v27, v29, v29
    v_fmac_f32 v24, v30, v30
    v_fmac_f32 v27, v31, v31
    v_fmac_f32 v24, v32, v32
    v_fmac_f32 v27, v33, v33
    v_fmac_f32 v24, v34, v34
    v_fmac_f32 v27, v35, v35
    v_dot2_f32_bf16 v28, v216, v25, v22
    v_dot2_f32_bf16 v29, v216, v26, v22
    v_dot2_f32_bf16 v30, v217, v25, v22
    v_dot2_f32_bf16 v31, v217, v26, v22
    v_dot2_f32_bf16 v32, v218, v25, v22
    v_dot2_f32_bf16 v33, v218, v26, v22
    v_dot2_f32_bf16 v34, v219, v25, v22
    v_dot2_f32_bf16 v35, v219, v26, v22
    v_cvt_pk_bf16_f32 v216, v28, v29
    v_cvt_pk_bf16_f32 v217, v30, v31
    v_cvt_pk_bf16_f32 v218, v32, v33
    v_cvt_pk_bf16_f32 v219, v34, v35
    v_fmac_f32 v24, v28, v28
    v_fmac_f32 v27, v29, v29
    v_fmac_f32 v24, v30, v30
    v_fmac_f32 v27, v31, v31
    v_fmac_f32 v24, v32, v32
    v_fmac_f32 v27, v33, v33
    v_fmac_f32 v24, v34, v34
    v_fmac_f32 v27, v35, v35
    v_dot2_f32_bf16 v28, v220, v25, v22
    v_dot2_f32_bf16 v29, v220, v26, v22
    v_dot2_f32_bf16 v30, v221, v25, v22
    v_dot2_f32_bf16 v31, v221, v26, v22
    v_dot2_f32_bf16 v32, v222, v25, v22
    v_dot2_f32_bf16 v33, v222, v26, v22
    v_dot2_f32_bf16 v34, v223, v25, v22
    v_dot2_f32_bf16 v35, v223, v26, v22
    v_cvt_pk_bf16_f32 v220, v28, v29
    v_cvt_pk_bf16_f32 v221, v30, v31
    v_cvt_pk_bf16_f32 v222, v32, v33
    v_cvt_pk_bf16_f32 v223, v34, v35
    v_fmac_f32 v24, v28, v28
    v_fmac_f32 v27, v29, v29
    v_fmac_f32 v24, v30, v30
    v_fmac_f32 v27, v31, v31
    v_fmac_f32 v24, v32, v32
    v_fmac_f32 v27, v33, v33
    v_fmac_f32 v24, v34, v34
    v_fmac_f32 v27, v35, v35
    s_mul_i32 s56, s34, 2752
    s_sub_u32 s57, s14, 6
    s_lshl_b32 s57, s57, 8
    s_add_u32 s56, s56, s57
    s_add_u32 s56, s56, 1067776
    s_add_u32 s57, s33, 66560
    s_mov_b32 m0, s57
    v_add_co_u32 v14, vcc, s56, v10
    s_nop 1
    v_addc_co_u32 v15, vcc, 0, v11, vcc
    global_load_lds_dwordx4 v[14:15], off

    v_dot2_f32_bf16 v28, v224, v25, v22
    v_dot2_f32_bf16 v29, v224, v26, v22
    v_dot2_f32_bf16 v30, v225, v25, v22
    v_dot2_f32_bf16 v31, v225, v26, v22
    v_dot2_f32_bf16 v32, v226, v25, v22
    v_dot2_f32_bf16 v33, v226, v26, v22
    v_dot2_f32_bf16 v34, v227, v25, v22
    v_dot2_f32_bf16 v35, v227, v26, v22
    v_cvt_pk_bf16_f32 v224, v28, v29
    v_cvt_pk_bf16_f32 v225, v30, v31
    v_cvt_pk_bf16_f32 v226, v32, v33
    v_cvt_pk_bf16_f32 v227, v34, v35
    v_fmac_f32 v24, v28, v28
    v_fmac_f32 v27, v29, v29
    v_fmac_f32 v24, v30, v30
    v_fmac_f32 v27, v31, v31
    v_fmac_f32 v24, v32, v32
    v_fmac_f32 v27, v33, v33
    v_fmac_f32 v24, v34, v34
    v_fmac_f32 v27, v35, v35
    v_dot2_f32_bf16 v28, v228, v25, v22
    v_dot2_f32_bf16 v29, v228, v26, v22
    v_dot2_f32_bf16 v30, v229, v25, v22
    v_dot2_f32_bf16 v31, v229, v26, v22
    v_dot2_f32_bf16 v32, v230, v25, v22
    v_dot2_f32_bf16 v33, v230, v26, v22
    v_dot2_f32_bf16 v34, v231, v25, v22
    v_dot2_f32_bf16 v35, v231, v26, v22
    v_cvt_pk_bf16_f32 v228, v28, v29
    v_cvt_pk_bf16_f32 v229, v30, v31
    v_cvt_pk_bf16_f32 v230, v32, v33
    v_cvt_pk_bf16_f32 v231, v34, v35
    v_fmac_f32 v24, v28, v28
    v_fmac_f32 v27, v29, v29
    v_fmac_f32 v24, v30, v30
    v_fmac_f32 v27, v31, v31
    v_fmac_f32 v24, v32, v32
    v_fmac_f32 v27, v33, v33
    v_fmac_f32 v24, v34, v34
    v_fmac_f32 v27, v35, v35
    v_dot2_f32_bf16 v28, v232, v25, v22
    v_dot2_f32_bf16 v29, v232, v26, v22
    v_dot2_f32_bf16 v30, v233, v25, v22
    v_dot2_f32_bf16 v31, v233, v26, v22
    v_dot2_f32_bf16 v32, v234, v25, v22
    v_dot2_f32_bf16 v33, v234, v26, v22
    v_dot2_f32_bf16 v34, v235, v25, v22
    v_dot2_f32_bf16 v35, v235, v26, v22
    v_cvt_pk_bf16_f32 v232, v28, v29
    v_cvt_pk_bf16_f32 v233, v30, v31
    v_cvt_pk_bf16_f32 v234, v32, v33
    v_cvt_pk_bf16_f32 v235, v34, v35
    v_fmac_f32 v24, v28, v28
    v_fmac_f32 v27, v29, v29
    v_fmac_f32 v24, v30, v30
    v_fmac_f32 v27, v31, v31
    v_fmac_f32 v24, v32, v32
    v_fmac_f32 v27, v33, v33
    v_fmac_f32 v24, v34, v34
    v_fmac_f32 v27, v35, v35
    v_dot2_f32_bf16 v28, v236, v25, v22
    v_dot2_f32_bf16 v29, v236, v26, v22
    v_dot2_f32_bf16 v30, v237, v25, v22
    v_dot2_f32_bf16 v31, v237, v26, v22
    v_dot2_f32_bf16 v32, v238, v25, v22
    v_dot2_f32_bf16 v33, v238, v26, v22
    v_dot2_f32_bf16 v34, v239, v25, v22
    v_dot2_f32_bf16 v35, v239, v26, v22
    v_cvt_pk_bf16_f32 v236, v28, v29
    v_cvt_pk_bf16_f32 v237, v30, v31
    v_cvt_pk_bf16_f32 v238, v32, v33
    v_cvt_pk_bf16_f32 v239, v34, v35
    v_fmac_f32 v24, v28, v28
    v_fmac_f32 v27, v29, v29
    v_fmac_f32 v24, v30, v30
    v_fmac_f32 v27, v31, v31
    v_fmac_f32 v24, v32, v32
    v_fmac_f32 v27, v33, v33
    v_fmac_f32 v24, v34, v34
    v_fmac_f32 v27, v35, v35
    s_mul_i32 s56, s34, 2752
    s_sub_u32 s57, s14, 6
    s_lshl_b32 s57, s57, 8
    s_add_u32 s56, s56, s57
    s_add_u32 s56, s56, 1078784
    s_add_u32 s57, s33, 67584
    s_mov_b32 m0, s57
    v_add_co_u32 v14, vcc, s56, v10
    s_nop 1
    v_addc_co_u32 v15, vcc, 0, v11, vcc
    global_load_lds_dwordx4 v[14:15], off

    v_dot2_f32_bf16 v28, v240, v25, v22
    v_dot2_f32_bf16 v29, v240, v26, v22
    v_dot2_f32_bf16 v30, v241, v25, v22
    v_dot2_f32_bf16 v31, v241, v26, v22
    v_dot2_f32_bf16 v32, v242, v25, v22
    v_dot2_f32_bf16 v33, v242, v26, v22
    v_dot2_f32_bf16 v34, v243, v25, v22
    v_dot2_f32_bf16 v35, v243, v26, v22
    v_cvt_pk_bf16_f32 v240, v28, v29
    v_cvt_pk_bf16_f32 v241, v30, v31
    v_cvt_pk_bf16_f32 v242, v32, v33
    v_cvt_pk_bf16_f32 v243, v34, v35
    v_fmac_f32 v24, v28, v28
    v_fmac_f32 v27, v29, v29
    v_fmac_f32 v24, v30, v30
    v_fmac_f32 v27, v31, v31
    v_fmac_f32 v24, v32, v32
    v_fmac_f32 v27, v33, v33
    v_fmac_f32 v24, v34, v34
    v_fmac_f32 v27, v35, v35
    v_dot2_f32_bf16 v28, v244, v25, v22
    v_dot2_f32_bf16 v29, v244, v26, v22
    v_dot2_f32_bf16 v30, v245, v25, v22
    v_dot2_f32_bf16 v31, v245, v26, v22
    v_dot2_f32_bf16 v32, v246, v25, v22
    v_dot2_f32_bf16 v33, v246, v26, v22
    v_dot2_f32_bf16 v34, v247, v25, v22
    v_dot2_f32_bf16 v35, v247, v26, v22
    v_cvt_pk_bf16_f32 v244, v28, v29
    v_cvt_pk_bf16_f32 v245, v30, v31
    v_cvt_pk_bf16_f32 v246, v32, v33
    v_cvt_pk_bf16_f32 v247, v34, v35
    v_fmac_f32 v24, v28, v28
    v_fmac_f32 v27, v29, v29
    v_fmac_f32 v24, v30, v30
    v_fmac_f32 v27, v31, v31
    v_fmac_f32 v24, v32, v32
    v_fmac_f32 v27, v33, v33
    v_fmac_f32 v24, v34, v34
    v_fmac_f32 v27, v35, v35
    v_dot2_f32_bf16 v28, v248, v25, v22
    v_dot2_f32_bf16 v29, v248, v26, v22
    v_dot2_f32_bf16 v30, v249, v25, v22
    v_dot2_f32_bf16 v31, v249, v26, v22
    v_dot2_f32_bf16 v32, v250, v25, v22
    v_dot2_f32_bf16 v33, v250, v26, v22
    v_dot2_f32_bf16 v34, v251, v25, v22
    v_dot2_f32_bf16 v35, v251, v26, v22
    v_cvt_pk_bf16_f32 v248, v28, v29
    v_cvt_pk_bf16_f32 v249, v30, v31
    v_cvt_pk_bf16_f32 v250, v32, v33
    v_cvt_pk_bf16_f32 v251, v34, v35
    v_fmac_f32 v24, v28, v28
    v_fmac_f32 v27, v29, v29
    v_fmac_f32 v24, v30, v30
    v_fmac_f32 v27, v31, v31
    v_fmac_f32 v24, v32, v32
    v_fmac_f32 v27, v33, v33
    v_fmac_f32 v24, v34, v34
    v_fmac_f32 v27, v35, v35
    v_dot2_f32_bf16 v28, v252, v25, v22
    v_dot2_f32_bf16 v29, v252, v26, v22
    v_dot2_f32_bf16 v30, v253, v25, v22
    v_dot2_f32_bf16 v31, v253, v26, v22
    v_dot2_f32_bf16 v32, v254, v25, v22
    v_dot2_f32_bf16 v33, v254, v26, v22
    v_dot2_f32_bf16 v34, v255, v25, v22
    v_dot2_f32_bf16 v35, v255, v26, v22
    v_cvt_pk_bf16_f32 v252, v28, v29
    v_cvt_pk_bf16_f32 v253, v30, v31
    v_cvt_pk_bf16_f32 v254, v32, v33
    v_cvt_pk_bf16_f32 v255, v34, v35
    v_fmac_f32 v24, v28, v28
    v_fmac_f32 v27, v29, v29
    v_fmac_f32 v24, v30, v30
    v_fmac_f32 v27, v31, v31
    v_fmac_f32 v24, v32, v32
    v_fmac_f32 v27, v33, v33
    v_fmac_f32 v24, v34, v34
    v_fmac_f32 v27, v35, v35
    s_mul_i32 s56, s34, 2752
    s_sub_u32 s57, s14, 6
    s_lshl_b32 s57, s57, 8
    s_add_u32 s56, s56, s57
    s_add_u32 s56, s56, 1089792
    s_add_u32 s57, s33, 68608
    s_mov_b32 m0, s57
    v_add_co_u32 v14, vcc, s56, v10
    s_nop 1
    v_addc_co_u32 v15, vcc, 0, v11, vcc
    global_load_lds_dwordx4 v[14:15], off

    s_nop 3
    v_add_f32 v24, v24, v27
    v_mov_b32 v27, v24
    s_nop 1
    v_permlane32_swap_b32 v24, v27
    s_nop 1
    v_add_f32 v24, v24, v27
    v_mul_f32 v24, 0x3b000000, v24
    v_fma_f32 v24, -v23, v23, v24
    v_max_f32 v24, 0, v24
    v_cvt_pk_bf16_f32 v24, v24, v24
    v_and_b32 v24, 0xffff0000, v24
    v_add_f32 v24, 0x3727c5ac, v24
    v_cvt_pk_bf16_f32 v24, v24, v24
    v_and_b32 v24, 0xffff0000, v24
    v_sqrt_f32 v24, v24
    s_nop 0
    v_cvt_pk_bf16_f32 v24, v24, v24
    v_and_b32 v24, 0xffff0000, v24
    v_rcp_f32 v24, v24

    v_lshlrev_b32 v26, 3, v4
    v_and_b32 v27, 15, v2
    v_lshrrev_b32 v27, 2, v27
    v_add_u32 v26, v26, v27
    v_and_b32 v27, 3, v27
    v_lshrrev_b32 v28, 4, v2
    v_and_b32 v28, 1, v28
    v_and_b32 v29, 3, v2
    v_lshlrev_b32 v29, 3, v29
    v_lshl_add_u32 v29, v26, 8, v29
    s_lshl_b32 s43, s41, 1

    s_add_u32 s30, s43, 0
    s_xor_b32 s31, s30, 1
    s_add_u32 s31, s31, 4
    v_cmp_ne_u32 vcc, 0, v28
    v_mov_b32 v30, s30
    v_mov_b32 v31, s31
    s_nop 0
    v_cndmask_b32 v30, v30, v31, vcc
    v_lshrrev_b32 v31, 1, v30
    v_xor_b32 v31, v31, v27
    v_and_b32 v30, 1, v30
    v_lshl_add_u32 v31, v31, 6, v29
    v_lshl_add_u32 v16, v30, 5, v31

    s_add_u32 s30, s43, 1
    s_xor_b32 s31, s30, 1
    s_add_u32 s31, s31, 4
    v_cmp_ne_u32 vcc, 0, v28
    v_mov_b32 v30, s30
    v_mov_b32 v31, s31
    s_nop 0
    v_cndmask_b32 v30, v30, v31, vcc
    v_lshrrev_b32 v31, 1, v30
    v_xor_b32 v31, v31, v27
    v_and_b32 v30, 1, v30
    v_lshl_add_u32 v31, v31, 6, v29
    v_lshl_add_u32 v17, v30, 5, v31

    v_lshlrev_b32 v21, 5, v5
    v_lshl_add_u32 v21, v4, 4, v21

    v_lshlrev_b32 v6, 13, v4
    v_lshl_add_u32 v6, v3, 1, v6
    v_add_u32 v6, s35, v6
    s_cmp_ge_u32 s52, 1888
    s_cbranch_scc1 K1f_wtd
    s_cmp_ge_u32 s53, 32
    s_cbranch_scc1 K1f_wtb
    s_lshl_b32 s54, s53, 14
    s_add_u32 s27, s54, 4096

    buffer_load_ushort v26, v6, s[44:47], s54 offen offset:0
    buffer_load_ushort v27, v6, s[44:47], s54 offen offset:1024
    buffer_load_ushort v28, v6, s[44:47], s54 offen offset:2048
    buffer_load_ushort v29, v6, s[44:47], s54 offen offset:3072
    buffer_load_ushort v30, v6, s[44:47], s27 offen offset:0
    buffer_load_ushort v31, v6, s[44:47], s27 offen offset:1024
    buffer_load_ushort v32, v6, s[44:47], s27 offen offset:2048
    buffer_load_ushort v33, v6, s[44:47], s27 offen offset:3072
    s_branch K1f_wtd
K1f_wtb:
    s_sub_u32 s54, s53, 32
    s_lshl_b32 s54, s54, 14
    s_add_u32 s27, s54, 4096

    buffer_load_ushort v26, v6, s[48:51], s54 offen offset:0
    buffer_load_ushort v27, v6, s[48:51], s54 offen offset:1024
    buffer_load_ushort v28, v6, s[48:51], s54 offen offset:2048
    buffer_load_ushort v29, v6, s[48:51], s54 offen offset:3072
    buffer_load_ushort v30, v6, s[48:51], s27 offen offset:0
    buffer_load_ushort v31, v6, s[48:51], s27 offen offset:1024
    buffer_load_ushort v32, v6, s[48:51], s27 offen offset:2048
    buffer_load_ushort v33, v6, s[48:51], s27 offen offset:3072
K1f_wtd:
    s_waitcnt vmcnt(12)
    s_waitcnt lgkmcnt(0)
    s_barrier
    v_add_u32 v34, 131072, v16
    v_add_u32 v35, 131072, v17
    ds_read_b64_tr_b16 v[40:41], v34 offset:0
    ds_read_b64_tr_b16 v[42:43], v34 offset:1024
    ds_read_b64_tr_b16 v[44:45], v35 offset:0
    ds_read_b64_tr_b16 v[46:47], v35 offset:1024
    ds_read_b64_tr_b16 v[48:49], v34 offset:4096
    ds_read_b64_tr_b16 v[50:51], v34 offset:5120
    ds_read_b64_tr_b16 v[52:53], v35 offset:4096
    ds_read_b64_tr_b16 v[54:55], v35 offset:5120
    ds_read_b64_tr_b16 v[56:57], v34 offset:8192
    ds_read_b64_tr_b16 v[58:59], v34 offset:9216
    ds_read_b64_tr_b16 v[60:61], v35 offset:8192
    ds_read_b64_tr_b16 v[62:63], v35 offset:9216
    s_waitcnt lgkmcnt(10)
    v_mfma_f32_32x32x16_bf16 v[64:79], v[40:43], v[128:131], 0
    ds_read_b64_tr_b16 v[40:41], v34 offset:12288
    ds_read_b64_tr_b16 v[42:43], v34 offset:13312
    s_waitcnt lgkmcnt(10)
    v_mfma_f32_32x32x16_bf16 v[80:95], v[44:47], v[128:131], 0
    ds_read_b64_tr_b16 v[44:45], v35 offset:12288
    ds_read_b64_tr_b16 v[46:47], v35 offset:13312
    s_waitcnt lgkmcnt(10)
    v_mfma_f32_32x32x16_bf16 v[64:79], v[48:51], v[132:135], v[64:79]
    ds_read_b64_tr_b16 v[48:49], v34 offset:16384
    ds_read_b64_tr_b16 v[50:51], v34 offset:17408
    s_waitcnt lgkmcnt(10)
    v_mfma_f32_32x32x16_bf16 v[80:95], v[52:55], v[132:135], v[80:95]
    ds_read_b64_tr_b16 v[52:53], v35 offset:16384
    ds_read_b64_tr_b16 v[54:55], v35 offset:17408
    s_waitcnt lgkmcnt(10)
    v_mfma_f32_32x32x16_bf16 v[64:79], v[56:59], v[136:139], v[64:79]
    ds_read_b64_tr_b16 v[56:57], v34 offset:20480
    ds_read_b64_tr_b16 v[58:59], v34 offset:21504
    s_waitcnt lgkmcnt(10)
    v_mfma_f32_32x32x16_bf16 v[80:95], v[60:63], v[136:139], v[80:95]
    ds_read_b64_tr_b16 v[60:61], v35 offset:20480
    ds_read_b64_tr_b16 v[62:63], v35 offset:21504
    s_waitcnt lgkmcnt(10)
    v_mfma_f32_32x32x16_bf16 v[64:79], v[40:43], v[140:143], v[64:79]
    ds_read_b64_tr_b16 v[40:41], v34 offset:24576
    ds_read_b64_tr_b16 v[42:43], v34 offset:25600
    s_waitcnt lgkmcnt(10)
    v_mfma_f32_32x32x16_bf16 v[80:95], v[44:47], v[140:143], v[80:95]
    ds_read_b64_tr_b16 v[44:45], v35 offset:24576
    ds_read_b64_tr_b16 v[46:47], v35 offset:25600
    s_waitcnt lgkmcnt(10)
    v_mfma_f32_32x32x16_bf16 v[64:79], v[48:51], v[144:147], v[64:79]
    ds_read_b64_tr_b16 v[48:49], v34 offset:28672
    ds_read_b64_tr_b16 v[50:51], v34 offset:29696
    s_waitcnt lgkmcnt(10)
    v_mfma_f32_32x32x16_bf16 v[80:95], v[52:55], v[144:147], v[80:95]
    ds_read_b64_tr_b16 v[52:53], v35 offset:28672
    ds_read_b64_tr_b16 v[54:55], v35 offset:29696
    s_waitcnt lgkmcnt(10)
    v_mfma_f32_32x32x16_bf16 v[64:79], v[56:59], v[148:151], v[64:79]
    s_waitcnt lgkmcnt(8)
    v_mfma_f32_32x32x16_bf16 v[80:95], v[60:63], v[148:151], v[80:95]
    s_waitcnt lgkmcnt(6)
    v_mfma_f32_32x32x16_bf16 v[64:79], v[40:43], v[152:155], v[64:79]
    s_waitcnt lgkmcnt(4)
    v_mfma_f32_32x32x16_bf16 v[80:95], v[44:47], v[152:155], v[80:95]
    s_waitcnt lgkmcnt(2)
    v_mfma_f32_32x32x16_bf16 v[64:79], v[48:51], v[156:159], v[64:79]
    s_waitcnt lgkmcnt(0)
    v_mfma_f32_32x32x16_bf16 v[80:95], v[52:55], v[156:159], v[80:95]
    s_waitcnt vmcnt(8)
    s_waitcnt lgkmcnt(0)
    s_barrier
    v_add_u32 v34, 0, v16
    v_add_u32 v35, 0, v17
    ds_read_b64_tr_b16 v[40:41], v34 offset:0
    ds_read_b64_tr_b16 v[42:43], v34 offset:1024
    ds_read_b64_tr_b16 v[44:45], v35 offset:0
    ds_read_b64_tr_b16 v[46:47], v35 offset:1024
    ds_read_b64_tr_b16 v[48:49], v34 offset:4096
    ds_read_b64_tr_b16 v[50:51], v34 offset:5120
    ds_read_b64_tr_b16 v[52:53], v35 offset:4096
    ds_read_b64_tr_b16 v[54:55], v35 offset:5120
    ds_read_b64_tr_b16 v[56:57], v34 offset:8192
    ds_read_b64_tr_b16 v[58:59], v34 offset:9216
    ds_read_b64_tr_b16 v[60:61], v35 offset:8192
    ds_read_b64_tr_b16 v[62:63], v35 offset:9216
    s_waitcnt lgkmcnt(10)
    v_mfma_f32_32x32x16_bf16 v[64:79], v[40:43], v[160:163], v[64:79]
    ds_read_b64_tr_b16 v[40:41], v34 offset:12288
    ds_read_b64_tr_b16 v[42:43], v34 offset:13312
    s_waitcnt lgkmcnt(10)
    v_mfma_f32_32x32x16_bf16 v[80:95], v[44:47], v[160:163], v[80:95]
    s_mul_i32 s56, s34, 2752
    s_sub_u32 s57, s14, 6
    s_lshl_b32 s57, s57, 8
    s_add_u32 s56, s56, s57
    s_add_u32 s56, s56, 128
    s_add_u32 s57, s33, 131072
    s_mov_b32 m0, s57
    v_add_co_u32 v14, vcc, s56, v10
    s_nop 1
    v_addc_co_u32 v15, vcc, 0, v11, vcc
    global_load_lds_dwordx4 v[14:15], off

    ds_read_b64_tr_b16 v[44:45], v35 offset:12288
    ds_read_b64_tr_b16 v[46:47], v35 offset:13312
    s_waitcnt lgkmcnt(10)
    v_mfma_f32_32x32x16_bf16 v[64:79], v[48:51], v[164:167], v[64:79]
    ds_read_b64_tr_b16 v[48:49], v34 offset:16384
    ds_read_b64_tr_b16 v[50:51], v34 offset:17408
    s_waitcnt lgkmcnt(10)
    v_mfma_f32_32x32x16_bf16 v[80:95], v[52:55], v[164:167], v[80:95]
    ds_read_b64_tr_b16 v[52:53], v35 offset:16384
    ds_read_b64_tr_b16 v[54:55], v35 offset:17408
    s_waitcnt lgkmcnt(10)
    v_mfma_f32_32x32x16_bf16 v[64:79], v[56:59], v[168:171], v[64:79]
    ds_read_b64_tr_b16 v[56:57], v34 offset:20480
    ds_read_b64_tr_b16 v[58:59], v34 offset:21504
    s_waitcnt lgkmcnt(10)
    v_mfma_f32_32x32x16_bf16 v[80:95], v[60:63], v[168:171], v[80:95]
    s_mul_i32 s56, s34, 2752
    s_sub_u32 s57, s14, 6
    s_lshl_b32 s57, s57, 8
    s_add_u32 s56, s56, s57
    s_add_u32 s56, s56, 11136
    s_add_u32 s57, s33, 132096
    s_mov_b32 m0, s57
    v_add_co_u32 v14, vcc, s56, v10
    s_nop 1
    v_addc_co_u32 v15, vcc, 0, v11, vcc
    global_load_lds_dwordx4 v[14:15], off

    ds_read_b64_tr_b16 v[60:61], v35 offset:20480
    ds_read_b64_tr_b16 v[62:63], v35 offset:21504
    s_waitcnt lgkmcnt(10)
    v_mfma_f32_32x32x16_bf16 v[64:79], v[40:43], v[172:175], v[64:79]
    ds_read_b64_tr_b16 v[40:41], v34 offset:24576
    ds_read_b64_tr_b16 v[42:43], v34 offset:25600
    s_waitcnt lgkmcnt(10)
    v_mfma_f32_32x32x16_bf16 v[80:95], v[44:47], v[172:175], v[80:95]
    ds_read_b64_tr_b16 v[44:45], v35 offset:24576
    ds_read_b64_tr_b16 v[46:47], v35 offset:25600
    s_waitcnt lgkmcnt(10)
    v_mfma_f32_32x32x16_bf16 v[64:79], v[48:51], v[176:179], v[64:79]
    ds_read_b64_tr_b16 v[48:49], v34 offset:28672
    ds_read_b64_tr_b16 v[50:51], v34 offset:29696
    s_waitcnt lgkmcnt(10)
    v_mfma_f32_32x32x16_bf16 v[80:95], v[52:55], v[176:179], v[80:95]
    s_mul_i32 s56, s34, 2752
    s_sub_u32 s57, s14, 6
    s_lshl_b32 s57, s57, 8
    s_add_u32 s56, s56, s57
    s_add_u32 s56, s56, 22144
    s_add_u32 s57, s33, 133120
    s_mov_b32 m0, s57
    v_add_co_u32 v14, vcc, s56, v10
    s_nop 1
    v_addc_co_u32 v15, vcc, 0, v11, vcc
    global_load_lds_dwordx4 v[14:15], off

    ds_read_b64_tr_b16 v[52:53], v35 offset:28672
    ds_read_b64_tr_b16 v[54:55], v35 offset:29696
    s_waitcnt lgkmcnt(10)
    v_mfma_f32_32x32x16_bf16 v[64:79], v[56:59], v[180:183], v[64:79]
    s_waitcnt lgkmcnt(8)
    v_mfma_f32_32x32x16_bf16 v[80:95], v[60:63], v[180:183], v[80:95]
    s_waitcnt lgkmcnt(6)
    v_mfma_f32_32x32x16_bf16 v[64:79], v[40:43], v[184:187], v[64:79]
    s_waitcnt lgkmcnt(4)
    v_mfma_f32_32x32x16_bf16 v[80:95], v[44:47], v[184:187], v[80:95]
    s_mul_i32 s56, s34, 2752
    s_sub_u32 s57, s14, 6
    s_lshl_b32 s57, s57, 8
    s_add_u32 s56, s56, s57
    s_add_u32 s56, s56, 33152
    s_add_u32 s57, s33, 134144
    s_mov_b32 m0, s57
    v_add_co_u32 v14, vcc, s56, v10
    s_nop 1
    v_addc_co_u32 v15, vcc, 0, v11, vcc
    global_load_lds_dwordx4 v[14:15], off

    s_waitcnt lgkmcnt(2)
    v_mfma_f32_32x32x16_bf16 v[64:79], v[48:51], v[188:191], v[64:79]
    s_waitcnt lgkmcnt(0)
    v_mfma_f32_32x32x16_bf16 v[80:95], v[52:55], v[188:191], v[80:95]
    s_waitcnt vmcnt(8)
    s_waitcnt lgkmcnt(0)
    s_barrier
    v_add_u32 v34, 32768, v16
    v_add_u32 v35, 32768, v17
    ds_read_b64_tr_b16 v[40:41], v34 offset:0
    ds_read_b64_tr_b16 v[42:43], v34 offset:1024
    ds_read_b64_tr_b16 v[44:45], v35 offset:0
    ds_read_b64_tr_b16 v[46:47], v35 offset:1024
    ds_read_b64_tr_b16 v[48:49], v34 offset:4096
    ds_read_b64_tr_b16 v[50:51], v34 offset:5120
    ds_read_b64_tr_b16 v[52:53], v35 offset:4096
    ds_read_b64_tr_b16 v[54:55], v35 offset:5120
    ds_read_b64_tr_b16 v[56:57], v34 offset:8192
    ds_read_b64_tr_b16 v[58:59], v34 offset:9216
    ds_read_b64_tr_b16 v[60:61], v35 offset:8192
    ds_read_b64_tr_b16 v[62:63], v35 offset:9216
    s_waitcnt lgkmcnt(10)
    v_mfma_f32_32x32x16_bf16 v[64:79], v[40:43], v[192:195], v[64:79]
    ds_read_b64_tr_b16 v[40:41], v34 offset:12288
    ds_read_b64_tr_b16 v[42:43], v34 offset:13312
    s_waitcnt lgkmcnt(10)
    v_mfma_f32_32x32x16_bf16 v[80:95], v[44:47], v[192:195], v[80:95]
    s_mul_i32 s56, s34, 2752
    s_sub_u32 s57, s14, 6
    s_lshl_b32 s57, s57, 8
    s_add_u32 s56, s56, s57
    s_add_u32 s56, s56, 352384
    s_add_u32 s57, s33, 0
    s_mov_b32 m0, s57
    v_add_co_u32 v14, vcc, s56, v10
    s_nop 1
    v_addc_co_u32 v15, vcc, 0, v11, vcc
    global_load_lds_dwordx4 v[14:15], off

    ds_read_b64_tr_b16 v[44:45], v35 offset:12288
    ds_read_b64_tr_b16 v[46:47], v35 offset:13312
    s_waitcnt lgkmcnt(10)
    v_mfma_f32_32x32x16_bf16 v[64:79], v[48:51], v[196:199], v[64:79]
    ds_read_b64_tr_b16 v[48:49], v34 offset:16384
    ds_read_b64_tr_b16 v[50:51], v34 offset:17408
    s_waitcnt lgkmcnt(10)
    v_mfma_f32_32x32x16_bf16 v[80:95], v[52:55], v[196:199], v[80:95]
    ds_read_b64_tr_b16 v[52:53], v35 offset:16384
    ds_read_b64_tr_b16 v[54:55], v35 offset:17408
    s_waitcnt lgkmcnt(10)
    v_mfma_f32_32x32x16_bf16 v[64:79], v[56:59], v[200:203], v[64:79]
    ds_read_b64_tr_b16 v[56:57], v34 offset:20480
    ds_read_b64_tr_b16 v[58:59], v34 offset:21504
    s_waitcnt lgkmcnt(10)
    v_mfma_f32_32x32x16_bf16 v[80:95], v[60:63], v[200:203], v[80:95]
    s_mul_i32 s56, s34, 2752
    s_sub_u32 s57, s14, 6
    s_lshl_b32 s57, s57, 8
    s_add_u32 s56, s56, s57
    s_add_u32 s56, s56, 363392
    s_add_u32 s57, s33, 1024
    s_mov_b32 m0, s57
    v_add_co_u32 v14, vcc, s56, v10
    s_nop 1
    v_addc_co_u32 v15, vcc, 0, v11, vcc
    global_load_lds_dwordx4 v[14:15], off

    ds_read_b64_tr_b16 v[60:61], v35 offset:20480
    ds_read_b64_tr_b16 v[62:63], v35 offset:21504
    s_waitcnt lgkmcnt(10)
    v_mfma_f32_32x32x16_bf16 v[64:79], v[40:43], v[204:207], v[64:79]
    ds_read_b64_tr_b16 v[40:41], v34 offset:24576
    ds_read_b64_tr_b16 v[42:43], v34 offset:25600
    s_waitcnt lgkmcnt(10)
    v_mfma_f32_32x32x16_bf16 v[80:95], v[44:47], v[204:207], v[80:95]
    ds_read_b64_tr_b16 v[44:45], v35 offset:24576
    ds_read_b64_tr_b16 v[46:47], v35 offset:25600
    s_waitcnt lgkmcnt(10)
    v_mfma_f32_32x32x16_bf16 v[64:79], v[48:51], v[208:211], v[64:79]
    ds_read_b64_tr_b16 v[48:49], v34 offset:28672
    ds_read_b64_tr_b16 v[50:51], v34 offset:29696
    s_waitcnt lgkmcnt(10)
    v_mfma_f32_32x32x16_bf16 v[80:95], v[52:55], v[208:211], v[80:95]
    s_mul_i32 s56, s34, 2752
    s_sub_u32 s57, s14, 6
    s_lshl_b32 s57, s57, 8
    s_add_u32 s56, s56, s57
    s_add_u32 s56, s56, 374400
    s_add_u32 s57, s33, 2048
    s_mov_b32 m0, s57
    v_add_co_u32 v14, vcc, s56, v10
    s_nop 1
    v_addc_co_u32 v15, vcc, 0, v11, vcc
    global_load_lds_dwordx4 v[14:15], off

    ds_read_b64_tr_b16 v[52:53], v35 offset:28672
    ds_read_b64_tr_b16 v[54:55], v35 offset:29696
    s_waitcnt lgkmcnt(10)
    v_mfma_f32_32x32x16_bf16 v[64:79], v[56:59], v[212:215], v[64:79]
    s_waitcnt lgkmcnt(8)
    v_mfma_f32_32x32x16_bf16 v[80:95], v[60:63], v[212:215], v[80:95]
    s_waitcnt lgkmcnt(6)
    v_mfma_f32_32x32x16_bf16 v[64:79], v[40:43], v[216:219], v[64:79]
    s_waitcnt lgkmcnt(4)
    v_mfma_f32_32x32x16_bf16 v[80:95], v[44:47], v[216:219], v[80:95]
    s_mul_i32 s56, s34, 2752
    s_sub_u32 s57, s14, 6
    s_lshl_b32 s57, s57, 8
    s_add_u32 s56, s56, s57
    s_add_u32 s56, s56, 385408
    s_add_u32 s57, s33, 3072
    s_mov_b32 m0, s57
    v_add_co_u32 v14, vcc, s56, v10
    s_nop 1
    v_addc_co_u32 v15, vcc, 0, v11, vcc
    global_load_lds_dwordx4 v[14:15], off

    s_waitcnt lgkmcnt(2)
    v_mfma_f32_32x32x16_bf16 v[64:79], v[48:51], v[220:223], v[64:79]
    s_waitcnt lgkmcnt(0)
    v_mfma_f32_32x32x16_bf16 v[80:95], v[52:55], v[220:223], v[80:95]
    s_waitcnt vmcnt(8)
    s_waitcnt lgkmcnt(0)
    s_barrier
    v_add_u32 v34, 65536, v16
    v_add_u32 v35, 65536, v17
    ds_read_b64_tr_b16 v[40:41], v34 offset:0
    ds_read_b64_tr_b16 v[42:43], v34 offset:1024
    ds_read_b64_tr_b16 v[44:45], v35 offset:0
    ds_read_b64_tr_b16 v[46:47], v35 offset:1024
    ds_read_b64_tr_b16 v[48:49], v34 offset:4096
    ds_read_b64_tr_b16 v[50:51], v34 offset:5120
    ds_read_b64_tr_b16 v[52:53], v35 offset:4096
    ds_read_b64_tr_b16 v[54:55], v35 offset:5120
    ds_read_b64_tr_b16 v[56:57], v34 offset:8192
    ds_read_b64_tr_b16 v[58:59], v34 offset:9216
    ds_read_b64_tr_b16 v[60:61], v35 offset:8192
    ds_read_b64_tr_b16 v[62:63], v35 offset:9216
    s_waitcnt lgkmcnt(10)
    v_mfma_f32_32x32x16_bf16 v[64:79], v[40:43], v[224:227], v[64:79]
    ds_read_b64_tr_b16 v[40:41], v34 offset:12288
    ds_read_b64_tr_b16 v[42:43], v34 offset:13312
    s_waitcnt lgkmcnt(10)
    v_mfma_f32_32x32x16_bf16 v[80:95], v[44:47], v[224:227], v[80:95]
    s_mul_i32 s56, s34, 2752
    s_sub_u32 s57, s14, 6
    s_lshl_b32 s57, s57, 8
    s_add_u32 s56, s56, s57
    s_add_u32 s56, s56, 704640
    s_add_u32 s57, s33, 32768
    s_mov_b32 m0, s57
    v_add_co_u32 v14, vcc, s56, v10
    s_nop 1
    v_addc_co_u32 v15, vcc, 0, v11, vcc
    global_load_lds_dwordx4 v[14:15], off

    ds_read_b64_tr_b16 v[44:45], v35 offset:12288
    ds_read_b64_tr_b16 v[46:47], v35 offset:13312
    s_waitcnt lgkmcnt(10)
    v_mfma_f32_32x32x16_bf16 v[64:79], v[48:51], v[228:231], v[64:79]
    ds_read_b64_tr_b16 v[48:49], v34 offset:16384
    ds_read_b64_tr_b16 v[50:51], v34 offset:17408
    s_waitcnt lgkmcnt(10)
    v_mfma_f32_32x32x16_bf16 v[80:95], v[52:55], v[228:231], v[80:95]
    ds_read_b64_tr_b16 v[52:53], v35 offset:16384
    ds_read_b64_tr_b16 v[54:55], v35 offset:17408
    s_waitcnt lgkmcnt(10)
    v_mfma_f32_32x32x16_bf16 v[64:79], v[56:59], v[232:235], v[64:79]
    ds_read_b64_tr_b16 v[56:57], v34 offset:20480
    ds_read_b64_tr_b16 v[58:59], v34 offset:21504
    s_waitcnt lgkmcnt(10)
    v_mfma_f32_32x32x16_bf16 v[80:95], v[60:63], v[232:235], v[80:95]
    s_mul_i32 s56, s34, 2752
    s_sub_u32 s57, s14, 6
    s_lshl_b32 s57, s57, 8
    s_add_u32 s56, s56, s57
    s_add_u32 s56, s56, 715648
    s_add_u32 s57, s33, 33792
    s_mov_b32 m0, s57
    v_add_co_u32 v14, vcc, s56, v10
    s_nop 1
    v_addc_co_u32 v15, vcc, 0, v11, vcc
    global_load_lds_dwordx4 v[14:15], off

    ds_read_b64_tr_b16 v[60:61], v35 offset:20480
    ds_read_b64_tr_b16 v[62:63], v35 offset:21504
    s_waitcnt lgkmcnt(10)
    v_mfma_f32_32x32x16_bf16 v[64:79], v[40:43], v[236:239], v[64:79]
    ds_read_b64_tr_b16 v[40:41], v34 offset:24576
    ds_read_b64_tr_b16 v[42:43], v34 offset:25600
    s_waitcnt lgkmcnt(10)
    v_mfma_f32_32x32x16_bf16 v[80:95], v[44:47], v[236:239], v[80:95]
    ds_read_b64_tr_b16 v[44:45], v35 offset:24576
    ds_read_b64_tr_b16 v[46:47], v35 offset:25600
    s_waitcnt lgkmcnt(10)
    v_mfma_f32_32x32x16_bf16 v[64:79], v[48:51], v[240:243], v[64:79]
    ds_read_b64_tr_b16 v[48:49], v34 offset:28672
    ds_read_b64_tr_b16 v[50:51], v34 offset:29696
    s_waitcnt lgkmcnt(10)
    v_mfma_f32_32x32x16_bf16 v[80:95], v[52:55], v[240:243], v[80:95]
    s_mul_i32 s56, s34, 2752
    s_sub_u32 s57, s14, 6
    s_lshl_b32 s57, s57, 8
    s_add_u32 s56, s56, s57
    s_add_u32 s56, s56, 726656
    s_add_u32 s57, s33, 34816
    s_mov_b32 m0, s57
    v_add_co_u32 v14, vcc, s56, v10
    s_nop 1
    v_addc_co_u32 v15, vcc, 0, v11, vcc
    global_load_lds_dwordx4 v[14:15], off

    ds_read_b64_tr_b16 v[52:53], v35 offset:28672
    ds_read_b64_tr_b16 v[54:55], v35 offset:29696
    s_waitcnt lgkmcnt(10)
    v_mfma_f32_32x32x16_bf16 v[64:79], v[56:59], v[244:247], v[64:79]
    s_waitcnt lgkmcnt(8)
    v_mfma_f32_32x32x16_bf16 v[80:95], v[60:63], v[244:247], v[80:95]
    s_waitcnt lgkmcnt(6)
    v_mfma_f32_32x32x16_bf16 v[64:79], v[40:43], v[248:251], v[64:79]
    s_waitcnt lgkmcnt(4)
    v_mfma_f32_32x32x16_bf16 v[80:95], v[44:47], v[248:251], v[80:95]
    s_mul_i32 s56, s34, 2752
    s_sub_u32 s57, s14, 6
    s_lshl_b32 s57, s57, 8
    s_add_u32 s56, s56, s57
    s_add_u32 s56, s56, 737664
    s_add_u32 s57, s33, 35840
    s_mov_b32 m0, s57
    v_add_co_u32 v14, vcc, s56, v10
    s_nop 1
    v_addc_co_u32 v15, vcc, 0, v11, vcc
    global_load_lds_dwordx4 v[14:15], off

    s_waitcnt lgkmcnt(2)
    v_mfma_f32_32x32x16_bf16 v[64:79], v[48:51], v[252:255], v[64:79]
    s_waitcnt lgkmcnt(0)
    v_mfma_f32_32x32x16_bf16 v[80:95], v[52:55], v[252:255], v[80:95]
    s_nop 15
    s_sub_u32 s30, s14, 6
    s_lshl_b32 s30, s30, 3
    s_add_u32 s30, s30, 0
    s_add_u32 s30, s30, s43
    s_lshl_b32 s30, s30, 16
    s_add_u32 s30, s30, 8388608
    v_mul_f32 v38, 0xbfb8aa3b, v24
    v_mul_f32 v39, v24, v24

    v_mul_f32 v40, v38, v64
    v_mul_f32 v41, v38, v65
    v_mul_f32 v42, v38, v66
    v_mul_f32 v43, v38, v67
    v_mul_f32 v44, v38, v68
    v_mul_f32 v45, v38, v69
    v_mul_f32 v46, v38, v70
    v_mul_f32 v47, v38, v71
    v_exp_f32 v40, v40
    v_exp_f32 v41, v41
    v_exp_f32 v42, v42
    v_exp_f32 v43, v43
    v_exp_f32 v44, v44
    v_exp_f32 v45, v45
    v_exp_f32 v46, v46
    v_exp_f32 v47, v47
    v_mul_f32 v64, v64, v72
    v_mul_f32 v65, v65, v73
    v_mul_f32 v66, v66, v74
    v_mul_f32 v67, v67, v75
    v_mul_f32 v68, v68, v76
    v_mul_f32 v69, v69, v77
    v_mul_f32 v70, v70, v78
    v_mul_f32 v71, v71, v79
    v_add_f32 v40, 1.0, v40
    v_add_f32 v41, 1.0, v41
    v_add_f32 v42, 1.0, v42
    v_add_f32 v43, 1.0, v43
    v_add_f32 v44, 1.0, v44
    v_add_f32 v45, 1.0, v45
    v_add_f32 v46, 1.0, v46
    v_add_f32 v47, 1.0, v47
    v_rcp_f32 v40, v40
    v_rcp_f32 v41, v41
    v_rcp_f32 v42, v42
    v_rcp_f32 v43, v43
    v_rcp_f32 v44, v44
    v_rcp_f32 v45, v45
    v_rcp_f32 v46, v46
    v_rcp_f32 v47, v47
    v_mul_f32 v64, v39, v64
    v_mul_f32 v65, v39, v65
    v_mul_f32 v66, v39, v66
    v_mul_f32 v67, v39, v67
    v_mul_f32 v68, v39, v68
    v_mul_f32 v69, v39, v69
    v_mul_f32 v70, v39, v70
    v_mul_f32 v71, v39, v71
    v_mul_f32 v64, v40, v64
    v_mul_f32 v65, v41, v65
    v_mul_f32 v66, v42, v66
    v_mul_f32 v67, v43, v67
    v_mul_f32 v68, v44, v68
    v_mul_f32 v69, v45, v69
    v_mul_f32 v70, v46, v70
    v_mul_f32 v71, v47, v71
    v_cvt_pk_bf16_f32 v64, v64, v65
    v_cvt_pk_bf16_f32 v65, v66, v67
    v_cvt_pk_bf16_f32 v66, v68, v69
    v_cvt_pk_bf16_f32 v67, v70, v71
    s_add_u32 s31, s30, 0
    s_nop 1
    v_permlane32_swap_b32 v64, v66
    v_permlane32_swap_b32 v65, v67
    buffer_store_dwordx4 v[64:67], v21, s[20:23], s31 offen sc0 sc1

    v_mul_f32 v40, v38, v80
    v_mul_f32 v41, v38, v81
    v_mul_f32 v42, v38, v82
    v_mul_f32 v43, v38, v83
    v_mul_f32 v44, v38, v84
    v_mul_f32 v45, v38, v85
    v_mul_f32 v46, v38, v86
    v_mul_f32 v47, v38, v87
    v_exp_f32 v40, v40
    v_exp_f32 v41, v41
    v_exp_f32 v42, v42
    v_exp_f32 v43, v43
    v_exp_f32 v44, v44
    v_exp_f32 v45, v45
    v_exp_f32 v46, v46
    v_exp_f32 v47, v47
    v_mul_f32 v80, v80, v88
    v_mul_f32 v81, v81, v89
    v_mul_f32 v82, v82, v90
    v_mul_f32 v83, v83, v91
    v_mul_f32 v84, v84, v92
    v_mul_f32 v85, v85, v93
    v_mul_f32 v86, v86, v94
    v_mul_f32 v87, v87, v95
    v_add_f32 v40, 1.0, v40
    v_add_f32 v41, 1.0, v41
    v_add_f32 v42, 1.0, v42
    v_add_f32 v43, 1.0, v43
    v_add_f32 v44, 1.0, v44
    v_add_f32 v45, 1.0, v45
    v_add_f32 v46, 1.0, v46
    v_add_f32 v47, 1.0, v47
    v_rcp_f32 v40, v40
    v_rcp_f32 v41, v41
    v_rcp_f32 v42, v42
    v_rcp_f32 v43, v43
    v_rcp_f32 v44, v44
    v_rcp_f32 v45, v45
    v_rcp_f32 v46, v46
    v_rcp_f32 v47, v47
    v_mul_f32 v80, v39, v80
    v_mul_f32 v81, v39, v81
    v_mul_f32 v82, v39, v82
    v_mul_f32 v83, v39, v83
    v_mul_f32 v84, v39, v84
    v_mul_f32 v85, v39, v85
    v_mul_f32 v86, v39, v86
    v_mul_f32 v87, v39, v87
    v_mul_f32 v80, v40, v80
    v_mul_f32 v81, v41, v81
    v_mul_f32 v82, v42, v82
    v_mul_f32 v83, v43, v83
    v_mul_f32 v84, v44, v84
    v_mul_f32 v85, v45, v85
    v_mul_f32 v86, v46, v86
    v_mul_f32 v87, v47, v87
    v_cvt_pk_bf16_f32 v80, v80, v81
    v_cvt_pk_bf16_f32 v81, v82, v83
    v_cvt_pk_bf16_f32 v82, v84, v85
    v_cvt_pk_bf16_f32 v83, v86, v87
    s_add_u32 s31, s30, 65536
    s_nop 1
    v_permlane32_swap_b32 v80, v82
    v_permlane32_swap_b32 v81, v83
    buffer_store_dwordx4 v[80:83], v21, s[20:23], s31 offen sc0 sc1

    s_nop 1
    s_waitcnt vmcnt(10)
    s_waitcnt lgkmcnt(0)
    s_barrier
    s_cmp_ge_u32 s52, 1888
    s_cbranch_scc1 K1f_wts
    v_lshlrev_b32 v6, 4, v2
    v_lshl_or_b32 v26, v27, 16, v26
    v_lshl_or_b32 v27, v29, 16, v28
    v_lshl_or_b32 v28, v31, 16, v30
    v_lshl_or_b32 v29, v33, 16, v32
    buffer_store_dwordx4 v[26:29], v6, s[20:23], s55 offen sc0 sc1

K1f_wts:
    v_add_u32 v34, 131072, v16
    v_add_u32 v35, 131072, v17
    ds_read_b64_tr_b16 v[40:41], v34 offset:0
    ds_read_b64_tr_b16 v[42:43], v34 offset:1024
    ds_read_b64_tr_b16 v[44:45], v35 offset:0
    ds_read_b64_tr_b16 v[46:47], v35 offset:1024
    ds_read_b64_tr_b16 v[48:49], v34 offset:4096
    ds_read_b64_tr_b16 v[50:51], v34 offset:5120
    ds_read_b64_tr_b16 v[52:53], v35 offset:4096
    ds_read_b64_tr_b16 v[54:55], v35 offset:5120
    ds_read_b64_tr_b16 v[56:57], v34 offset:8192
    ds_read_b64_tr_b16 v[58:59], v34 offset:9216
    ds_read_b64_tr_b16 v[60:61], v35 offset:8192
    ds_read_b64_tr_b16 v[62:63], v35 offset:9216
    s_waitcnt lgkmcnt(10)
    v_mfma_f32_32x32x16_bf16 v[64:79], v[40:43], v[128:131], 0
    ds_read_b64_tr_b16 v[40:41], v34 offset:12288
    ds_read_b64_tr_b16 v[42:43], v34 offset:13312
    s_waitcnt lgkmcnt(10)
    v_mfma_f32_32x32x16_bf16 v[80:95], v[44:47], v[128:131], 0
    s_mul_i32 s56, s34, 2752
    s_sub_u32 s57, s14, 6
    s_lshl_b32 s57, s57, 8
    s_add_u32 s56, s56, s57
    s_add_u32 s56, s56, 1056896
    s_add_u32 s57, s33, 65536
    s_mov_b32 m0, s57
    v_add_co_u32 v14, vcc, s56, v10
    s_nop 1
    v_addc_co_u32 v15, vcc, 0, v11, vcc
    global_load_lds_dwordx4 v[14:15], off

    ds_read_b64_tr_b16 v[44:45], v35 offset:12288
    ds_read_b64_tr_b16 v[46:47], v35 offset:13312
    s_waitcnt lgkmcnt(10)
    v_mfma_f32_32x32x16_bf16 v[64:79], v[48:51], v[132:135], v[64:79]
    ds_read_b64_tr_b16 v[48:49], v34 offset:16384
    ds_read_b64_tr_b16 v[50:51], v34 offset:17408
    s_waitcnt lgkmcnt(10)
    v_mfma_f32_32x32x16_bf16 v[80:95], v[52:55], v[132:135], v[80:95]
    ds_read_b64_tr_b16 v[52:53], v35 offset:16384
    ds_read_b64_tr_b16 v[54:55], v35 offset:17408
    s_waitcnt lgkmcnt(10)
    v_mfma_f32_32x32x16_bf16 v[64:79], v[56:59], v[136:139], v[64:79]
    ds_read_b64_tr_b16 v[56:57], v34 offset:20480
    ds_read_b64_tr_b16 v[58:59], v34 offset:21504
    s_waitcnt lgkmcnt(10)
    v_mfma_f32_32x32x16_bf16 v[80:95], v[60:63], v[136:139], v[80:95]
    s_mul_i32 s56, s34, 2752
    s_sub_u32 s57, s14, 6
    s_lshl_b32 s57, s57, 8
    s_add_u32 s56, s56, s57
    s_add_u32 s56, s56, 1067904
    s_add_u32 s57, s33, 66560
    s_mov_b32 m0, s57
    v_add_co_u32 v14, vcc, s56, v10
    s_nop 1
    v_addc_co_u32 v15, vcc, 0, v11, vcc
    global_load_lds_dwordx4 v[14:15], off

    ds_read_b64_tr_b16 v[60:61], v35 offset:20480
    ds_read_b64_tr_b16 v[62:63], v35 offset:21504
    s_waitcnt lgkmcnt(10)
    v_mfma_f32_32x32x16_bf16 v[64:79], v[40:43], v[140:143], v[64:79]
    ds_read_b64_tr_b16 v[40:41], v34 offset:24576
    ds_read_b64_tr_b16 v[42:43], v34 offset:25600
    s_waitcnt lgkmcnt(10)
    v_mfma_f32_32x32x16_bf16 v[80:95], v[44:47], v[140:143], v[80:95]
    ds_read_b64_tr_b16 v[44:45], v35 offset:24576
    ds_read_b64_tr_b16 v[46:47], v35 offset:25600
    s_waitcnt lgkmcnt(10)
    v_mfma_f32_32x32x16_bf16 v[64:79], v[48:51], v[144:147], v[64:79]
    ds_read_b64_tr_b16 v[48:49], v34 offset:28672
    ds_read_b64_tr_b16 v[50:51], v34 offset:29696
    s_waitcnt lgkmcnt(10)
    v_mfma_f32_32x32x16_bf16 v[80:95], v[52:55], v[144:147], v[80:95]
    s_mul_i32 s56, s34, 2752
    s_sub_u32 s57, s14, 6
    s_lshl_b32 s57, s57, 8
    s_add_u32 s56, s56, s57
    s_add_u32 s56, s56, 1078912
    s_add_u32 s57, s33, 67584
    s_mov_b32 m0, s57
    v_add_co_u32 v14, vcc, s56, v10
    s_nop 1
    v_addc_co_u32 v15, vcc, 0, v11, vcc
    global_load_lds_dwordx4 v[14:15], off

    ds_read_b64_tr_b16 v[52:53], v35 offset:28672
    ds_read_b64_tr_b16 v[54:55], v35 offset:29696
    s_waitcnt lgkmcnt(10)
    v_mfma_f32_32x32x16_bf16 v[64:79], v[56:59], v[148:151], v[64:79]
    s_waitcnt lgkmcnt(8)
    v_mfma_f32_32x32x16_bf16 v[80:95], v[60:63], v[148:151], v[80:95]
    s_waitcnt lgkmcnt(6)
    v_mfma_f32_32x32x16_bf16 v[64:79], v[40:43], v[152:155], v[64:79]
    s_waitcnt lgkmcnt(4)
    v_mfma_f32_32x32x16_bf16 v[80:95], v[44:47], v[152:155], v[80:95]
    s_mul_i32 s56, s34, 2752
    s_sub_u32 s57, s14, 6
    s_lshl_b32 s57, s57, 8
    s_add_u32 s56, s56, s57
    s_add_u32 s56, s56, 1089920
    s_add_u32 s57, s33, 68608
    s_mov_b32 m0, s57
    v_add_co_u32 v14, vcc, s56, v10
    s_nop 1
    v_addc_co_u32 v15, vcc, 0, v11, vcc
    global_load_lds_dwordx4 v[14:15], off

    s_waitcnt lgkmcnt(2)
    v_mfma_f32_32x32x16_bf16 v[64:79], v[48:51], v[156:159], v[64:79]
    s_waitcnt lgkmcnt(0)
    v_mfma_f32_32x32x16_bf16 v[80:95], v[52:55], v[156:159], v[80:95]
    s_waitcnt vmcnt(10)
    s_waitcnt lgkmcnt(0)
    s_barrier
    v_add_u32 v34, 0, v16
    v_add_u32 v35, 0, v17
    ds_read_b64_tr_b16 v[40:41], v34 offset:0
    ds_read_b64_tr_b16 v[42:43], v34 offset:1024
    ds_read_b64_tr_b16 v[44:45], v35 offset:0
    ds_read_b64_tr_b16 v[46:47], v35 offset:1024
    ds_read_b64_tr_b16 v[48:49], v34 offset:4096
    ds_read_b64_tr_b16 v[50:51], v34 offset:5120
    ds_read_b64_tr_b16 v[52:53], v35 offset:4096
    ds_read_b64_tr_b16 v[54:55], v35 offset:5120
    ds_read_b64_tr_b16 v[56:57], v34 offset:8192
    ds_read_b64_tr_b16 v[58:59], v34 offset:9216
    ds_read_b64_tr_b16 v[60:61], v35 offset:8192
    ds_read_b64_tr_b16 v[62:63], v35 offset:9216
    s_waitcnt lgkmcnt(10)
    v_mfma_f32_32x32x16_bf16 v[64:79], v[40:43], v[160:163], v[64:79]
    ds_read_b64_tr_b16 v[40:41], v34 offset:12288
    ds_read_b64_tr_b16 v[42:43], v34 offset:13312
    s_waitcnt lgkmcnt(10)
    v_mfma_f32_32x32x16_bf16 v[80:95], v[44:47], v[160:163], v[80:95]
    ds_read_b64_tr_b16 v[44:45], v35 offset:12288
    ds_read_b64_tr_b16 v[46:47], v35 offset:13312
    s_waitcnt lgkmcnt(10)
    v_mfma_f32_32x32x16_bf16 v[64:79], v[48:51], v[164:167], v[64:79]
    ds_read_b64_tr_b16 v[48:49], v34 offset:16384
    ds_read_b64_tr_b16 v[50:51], v34 offset:17408
    s_waitcnt lgkmcnt(10)
    v_mfma_f32_32x32x16_bf16 v[80:95], v[52:55], v[164:167], v[80:95]
    ds_read_b64_tr_b16 v[52:53], v35 offset:16384
    ds_read_b64_tr_b16 v[54:55], v35 offset:17408
    s_waitcnt lgkmcnt(10)
    v_mfma_f32_32x32x16_bf16 v[64:79], v[56:59], v[168:171], v[64:79]
    ds_read_b64_tr_b16 v[56:57], v34 offset:20480
    ds_read_b64_tr_b16 v[58:59], v34 offset:21504
    s_waitcnt lgkmcnt(10)
    v_mfma_f32_32x32x16_bf16 v[80:95], v[60:63], v[168:171], v[80:95]
    ds_read_b64_tr_b16 v[60:61], v35 offset:20480
    ds_read_b64_tr_b16 v[62:63], v35 offset:21504
    s_waitcnt lgkmcnt(10)
    v_mfma_f32_32x32x16_bf16 v[64:79], v[40:43], v[172:175], v[64:79]
    ds_read_b64_tr_b16 v[40:41], v34 offset:24576
    ds_read_b64_tr_b16 v[42:43], v34 offset:25600
    s_waitcnt lgkmcnt(10)
    v_mfma_f32_32x32x16_bf16 v[80:95], v[44:47], v[172:175], v[80:95]
    ds_read_b64_tr_b16 v[44:45], v35 offset:24576
    ds_read_b64_tr_b16 v[46:47], v35 offset:25600
    s_waitcnt lgkmcnt(10)
    v_mfma_f32_32x32x16_bf16 v[64:79], v[48:51], v[176:179], v[64:79]
    ds_read_b64_tr_b16 v[48:49], v34 offset:28672
    ds_read_b64_tr_b16 v[50:51], v34 offset:29696
    s_waitcnt lgkmcnt(10)
    v_mfma_f32_32x32x16_bf16 v[80:95], v[52:55], v[176:179], v[80:95]
    ds_read_b64_tr_b16 v[52:53], v35 offset:28672
    ds_read_b64_tr_b16 v[54:55], v35 offset:29696
    s_waitcnt lgkmcnt(10)
    v_mfma_f32_32x32x16_bf16 v[64:79], v[56:59], v[180:183], v[64:79]
    s_waitcnt lgkmcnt(8)
    v_mfma_f32_32x32x16_bf16 v[80:95], v[60:63], v[180:183], v[80:95]
    s_waitcnt lgkmcnt(6)
    v_mfma_f32_32x32x16_bf16 v[64:79], v[40:43], v[184:187], v[64:79]
    s_waitcnt lgkmcnt(4)
    v_mfma_f32_32x32x16_bf16 v[80:95], v[44:47], v[184:187], v[80:95]
    s_waitcnt lgkmcnt(2)
    v_mfma_f32_32x32x16_bf16 v[64:79], v[48:51], v[188:191], v[64:79]
    s_waitcnt lgkmcnt(0)
    v_mfma_f32_32x32x16_bf16 v[80:95], v[52:55], v[188:191], v[80:95]
    s_waitcnt vmcnt(6)
    s_waitcnt lgkmcnt(0)
    s_barrier
    v_add_u32 v34, 32768, v16
    v_add_u32 v35, 32768, v17
    ds_read_b64_tr_b16 v[40:41], v34 offset:0
    ds_read_b64_tr_b16 v[42:43], v34 offset:1024
    ds_read_b64_tr_b16 v[44:45], v35 offset:0
    ds_read_b64_tr_b16 v[46:47], v35 offset:1024
    ds_read_b64_tr_b16 v[48:49], v34 offset:4096
    ds_read_b64_tr_b16 v[50:51], v34 offset:5120
    ds_read_b64_tr_b16 v[52:53], v35 offset:4096
    ds_read_b64_tr_b16 v[54:55], v35 offset:5120
    ds_read_b64_tr_b16 v[56:57], v34 offset:8192
    ds_read_b64_tr_b16 v[58:59], v34 offset:9216
    ds_read_b64_tr_b16 v[60:61], v35 offset:8192
    ds_read_b64_tr_b16 v[62:63], v35 offset:9216
    s_waitcnt lgkmcnt(10)
    v_mfma_f32_32x32x16_bf16 v[64:79], v[40:43], v[192:195], v[64:79]
    ds_read_b64_tr_b16 v[40:41], v34 offset:12288
    ds_read_b64_tr_b16 v[42:43], v34 offset:13312
    s_waitcnt lgkmcnt(10)
    v_mfma_f32_32x32x16_bf16 v[80:95], v[44:47], v[192:195], v[80:95]
    ds_read_b64_tr_b16 v[44:45], v35 offset:12288
    ds_read_b64_tr_b16 v[46:47], v35 offset:13312
    s_waitcnt lgkmcnt(10)
    v_mfma_f32_32x32x16_bf16 v[64:79], v[48:51], v[196:199], v[64:79]
    ds_read_b64_tr_b16 v[48:49], v34 offset:16384
    ds_read_b64_tr_b16 v[50:51], v34 offset:17408
    s_waitcnt lgkmcnt(10)
    v_mfma_f32_32x32x16_bf16 v[80:95], v[52:55], v[196:199], v[80:95]
    ds_read_b64_tr_b16 v[52:53], v35 offset:16384
    ds_read_b64_tr_b16 v[54:55], v35 offset:17408
    s_waitcnt lgkmcnt(10)
    v_mfma_f32_32x32x16_bf16 v[64:79], v[56:59], v[200:203], v[64:79]
    ds_read_b64_tr_b16 v[56:57], v34 offset:20480
    ds_read_b64_tr_b16 v[58:59], v34 offset:21504
    s_waitcnt lgkmcnt(10)
    v_mfma_f32_32x32x16_bf16 v[80:95], v[60:63], v[200:203], v[80:95]
    ds_read_b64_tr_b16 v[60:61], v35 offset:20480
    ds_read_b64_tr_b16 v[62:63], v35 offset:21504
    s_waitcnt lgkmcnt(10)
    v_mfma_f32_32x32x16_bf16 v[64:79], v[40:43], v[204:207], v[64:79]
    ds_read_b64_tr_b16 v[40:41], v34 offset:24576
    ds_read_b64_tr_b16 v[42:43], v34 offset:25600
    s_waitcnt lgkmcnt(10)
    v_mfma_f32_32x32x16_bf16 v[80:95], v[44:47], v[204:207], v[80:95]
    ds_read_b64_tr_b16 v[44:45], v35 offset:24576
    ds_read_b64_tr_b16 v[46:47], v35 offset:25600
    s_waitcnt lgkmcnt(10)
    v_mfma_f32_32x32x16_bf16 v[64:79], v[48:51], v[208:211], v[64:79]
    ds_read_b64_tr_b16 v[48:49], v34 offset:28672
    ds_read_b64_tr_b16 v[50:51], v34 offset:29696
    s_waitcnt lgkmcnt(10)
    v_mfma_f32_32x32x16_bf16 v[80:95], v[52:55], v[208:211], v[80:95]
    ds_read_b64_tr_b16 v[52:53], v35 offset:28672
    ds_read_b64_tr_b16 v[54:55], v35 offset:29696
    s_waitcnt lgkmcnt(10)
    v_mfma_f32_32x32x16_bf16 v[64:79], v[56:59], v[212:215], v[64:79]
    s_waitcnt lgkmcnt(8)
    v_mfma_f32_32x32x16_bf16 v[80:95], v[60:63], v[212:215], v[80:95]
    s_waitcnt lgkmcnt(6)
    v_mfma_f32_32x32x16_bf16 v[64:79], v[40:43], v[216:219], v[64:79]
    s_waitcnt lgkmcnt(4)
    v_mfma_f32_32x32x16_bf16 v[80:95], v[44:47], v[216:219], v[80:95]
    s_waitcnt lgkmcnt(2)
    v_mfma_f32_32x32x16_bf16 v[64:79], v[48:51], v[220:223], v[64:79]
    s_waitcnt lgkmcnt(0)
    v_mfma_f32_32x32x16_bf16 v[80:95], v[52:55], v[220:223], v[80:95]
    s_waitcnt vmcnt(0)
    s_waitcnt lgkmcnt(0)
    s_barrier
    v_add_u32 v34, 65536, v16
    v_add_u32 v35, 65536, v17
    ds_read_b64_tr_b16 v[40:41], v34 offset:0
    ds_read_b64_tr_b16 v[42:43], v34 offset:1024
    ds_read_b64_tr_b16 v[44:45], v35 offset:0
    ds_read_b64_tr_b16 v[46:47], v35 offset:1024
    ds_read_b64_tr_b16 v[48:49], v34 offset:4096
    ds_read_b64_tr_b16 v[50:51], v34 offset:5120
    ds_read_b64_tr_b16 v[52:53], v35 offset:4096
    ds_read_b64_tr_b16 v[54:55], v35 offset:5120
    ds_read_b64_tr_b16 v[56:57], v34 offset:8192
    ds_read_b64_tr_b16 v[58:59], v34 offset:9216
    ds_read_b64_tr_b16 v[60:61], v35 offset:8192
    ds_read_b64_tr_b16 v[62:63], v35 offset:9216
    s_waitcnt lgkmcnt(10)
    v_mfma_f32_32x32x16_bf16 v[64:79], v[40:43], v[224:227], v[64:79]
    ds_read_b64_tr_b16 v[40:41], v34 offset:12288
    ds_read_b64_tr_b16 v[42:43], v34 offset:13312
    s_waitcnt lgkmcnt(10)
    v_mfma_f32_32x32x16_bf16 v[80:95], v[44:47], v[224:227], v[80:95]
    ds_read_b64_tr_b16 v[44:45], v35 offset:12288
    ds_read_b64_tr_b16 v[46:47], v35 offset:13312
    s_waitcnt lgkmcnt(10)
    v_mfma_f32_32x32x16_bf16 v[64:79], v[48:51], v[228:231], v[64:79]
    ds_read_b64_tr_b16 v[48:49], v34 offset:16384
    ds_read_b64_tr_b16 v[50:51], v34 offset:17408
    s_waitcnt lgkmcnt(10)
    v_mfma_f32_32x32x16_bf16 v[80:95], v[52:55], v[228:231], v[80:95]
    ds_read_b64_tr_b16 v[52:53], v35 offset:16384
    ds_read_b64_tr_b16 v[54:55], v35 offset:17408
    s_waitcnt lgkmcnt(10)
    v_mfma_f32_32x32x16_bf16 v[64:79], v[56:59], v[232:235], v[64:79]
    ds_read_b64_tr_b16 v[56:57], v34 offset:20480
    ds_read_b64_tr_b16 v[58:59], v34 offset:21504
    s_waitcnt lgkmcnt(10)
    v_mfma_f32_32x32x16_bf16 v[80:95], v[60:63], v[232:235], v[80:95]
    ds_read_b64_tr_b16 v[60:61], v35 offset:20480
    ds_read_b64_tr_b16 v[62:63], v35 offset:21504
    s_waitcnt lgkmcnt(10)
    v_mfma_f32_32x32x16_bf16 v[64:79], v[40:43], v[236:239], v[64:79]
    ds_read_b64_tr_b16 v[40:41], v34 offset:24576
    ds_read_b64_tr_b16 v[42:43], v34 offset:25600
    s_waitcnt lgkmcnt(10)
    v_mfma_f32_32x32x16_bf16 v[80:95], v[44:47], v[236:239], v[80:95]
    ds_read_b64_tr_b16 v[44:45], v35 offset:24576
    ds_read_b64_tr_b16 v[46:47], v35 offset:25600
    s_waitcnt lgkmcnt(10)
    v_mfma_f32_32x32x16_bf16 v[64:79], v[48:51], v[240:243], v[64:79]
    ds_read_b64_tr_b16 v[48:49], v34 offset:28672
    ds_read_b64_tr_b16 v[50:51], v34 offset:29696
    s_waitcnt lgkmcnt(10)
    v_mfma_f32_32x32x16_bf16 v[80:95], v[52:55], v[240:243], v[80:95]
    ds_read_b64_tr_b16 v[52:53], v35 offset:28672
    ds_read_b64_tr_b16 v[54:55], v35 offset:29696
    s_waitcnt lgkmcnt(10)
    v_mfma_f32_32x32x16_bf16 v[64:79], v[56:59], v[244:247], v[64:79]
    s_waitcnt lgkmcnt(8)
    v_mfma_f32_32x32x16_bf16 v[80:95], v[60:63], v[244:247], v[80:95]
    s_waitcnt lgkmcnt(6)
    v_mfma_f32_32x32x16_bf16 v[64:79], v[40:43], v[248:251], v[64:79]
    s_waitcnt lgkmcnt(4)
    v_mfma_f32_32x32x16_bf16 v[80:95], v[44:47], v[248:251], v[80:95]
    s_waitcnt lgkmcnt(2)
    v_mfma_f32_32x32x16_bf16 v[64:79], v[48:51], v[252:255], v[64:79]
    s_waitcnt lgkmcnt(0)
    v_mfma_f32_32x32x16_bf16 v[80:95], v[52:55], v[252:255], v[80:95]
    s_nop 15
    s_sub_u32 s30, s14, 6
    s_lshl_b32 s30, s30, 3
    s_add_u32 s30, s30, 4
    s_add_u32 s30, s30, s43
    s_lshl_b32 s30, s30, 16
    s_add_u32 s30, s30, 8388608
    v_mul_f32 v38, 0xbfb8aa3b, v24
    v_mul_f32 v39, v24, v24

    v_mul_f32 v40, v38, v64
    v_mul_f32 v41, v38, v65
    v_mul_f32 v42, v38, v66
    v_mul_f32 v43, v38, v67
    v_mul_f32 v44, v38, v68
    v_mul_f32 v45, v38, v69
    v_mul_f32 v46, v38, v70
    v_mul_f32 v47, v38, v71
    v_exp_f32 v40, v40
    v_exp_f32 v41, v41
    v_exp_f32 v42, v42
    v_exp_f32 v43, v43
    v_exp_f32 v44, v44
    v_exp_f32 v45, v45
    v_exp_f32 v46, v46
    v_exp_f32 v47, v47
    v_mul_f32 v64, v64, v72
    v_mul_f32 v65, v65, v73
    v_mul_f32 v66, v66, v74
    v_mul_f32 v67, v67, v75
    v_mul_f32 v68, v68, v76
    v_mul_f32 v69, v69, v77
    v_mul_f32 v70, v70, v78
    v_mul_f32 v71, v71, v79
    v_add_f32 v40, 1.0, v40
    v_add_f32 v41, 1.0, v41
    v_add_f32 v42, 1.0, v42
    v_add_f32 v43, 1.0, v43
    v_add_f32 v44, 1.0, v44
    v_add_f32 v45, 1.0, v45
    v_add_f32 v46, 1.0, v46
    v_add_f32 v47, 1.0, v47
    v_rcp_f32 v40, v40
    v_rcp_f32 v41, v41
    v_rcp_f32 v42, v42
    v_rcp_f32 v43, v43
    v_rcp_f32 v44, v44
    v_rcp_f32 v45, v45
    v_rcp_f32 v46, v46
    v_rcp_f32 v47, v47
    v_mul_f32 v64, v39, v64
    v_mul_f32 v65, v39, v65
    v_mul_f32 v66, v39, v66
    v_mul_f32 v67, v39, v67
    v_mul_f32 v68, v39, v68
    v_mul_f32 v69, v39, v69
    v_mul_f32 v70, v39, v70
    v_mul_f32 v71, v39, v71
    v_mul_f32 v64, v40, v64
    v_mul_f32 v65, v41, v65
    v_mul_f32 v66, v42, v66
    v_mul_f32 v67, v43, v67
    v_mul_f32 v68, v44, v68
    v_mul_f32 v69, v45, v69
    v_mul_f32 v70, v46, v70
    v_mul_f32 v71, v47, v71
    v_cvt_pk_bf16_f32 v64, v64, v65
    v_cvt_pk_bf16_f32 v65, v66, v67
    v_cvt_pk_bf16_f32 v66, v68, v69
    v_cvt_pk_bf16_f32 v67, v70, v71
    s_add_u32 s31, s30, 0
    s_nop 1
    v_permlane32_swap_b32 v64, v66
    v_permlane32_swap_b32 v65, v67
    buffer_store_dwordx4 v[64:67], v21, s[20:23], s31 offen sc0 sc1

    v_mul_f32 v40, v38, v80
    v_mul_f32 v41, v38, v81
    v_mul_f32 v42, v38, v82
    v_mul_f32 v43, v38, v83
    v_mul_f32 v44, v38, v84
    v_mul_f32 v45, v38, v85
    v_mul_f32 v46, v38, v86
    v_mul_f32 v47, v38, v87
    v_exp_f32 v40, v40
    v_exp_f32 v41, v41
    v_exp_f32 v42, v42
    v_exp_f32 v43, v43
    v_exp_f32 v44, v44
    v_exp_f32 v45, v45
    v_exp_f32 v46, v46
    v_exp_f32 v47, v47
    v_mul_f32 v80, v80, v88
    v_mul_f32 v81, v81, v89
    v_mul_f32 v82, v82, v90
    v_mul_f32 v83, v83, v91
    v_mul_f32 v84, v84, v92
    v_mul_f32 v85, v85, v93
    v_mul_f32 v86, v86, v94
    v_mul_f32 v87, v87, v95
    v_add_f32 v40, 1.0, v40
    v_add_f32 v41, 1.0, v41
    v_add_f32 v42, 1.0, v42
    v_add_f32 v43, 1.0, v43
    v_add_f32 v44, 1.0, v44
    v_add_f32 v45, 1.0, v45
    v_add_f32 v46, 1.0, v46
    v_add_f32 v47, 1.0, v47
    v_rcp_f32 v40, v40
    v_rcp_f32 v41, v41
    v_rcp_f32 v42, v42
    v_rcp_f32 v43, v43
    v_rcp_f32 v44, v44
    v_rcp_f32 v45, v45
    v_rcp_f32 v46, v46
    v_rcp_f32 v47, v47
    v_mul_f32 v80, v39, v80
    v_mul_f32 v81, v39, v81
    v_mul_f32 v82, v39, v82
    v_mul_f32 v83, v39, v83
    v_mul_f32 v84, v39, v84
    v_mul_f32 v85, v39, v85
    v_mul_f32 v86, v39, v86
    v_mul_f32 v87, v39, v87
    v_mul_f32 v80, v40, v80
    v_mul_f32 v81, v41, v81
    v_mul_f32 v82, v42, v82
    v_mul_f32 v83, v43, v83
    v_mul_f32 v84, v44, v84
    v_mul_f32 v85, v45, v85
    v_mul_f32 v86, v46, v86
    v_mul_f32 v87, v47, v87
    v_cvt_pk_bf16_f32 v80, v80, v81
    v_cvt_pk_bf16_f32 v81, v82, v83
    v_cvt_pk_bf16_f32 v82, v84, v85
    v_cvt_pk_bf16_f32 v83, v86, v87
    s_add_u32 s31, s30, 65536
    s_nop 1
    v_permlane32_swap_b32 v80, v82
    v_permlane32_swap_b32 v81, v83
    buffer_store_dwordx4 v[80:83], v21, s[20:23], s31 offen sc0 sc1

    s_nop 1
    s_branch K1_done
K1_done:
K1_end:
    s_endpgm
.globl k2_kernel
.p2align 8
.type k2_kernel,@function
k2_kernel:
    s_cmp_ge_u32 s2, 256
    s_cbranch_scc1 K2_end
    s_load_dwordx2 s[4:5], s[0:1], 72
    v_lshrrev_b32 v1, 6, v0
    v_and_b32 v2, 63, v0
    s_nop 0
    v_readfirstlane_b32 s3, v1
    s_and_b32 s14, s2, 7
    s_lshl_b32 s14, s14, 2
    s_lshr_b32 s15, s2, 3
    s_and_b32 s15, s15, 3
    s_add_u32 s14, s14, s15
    s_lshr_b32 s15, s2, 5
    s_lshl_b32 s16, s15, 8
    s_lshl_b32 s17, s3, 5
    s_add_u32 s16, s16, s17
    s_lshl_b32 s17, s14, 16
    v_and_b32 v3, 31, v2
    v_lshrrev_b32 v4, 5, v2
    v_add_u32 v5, s16, v3
    v_lshlrev_b32 v6, 5, v5
    v_lshl_add_u32 v6, v4, 4, v6
    v_lshlrev_b32 v7, 4, v2
    s_waitcnt lgkmcnt(0)
    s_mov_b32 s8, s4
    s_mov_b32 s9, s5
    s_mov_b32 s10, 25165824
    s_mov_b32 s11, 0x00020000
    buffer_load_dwordx4 v[8:11], v6, s[8:11], s17 offen
    s_lshl_b32 s18, s3, 13
    s_add_u32 s19, s17, s18
    s_add_u32 s19, s19, 2097152

    s_lshl_b32 s24, s3, 11
    s_add_u32 s25, s17, s24
    s_add_u32 s25, s25, 2097152

    s_add_u32 s20, s24, 0
    s_mov_b32 m0, s20
    s_add_u32 s21, s25, 0
    buffer_load_dwordx4 v7, s[8:11], s21 offen lds

    s_add_u32 s20, s24, 1024
    s_mov_b32 m0, s20
    s_add_u32 s21, s25, 1024
    buffer_load_dwordx4 v7, s[8:11], s21 offen lds

    s_add_u32 s20, s24, 16384
    s_mov_b32 m0, s20
    s_add_u32 s21, s25, 16384
    buffer_load_dwordx4 v7, s[8:11], s21 offen lds

    s_add_u32 s20, s24, 17408
    s_mov_b32 m0, s20
    s_add_u32 s21, s25, 17408
    buffer_load_dwordx4 v7, s[8:11], s21 offen lds

    s_add_u32 s20, s24, 32768
    s_mov_b32 m0, s20
    s_add_u32 s21, s25, 32768
    buffer_load_dwordx4 v7, s[8:11], s21 offen lds

    s_add_u32 s20, s24, 33792
    s_mov_b32 m0, s20
    s_add_u32 s21, s25, 33792
    buffer_load_dwordx4 v7, s[8:11], s21 offen lds

    s_add_u32 s20, s24, 49152
    s_mov_b32 m0, s20
    s_add_u32 s21, s25, 49152
    buffer_load_dwordx4 v7, s[8:11], s21 offen lds

    s_add_u32 s20, s24, 50176
    s_mov_b32 m0, s20
    s_add_u32 s21, s25, 50176
    buffer_load_dwordx4 v7, s[8:11], s21 offen lds

    v_lshrrev_b32 v12, 5, v2
    v_lshlrev_b32 v12, 10, v12
    v_lshrrev_b32 v13, 4, v2
    v_and_b32 v13, 1, v13
    v_lshl_add_u32 v12, v13, 9, v12
    v_and_b32 v13, 15, v2
    v_lshl_add_u32 v12, v13, 4, v12
    s_and_b32 s19, s14, 1
    s_lshl_b32 s19, s19, 8
    s_lshr_b32 s20, s14, 1
    s_lshl_b32 s20, s20, 11
    s_add_u32 s19, s19, s20
    s_lshl_b32 s20, s3, 18
    s_add_u32 s19, s19, s20
    s_add_u32 s19, s19, 4194304
    s_add_u32 s22, s18, 65536

    s_add_u32 s20, s22, 0
    s_mov_b32 m0, s20
    s_add_u32 s21, s19, 0
    buffer_load_dwordx4 v12, s[8:11], s21 offen lds

    s_add_u32 s20, s22, 1024
    s_mov_b32 m0, s20
    s_add_u32 s21, s19, 32768
    buffer_load_dwordx4 v12, s[8:11], s21 offen lds

    s_add_u32 s20, s22, 2048
    s_mov_b32 m0, s20
    s_add_u32 s21, s19, 65536
    buffer_load_dwordx4 v12, s[8:11], s21 offen lds

    s_add_u32 s20, s22, 3072
    s_mov_b32 m0, s20
    s_add_u32 s21, s19, 98304
    buffer_load_dwordx4 v12, s[8:11], s21 offen lds

    s_add_u32 s20, s22, 4096
    s_mov_b32 m0, s20
    s_add_u32 s21, s19, 131072
    buffer_load_dwordx4 v12, s[8:11], s21 offen lds

    s_add_u32 s20, s22, 5120
    s_mov_b32 m0, s20
    s_add_u32 s21, s19, 163840
    buffer_load_dwordx4 v12, s[8:11], s21 offen lds

    s_add_u32 s20, s22, 6144
    s_mov_b32 m0, s20
    s_add_u32 s21, s19, 196608
    buffer_load_dwordx4 v12, s[8:11], s21 offen lds

    s_add_u32 s20, s22, 7168
    s_mov_b32 m0, s20
    s_add_u32 s21, s19, 229376
    buffer_load_dwordx4 v12, s[8:11], s21 offen lds

    v_lshlrev_b32 v12, 5, v3
    v_lshl_add_u32 v12, v4, 4, v12
    v_mov_b32 v13, 0xff7fffff
    v_mov_b32 v14, 0xff7fffff

    v_mov_b32 v128, 0xff7fffff
    v_mov_b32 v129, 0xff7fffff
    v_mov_b32 v130, 0xff7fffff
    v_mov_b32 v131, 0xff7fffff
    v_mov_b32 v132, 0xff7fffff
    v_mov_b32 v133, 0xff7fffff
    v_mov_b32 v134, 0xff7fffff
    v_mov_b32 v135, 0xff7fffff
    v_mov_b32 v136, 0xff7fffff
    v_mov_b32 v137, 0xff7fffff
    v_mov_b32 v138, 0xff7fffff
    v_mov_b32 v139, 0xff7fffff
    v_mov_b32 v140, 0xff7fffff
    v_mov_b32 v141, 0xff7fffff
    v_mov_b32 v142, 0xff7fffff
    v_mov_b32 v143, 0xff7fffff
    v_mov_b32 v144, 0xff7fffff
    v_mov_b32 v145, 0xff7fffff
    v_mov_b32 v146, 0xff7fffff
    v_mov_b32 v147, 0xff7fffff
    v_mov_b32 v148, 0xff7fffff
    v_mov_b32 v149, 0xff7fffff
    v_mov_b32 v150, 0xff7fffff
    v_mov_b32 v151, 0xff7fffff
    v_mov_b32 v152, 0xff7fffff
    v_mov_b32 v153, 0xff7fffff
    v_mov_b32 v154, 0xff7fffff
    v_mov_b32 v155, 0xff7fffff
    v_mov_b32 v156, 0xff7fffff
    v_mov_b32 v157, 0xff7fffff
    v_mov_b32 v158, 0xff7fffff
    v_mov_b32 v159, 0xff7fffff
    v_mov_b32 v160, 0xff7fffff
    v_mov_b32 v161, 0xff7fffff
    v_mov_b32 v162, 0xff7fffff
    v_mov_b32 v163, 0xff7fffff
    v_mov_b32 v164, 0xff7fffff
    v_mov_b32 v165, 0xff7fffff
    v_mov_b32 v166, 0xff7fffff
    v_mov_b32 v167, 0xff7fffff
    v_mov_b32 v168, 0xff7fffff
    v_mov_b32 v169, 0xff7fffff
    v_mov_b32 v170, 0xff7fffff
    v_mov_b32 v171, 0xff7fffff
    v_mov_b32 v172, 0xff7fffff
    v_mov_b32 v173, 0xff7fffff
    v_mov_b32 v174, 0xff7fffff
    v_mov_b32 v175, 0xff7fffff
    v_mov_b32 v176, 0xff7fffff
    v_mov_b32 v177, 0xff7fffff
    v_mov_b32 v178, 0xff7fffff
    v_mov_b32 v179, 0xff7fffff
    v_mov_b32 v180, 0xff7fffff
    v_mov_b32 v181, 0xff7fffff
    v_mov_b32 v182, 0xff7fffff
    v_mov_b32 v183, 0xff7fffff
    v_mov_b32 v184, 0xff7fffff
    v_mov_b32 v185, 0xff7fffff
    v_mov_b32 v186, 0xff7fffff
    v_mov_b32 v187, 0xff7fffff
    v_mov_b32 v188, 0xff7fffff
    v_mov_b32 v189, 0xff7fffff
    v_mov_b32 v190, 0xff7fffff
    v_mov_b32 v191, 0xff7fffff
    s_waitcnt vmcnt(14)
    s_barrier

    ds_read_b128 v[16:19], v12 offset:0
    ds_read_b128 v[20:23], v12 offset:1024
    ds_read_b128 v[24:27], v12 offset:2048
    ds_read_b128 v[28:31], v12 offset:3072
    ds_read_b128 v[32:35], v12 offset:4096
    ds_read_b128 v[36:39], v12 offset:5120
    ds_read_b128 v[40:43], v12 offset:6144
    ds_read_b128 v[44:47], v12 offset:7168
    s_waitcnt lgkmcnt(4)
    v_mfma_f32_32x32x16_bf16 v[64:79], v[16:19], v[8:11], 0
    v_max3_f32 v13, v13, v128, v129
    v_max3_f32 v14, v14, v130, v131
    v_max3_f32 v13, v13, v132, v133
    v_max3_f32 v14, v14, v134, v135
    v_max3_f32 v13, v13, v136, v137
    v_max3_f32 v14, v14, v138, v139
    v_max3_f32 v13, v13, v140, v141
    v_max3_f32 v14, v14, v142, v143
    v_mfma_f32_32x32x16_bf16 v[80:95], v[20:23], v[8:11], 0
    v_max3_f32 v13, v13, v144, v145
    v_max3_f32 v14, v14, v146, v147
    v_max3_f32 v13, v13, v148, v149
    v_max3_f32 v14, v14, v150, v151
    v_max3_f32 v13, v13, v152, v153
    v_max3_f32 v14, v14, v154, v155
    v_max3_f32 v13, v13, v156, v157
    v_max3_f32 v14, v14, v158, v159
    v_mfma_f32_32x32x16_bf16 v[96:111], v[24:27], v[8:11], 0
    v_max3_f32 v13, v13, v160, v161
    v_max3_f32 v14, v14, v162, v163
    v_max3_f32 v13, v13, v164, v165
    v_max3_f32 v14, v14, v166, v167
    v_max3_f32 v13, v13, v168, v169
    v_max3_f32 v14, v14, v170, v171
    v_max3_f32 v13, v13, v172, v173
    v_max3_f32 v14, v14, v174, v175
    v_mfma_f32_32x32x16_bf16 v[112:127], v[28:31], v[8:11], 0
    v_max3_f32 v13, v13, v176, v177
    v_max3_f32 v14, v14, v178, v179
    v_max3_f32 v13, v13, v180, v181
    v_max3_f32 v14, v14, v182, v183
    v_max3_f32 v13, v13, v184, v185
    v_max3_f32 v14, v14, v186, v187
    v_max3_f32 v13, v13, v188, v189
    v_max3_f32 v14, v14, v190, v191
    ds_read_b128 v[16:19], v12 offset:8192
    ds_read_b128 v[20:23], v12 offset:9216
    ds_read_b128 v[24:27], v12 offset:10240
    ds_read_b128 v[28:31], v12 offset:11264
    s_waitcnt lgkmcnt(4)
    v_mfma_f32_32x32x16_bf16 v[128:143], v[32:35], v[8:11], 0
    v_max3_f32 v13, v13, v64, v65
    v_max3_f32 v14, v14, v66, v67
    v_max3_f32 v13, v13, v68, v69
    v_max3_f32 v14, v14, v70, v71
    v_max3_f32 v13, v13, v72, v73
    v_max3_f32 v14, v14, v74, v75
    v_max3_f32 v13, v13, v76, v77
    v_max3_f32 v14, v14, v78, v79
    v_mfma_f32_32x32x16_bf16 v[144:159], v[36:39], v[8:11], 0
    v_max3_f32 v13, v13, v80, v81
    v_max3_f32 v14, v14, v82, v83
    v_max3_f32 v13, v13, v84, v85
    v_max3_f32 v14, v14, v86, v87
    v_max3_f32 v13, v13, v88, v89
    v_max3_f32 v14, v14, v90, v91
    v_max3_f32 v13, v13, v92, v93
    v_max3_f32 v14, v14, v94, v95
    v_mfma_f32_32x32x16_bf16 v[160:175], v[40:43], v[8:11], 0
    v_max3_f32 v13, v13, v96, v97
    v_max3_f32 v14, v14, v98, v99
    v_max3_f32 v13, v13, v100, v101
    v_max3_f32 v14, v14, v102, v103
    v_max3_f32 v13, v13, v104, v105
    v_max3_f32 v14, v14, v106, v107
    v_max3_f32 v13, v13, v108, v109
    v_max3_f32 v14, v14, v110, v111
    v_mfma_f32_32x32x16_bf16 v[176:191], v[44:47], v[8:11], 0
    v_max3_f32 v13, v13, v112, v113
    v_max3_f32 v14, v14, v114, v115
    v_max3_f32 v13, v13, v116, v117
    v_max3_f32 v14, v14, v118, v119
    v_max3_f32 v13, v13, v120, v121
    v_max3_f32 v14, v14, v122, v123
    v_max3_f32 v13, v13, v124, v125
    v_max3_f32 v14, v14, v126, v127
    ds_read_b128 v[32:35], v12 offset:12288
    ds_read_b128 v[36:39], v12 offset:13312
    ds_read_b128 v[40:43], v12 offset:14336
    ds_read_b128 v[44:47], v12 offset:15360
    s_waitcnt lgkmcnt(4)
    v_mfma_f32_32x32x16_bf16 v[64:79], v[16:19], v[8:11], 0
    v_max3_f32 v13, v13, v128, v129
    v_max3_f32 v14, v14, v130, v131
    v_max3_f32 v13, v13, v132, v133
    v_max3_f32 v14, v14, v134, v135
    v_max3_f32 v13, v13, v136, v137
    v_max3_f32 v14, v14, v138, v139
    v_max3_f32 v13, v13, v140, v141
    v_max3_f32 v14, v14, v142, v143
    v_mfma_f32_32x32x16_bf16 v[80:95], v[20:23], v[8:11], 0
    v_max3_f32 v13, v13, v144, v145
    v_max3_f32 v14, v14, v146, v147
    v_max3_f32 v13, v13, v148, v149
    v_max3_f32 v14, v14, v150, v151
    v_max3_f32 v13, v13, v152, v153
    v_max3_f32 v14, v14, v154, v155
    v_max3_f32 v13, v13, v156, v157
    v_max3_f32 v14, v14, v158, v159
    v_mfma_f32_32x32x16_bf16 v[96:111], v[24:27], v[8:11], 0
    v_max3_f32 v13, v13, v160, v161
    v_max3_f32 v14, v14, v162, v163
    v_max3_f32 v13, v13, v164, v165
    v_max3_f32 v14, v14, v166, v167
    v_max3_f32 v13, v13, v168, v169
    v_max3_f32 v14, v14, v170, v171
    v_max3_f32 v13, v13, v172, v173
    v_max3_f32 v14, v14, v174, v175
    v_mfma_f32_32x32x16_bf16 v[112:127], v[28:31], v[8:11], 0
    v_max3_f32 v13, v13, v176, v177
    v_max3_f32 v14, v14, v178, v179
    v_max3_f32 v13, v13, v180, v181
    v_max3_f32 v14, v14, v182, v183
    v_max3_f32 v13, v13, v184, v185
    v_max3_f32 v14, v14, v186, v187
    v_max3_f32 v13, v13, v188, v189
    v_max3_f32 v14, v14, v190, v191
    s_waitcnt vmcnt(12)
    s_barrier
    ds_read_b128 v[16:19], v12 offset:16384
    ds_read_b128 v[20:23], v12 offset:17408
    ds_read_b128 v[24:27], v12 offset:18432
    ds_read_b128 v[28:31], v12 offset:19456
    s_waitcnt lgkmcnt(4)
    v_mfma_f32_32x32x16_bf16 v[128:143], v[32:35], v[8:11], 0
    v_max3_f32 v13, v13, v64, v65
    v_max3_f32 v14, v14, v66, v67
    v_max3_f32 v13, v13, v68, v69
    v_max3_f32 v14, v14, v70, v71
    v_max3_f32 v13, v13, v72, v73
    v_max3_f32 v14, v14, v74, v75
    v_max3_f32 v13, v13, v76, v77
    v_max3_f32 v14, v14, v78, v79
    v_mfma_f32_32x32x16_bf16 v[144:159], v[36:39], v[8:11], 0
    v_max3_f32 v13, v13, v80, v81
    v_max3_f32 v14, v14, v82, v83
    v_max3_f32 v13, v13, v84, v85
    v_max3_f32 v14, v14, v86, v87
    v_max3_f32 v13, v13, v88, v89
    v_max3_f32 v14, v14, v90, v91
    v_max3_f32 v13, v13, v92, v93
    v_max3_f32 v14, v14, v94, v95
    v_mfma_f32_32x32x16_bf16 v[160:175], v[40:43], v[8:11], 0
    v_max3_f32 v13, v13, v96, v97
    v_max3_f32 v14, v14, v98, v99
    v_max3_f32 v13, v13, v100, v101
    v_max3_f32 v14, v14, v102, v103
    v_max3_f32 v13, v13, v104, v105
    v_max3_f32 v14, v14, v106, v107
    v_max3_f32 v13, v13, v108, v109
    v_max3_f32 v14, v14, v110, v111
    v_mfma_f32_32x32x16_bf16 v[176:191], v[44:47], v[8:11], 0
    v_max3_f32 v13, v13, v112, v113
    v_max3_f32 v14, v14, v114, v115
    v_max3_f32 v13, v13, v116, v117
    v_max3_f32 v14, v14, v118, v119
    v_max3_f32 v13, v13, v120, v121
    v_max3_f32 v14, v14, v122, v123
    v_max3_f32 v13, v13, v124, v125
    v_max3_f32 v14, v14, v126, v127
    ds_read_b128 v[32:35], v12 offset:20480
    ds_read_b128 v[36:39], v12 offset:21504
    ds_read_b128 v[40:43], v12 offset:22528
    ds_read_b128 v[44:47], v12 offset:23552
    s_waitcnt lgkmcnt(4)
    v_mfma_f32_32x32x16_bf16 v[64:79], v[16:19], v[8:11], 0
    v_max3_f32 v13, v13, v128, v129
    v_max3_f32 v14, v14, v130, v131
    v_max3_f32 v13, v13, v132, v133
    v_max3_f32 v14, v14, v134, v135
    v_max3_f32 v13, v13, v136, v137
    v_max3_f32 v14, v14, v138, v139
    v_max3_f32 v13, v13, v140, v141
    v_max3_f32 v14, v14, v142, v143
    v_mfma_f32_32x32x16_bf16 v[80:95], v[20:23], v[8:11], 0
    v_max3_f32 v13, v13, v144, v145
    v_max3_f32 v14, v14, v146, v147
    v_max3_f32 v13, v13, v148, v149
    v_max3_f32 v14, v14, v150, v151
    v_max3_f32 v13, v13, v152, v153
    v_max3_f32 v14, v14, v154, v155
    v_max3_f32 v13, v13, v156, v157
    v_max3_f32 v14, v14, v158, v159
    v_mfma_f32_32x32x16_bf16 v[96:111], v[24:27], v[8:11], 0
    v_max3_f32 v13, v13, v160, v161
    v_max3_f32 v14, v14, v162, v163
    v_max3_f32 v13, v13, v164, v165
    v_max3_f32 v14, v14, v166, v167
    v_max3_f32 v13, v13, v168, v169
    v_max3_f32 v14, v14, v170, v171
    v_max3_f32 v13, v13, v172, v173
    v_max3_f32 v14, v14, v174, v175
    v_mfma_f32_32x32x16_bf16 v[112:127], v[28:31], v[8:11], 0
    v_max3_f32 v13, v13, v176, v177
    v_max3_f32 v14, v14, v178, v179
    v_max3_f32 v13, v13, v180, v181
    v_max3_f32 v14, v14, v182, v183
    v_max3_f32 v13, v13, v184, v185
    v_max3_f32 v14, v14, v186, v187
    v_max3_f32 v13, v13, v188, v189
    v_max3_f32 v14, v14, v190, v191
    ds_read_b128 v[16:19], v12 offset:24576
    ds_read_b128 v[20:23], v12 offset:25600
    ds_read_b128 v[24:27], v12 offset:26624
    ds_read_b128 v[28:31], v12 offset:27648
    s_waitcnt lgkmcnt(4)
    v_mfma_f32_32x32x16_bf16 v[128:143], v[32:35], v[8:11], 0
    v_max3_f32 v13, v13, v64, v65
    v_max3_f32 v14, v14, v66, v67
    v_max3_f32 v13, v13, v68, v69
    v_max3_f32 v14, v14, v70, v71
    v_max3_f32 v13, v13, v72, v73
    v_max3_f32 v14, v14, v74, v75
    v_max3_f32 v13, v13, v76, v77
    v_max3_f32 v14, v14, v78, v79
    v_mfma_f32_32x32x16_bf16 v[144:159], v[36:39], v[8:11], 0
    v_max3_f32 v13, v13, v80, v81
    v_max3_f32 v14, v14, v82, v83
    v_max3_f32 v13, v13, v84, v85
    v_max3_f32 v14, v14, v86, v87
    v_max3_f32 v13, v13, v88, v89
    v_max3_f32 v14, v14, v90, v91
    v_max3_f32 v13, v13, v92, v93
    v_max3_f32 v14, v14, v94, v95
    v_mfma_f32_32x32x16_bf16 v[160:175], v[40:43], v[8:11], 0
    v_max3_f32 v13, v13, v96, v97
    v_max3_f32 v14, v14, v98, v99
    v_max3_f32 v13, v13, v100, v101
    v_max3_f32 v14, v14, v102, v103
    v_max3_f32 v13, v13, v104, v105
    v_max3_f32 v14, v14, v106, v107
    v_max3_f32 v13, v13, v108, v109
    v_max3_f32 v14, v14, v110, v111
    v_mfma_f32_32x32x16_bf16 v[176:191], v[44:47], v[8:11], 0
    v_max3_f32 v13, v13, v112, v113
    v_max3_f32 v14, v14, v114, v115
    v_max3_f32 v13, v13, v116, v117
    v_max3_f32 v14, v14, v118, v119
    v_max3_f32 v13, v13, v120, v121
    v_max3_f32 v14, v14, v122, v123
    v_max3_f32 v13, v13, v124, v125
    v_max3_f32 v14, v14, v126, v127
    ds_read_b128 v[32:35], v12 offset:28672
    ds_read_b128 v[36:39], v12 offset:29696
    ds_read_b128 v[40:43], v12 offset:30720
    ds_read_b128 v[44:47], v12 offset:31744
    s_waitcnt lgkmcnt(4)
    v_mfma_f32_32x32x16_bf16 v[64:79], v[16:19], v[8:11], 0
    v_max3_f32 v13, v13, v128, v129
    v_max3_f32 v14, v14, v130, v131
    v_max3_f32 v13, v13, v132, v133
    v_max3_f32 v14, v14, v134, v135
    v_max3_f32 v13, v13, v136, v137
    v_max3_f32 v14, v14, v138, v139
    v_max3_f32 v13, v13, v140, v141
    v_max3_f32 v14, v14, v142, v143
    v_mfma_f32_32x32x16_bf16 v[80:95], v[20:23], v[8:11], 0
    v_max3_f32 v13, v13, v144, v145
    v_max3_f32 v14, v14, v146, v147
    v_max3_f32 v13, v13, v148, v149
    v_max3_f32 v14, v14, v150, v151
    v_max3_f32 v13, v13, v152, v153
    v_max3_f32 v14, v14, v154, v155
    v_max3_f32 v13, v13, v156, v157
    v_max3_f32 v14, v14, v158, v159
    v_mfma_f32_32x32x16_bf16 v[96:111], v[24:27], v[8:11], 0
    v_max3_f32 v13, v13, v160, v161
    v_max3_f32 v14, v14, v162, v163
    v_max3_f32 v13, v13, v164, v165
    v_max3_f32 v14, v14, v166, v167
    v_max3_f32 v13, v13, v168, v169
    v_max3_f32 v14, v14, v170, v171
    v_max3_f32 v13, v13, v172, v173
    v_max3_f32 v14, v14, v174, v175
    v_mfma_f32_32x32x16_bf16 v[112:127], v[28:31], v[8:11], 0
    v_max3_f32 v13, v13, v176, v177
    v_max3_f32 v14, v14, v178, v179
    v_max3_f32 v13, v13, v180, v181
    v_max3_f32 v14, v14, v182, v183
    v_max3_f32 v13, v13, v184, v185
    v_max3_f32 v14, v14, v186, v187
    v_max3_f32 v13, v13, v188, v189
    v_max3_f32 v14, v14, v190, v191
    s_waitcnt vmcnt(10)
    s_barrier
    ds_read_b128 v[16:19], v12 offset:32768
    ds_read_b128 v[20:23], v12 offset:33792
    ds_read_b128 v[24:27], v12 offset:34816
    ds_read_b128 v[28:31], v12 offset:35840
    s_waitcnt lgkmcnt(4)
    v_mfma_f32_32x32x16_bf16 v[128:143], v[32:35], v[8:11], 0
    v_max3_f32 v13, v13, v64, v65
    v_max3_f32 v14, v14, v66, v67
    v_max3_f32 v13, v13, v68, v69
    v_max3_f32 v14, v14, v70, v71
    v_max3_f32 v13, v13, v72, v73
    v_max3_f32 v14, v14, v74, v75
    v_max3_f32 v13, v13, v76, v77
    v_max3_f32 v14, v14, v78, v79
    v_mfma_f32_32x32x16_bf16 v[144:159], v[36:39], v[8:11], 0
    v_max3_f32 v13, v13, v80, v81
    v_max3_f32 v14, v14, v82, v83
    v_max3_f32 v13, v13, v84, v85
    v_max3_f32 v14, v14, v86, v87
    v_max3_f32 v13, v13, v88, v89
    v_max3_f32 v14, v14, v90, v91
    v_max3_f32 v13, v13, v92, v93
    v_max3_f32 v14, v14, v94, v95
    v_mfma_f32_32x32x16_bf16 v[160:175], v[40:43], v[8:11], 0
    v_max3_f32 v13, v13, v96, v97
    v_max3_f32 v14, v14, v98, v99
    v_max3_f32 v13, v13, v100, v101
    v_max3_f32 v14, v14, v102, v103
    v_max3_f32 v13, v13, v104, v105
    v_max3_f32 v14, v14, v106, v107
    v_max3_f32 v13, v13, v108, v109
    v_max3_f32 v14, v14, v110, v111
    v_mfma_f32_32x32x16_bf16 v[176:191], v[44:47], v[8:11], 0
    v_max3_f32 v13, v13, v112, v113
    v_max3_f32 v14, v14, v114, v115
    v_max3_f32 v13, v13, v116, v117
    v_max3_f32 v14, v14, v118, v119
    v_max3_f32 v13, v13, v120, v121
    v_max3_f32 v14, v14, v122, v123
    v_max3_f32 v13, v13, v124, v125
    v_max3_f32 v14, v14, v126, v127
    ds_read_b128 v[32:35], v12 offset:36864
    ds_read_b128 v[36:39], v12 offset:37888
    ds_read_b128 v[40:43], v12 offset:38912
    ds_read_b128 v[44:47], v12 offset:39936
    s_waitcnt lgkmcnt(4)
    v_mfma_f32_32x32x16_bf16 v[64:79], v[16:19], v[8:11], 0
    v_max3_f32 v13, v13, v128, v129
    v_max3_f32 v14, v14, v130, v131
    v_max3_f32 v13, v13, v132, v133
    v_max3_f32 v14, v14, v134, v135
    v_max3_f32 v13, v13, v136, v137
    v_max3_f32 v14, v14, v138, v139
    v_max3_f32 v13, v13, v140, v141
    v_max3_f32 v14, v14, v142, v143
    v_mfma_f32_32x32x16_bf16 v[80:95], v[20:23], v[8:11], 0
    v_max3_f32 v13, v13, v144, v145
    v_max3_f32 v14, v14, v146, v147
    v_max3_f32 v13, v13, v148, v149
    v_max3_f32 v14, v14, v150, v151
    v_max3_f32 v13, v13, v152, v153
    v_max3_f32 v14, v14, v154, v155
    v_max3_f32 v13, v13, v156, v157
    v_max3_f32 v14, v14, v158, v159
    v_mfma_f32_32x32x16_bf16 v[96:111], v[24:27], v[8:11], 0
    v_max3_f32 v13, v13, v160, v161
    v_max3_f32 v14, v14, v162, v163
    v_max3_f32 v13, v13, v164, v165
    v_max3_f32 v14, v14, v166, v167
    v_max3_f32 v13, v13, v168, v169
    v_max3_f32 v14, v14, v170, v171
    v_max3_f32 v13, v13, v172, v173
    v_max3_f32 v14, v14, v174, v175
    v_mfma_f32_32x32x16_bf16 v[112:127], v[28:31], v[8:11], 0
    v_max3_f32 v13, v13, v176, v177
    v_max3_f32 v14, v14, v178, v179
    v_max3_f32 v13, v13, v180, v181
    v_max3_f32 v14, v14, v182, v183
    v_max3_f32 v13, v13, v184, v185
    v_max3_f32 v14, v14, v186, v187
    v_max3_f32 v13, v13, v188, v189
    v_max3_f32 v14, v14, v190, v191
    ds_read_b128 v[16:19], v12 offset:40960
    ds_read_b128 v[20:23], v12 offset:41984
    ds_read_b128 v[24:27], v12 offset:43008
    ds_read_b128 v[28:31], v12 offset:44032
    s_waitcnt lgkmcnt(4)
    v_mfma_f32_32x32x16_bf16 v[128:143], v[32:35], v[8:11], 0
    v_max3_f32 v13, v13, v64, v65
    v_max3_f32 v14, v14, v66, v67
    v_max3_f32 v13, v13, v68, v69
    v_max3_f32 v14, v14, v70, v71
    v_max3_f32 v13, v13, v72, v73
    v_max3_f32 v14, v14, v74, v75
    v_max3_f32 v13, v13, v76, v77
    v_max3_f32 v14, v14, v78, v79
    v_mfma_f32_32x32x16_bf16 v[144:159], v[36:39], v[8:11], 0
    v_max3_f32 v13, v13, v80, v81
    v_max3_f32 v14, v14, v82, v83
    v_max3_f32 v13, v13, v84, v85
    v_max3_f32 v14, v14, v86, v87
    v_max3_f32 v13, v13, v88, v89
    v_max3_f32 v14, v14, v90, v91
    v_max3_f32 v13, v13, v92, v93
    v_max3_f32 v14, v14, v94, v95
    v_mfma_f32_32x32x16_bf16 v[160:175], v[40:43], v[8:11], 0
    v_max3_f32 v13, v13, v96, v97
    v_max3_f32 v14, v14, v98, v99
    v_max3_f32 v13, v13, v100, v101
    v_max3_f32 v14, v14, v102, v103
    v_max3_f32 v13, v13, v104, v105
    v_max3_f32 v14, v14, v106, v107
    v_max3_f32 v13, v13, v108, v109
    v_max3_f32 v14, v14, v110, v111
    v_mfma_f32_32x32x16_bf16 v[176:191], v[44:47], v[8:11], 0
    v_max3_f32 v13, v13, v112, v113
    v_max3_f32 v14, v14, v114, v115
    v_max3_f32 v13, v13, v116, v117
    v_max3_f32 v14, v14, v118, v119
    v_max3_f32 v13, v13, v120, v121
    v_max3_f32 v14, v14, v122, v123
    v_max3_f32 v13, v13, v124, v125
    v_max3_f32 v14, v14, v126, v127
    ds_read_b128 v[32:35], v12 offset:45056
    ds_read_b128 v[36:39], v12 offset:46080
    ds_read_b128 v[40:43], v12 offset:47104
    ds_read_b128 v[44:47], v12 offset:48128
    s_waitcnt lgkmcnt(4)
    v_mfma_f32_32x32x16_bf16 v[64:79], v[16:19], v[8:11], 0
    v_max3_f32 v13, v13, v128, v129
    v_max3_f32 v14, v14, v130, v131
    v_max3_f32 v13, v13, v132, v133
    v_max3_f32 v14, v14, v134, v135
    v_max3_f32 v13, v13, v136, v137
    v_max3_f32 v14, v14, v138, v139
    v_max3_f32 v13, v13, v140, v141
    v_max3_f32 v14, v14, v142, v143
    v_mfma_f32_32x32x16_bf16 v[80:95], v[20:23], v[8:11], 0
    v_max3_f32 v13, v13, v144, v145
    v_max3_f32 v14, v14, v146, v147
    v_max3_f32 v13, v13, v148, v149
    v_max3_f32 v14, v14, v150, v151
    v_max3_f32 v13, v13, v152, v153
    v_max3_f32 v14, v14, v154, v155
    v_max3_f32 v13, v13, v156, v157
    v_max3_f32 v14, v14, v158, v159
    v_mfma_f32_32x32x16_bf16 v[96:111], v[24:27], v[8:11], 0
    v_max3_f32 v13, v13, v160, v161
    v_max3_f32 v14, v14, v162, v163
    v_max3_f32 v13, v13, v164, v165
    v_max3_f32 v14, v14, v166, v167
    v_max3_f32 v13, v13, v168, v169
    v_max3_f32 v14, v14, v170, v171
    v_max3_f32 v13, v13, v172, v173
    v_max3_f32 v14, v14, v174, v175
    v_mfma_f32_32x32x16_bf16 v[112:127], v[28:31], v[8:11], 0
    v_max3_f32 v13, v13, v176, v177
    v_max3_f32 v14, v14, v178, v179
    v_max3_f32 v13, v13, v180, v181
    v_max3_f32 v14, v14, v182, v183
    v_max3_f32 v13, v13, v184, v185
    v_max3_f32 v14, v14, v186, v187
    v_max3_f32 v13, v13, v188, v189
    v_max3_f32 v14, v14, v190, v191
    s_waitcnt vmcnt(8)
    s_barrier
    ds_read_b128 v[16:19], v12 offset:49152
    ds_read_b128 v[20:23], v12 offset:50176
    ds_read_b128 v[24:27], v12 offset:51200
    ds_read_b128 v[28:31], v12 offset:52224
    s_waitcnt lgkmcnt(4)
    v_mfma_f32_32x32x16_bf16 v[128:143], v[32:35], v[8:11], 0
    v_max3_f32 v13, v13, v64, v65
    v_max3_f32 v14, v14, v66, v67
    v_max3_f32 v13, v13, v68, v69
    v_max3_f32 v14, v14, v70, v71
    v_max3_f32 v13, v13, v72, v73
    v_max3_f32 v14, v14, v74, v75
    v_max3_f32 v13, v13, v76, v77
    v_max3_f32 v14, v14, v78, v79
    v_mfma_f32_32x32x16_bf16 v[144:159], v[36:39], v[8:11], 0
    v_max3_f32 v13, v13, v80, v81
    v_max3_f32 v14, v14, v82, v83
    v_max3_f32 v13, v13, v84, v85
    v_max3_f32 v14, v14, v86, v87
    v_max3_f32 v13, v13, v88, v89
    v_max3_f32 v14, v14, v90, v91
    v_max3_f32 v13, v13, v92, v93
    v_max3_f32 v14, v14, v94, v95
    v_mfma_f32_32x32x16_bf16 v[160:175], v[40:43], v[8:11], 0
    v_max3_f32 v13, v13, v96, v97
    v_max3_f32 v14, v14, v98, v99
    v_max3_f32 v13, v13, v100, v101
    v_max3_f32 v14, v14, v102, v103
    v_max3_f32 v13, v13, v104, v105
    v_max3_f32 v14, v14, v106, v107
    v_max3_f32 v13, v13, v108, v109
    v_max3_f32 v14, v14, v110, v111
    v_mfma_f32_32x32x16_bf16 v[176:191], v[44:47], v[8:11], 0
    v_max3_f32 v13, v13, v112, v113
    v_max3_f32 v14, v14, v114, v115
    v_max3_f32 v13, v13, v116, v117
    v_max3_f32 v14, v14, v118, v119
    v_max3_f32 v13, v13, v120, v121
    v_max3_f32 v14, v14, v122, v123
    v_max3_f32 v13, v13, v124, v125
    v_max3_f32 v14, v14, v126, v127
    ds_read_b128 v[32:35], v12 offset:53248
    ds_read_b128 v[36:39], v12 offset:54272
    ds_read_b128 v[40:43], v12 offset:55296
    ds_read_b128 v[44:47], v12 offset:56320
    s_waitcnt lgkmcnt(4)
    v_mfma_f32_32x32x16_bf16 v[64:79], v[16:19], v[8:11], 0
    v_max3_f32 v13, v13, v128, v129
    v_max3_f32 v14, v14, v130, v131
    v_max3_f32 v13, v13, v132, v133
    v_max3_f32 v14, v14, v134, v135
    v_max3_f32 v13, v13, v136, v137
    v_max3_f32 v14, v14, v138, v139
    v_max3_f32 v13, v13, v140, v141
    v_max3_f32 v14, v14, v142, v143
    v_mfma_f32_32x32x16_bf16 v[80:95], v[20:23], v[8:11], 0
    v_max3_f32 v13, v13, v144, v145
    v_max3_f32 v14, v14, v146, v147
    v_max3_f32 v13, v13, v148, v149
    v_max3_f32 v14, v14, v150, v151
    v_max3_f32 v13, v13, v152, v153
    v_max3_f32 v14, v14, v154, v155
    v_max3_f32 v13, v13, v156, v157
    v_max3_f32 v14, v14, v158, v159
    v_mfma_f32_32x32x16_bf16 v[96:111], v[24:27], v[8:11], 0
    v_max3_f32 v13, v13, v160, v161
    v_max3_f32 v14, v14, v162, v163
    v_max3_f32 v13, v13, v164, v165
    v_max3_f32 v14, v14, v166, v167
    v_max3_f32 v13, v13, v168, v169
    v_max3_f32 v14, v14, v170, v171
    v_max3_f32 v13, v13, v172, v173
    v_max3_f32 v14, v14, v174, v175
    v_mfma_f32_32x32x16_bf16 v[112:127], v[28:31], v[8:11], 0
    v_max3_f32 v13, v13, v176, v177
    v_max3_f32 v14, v14, v178, v179
    v_max3_f32 v13, v13, v180, v181
    v_max3_f32 v14, v14, v182, v183
    v_max3_f32 v13, v13, v184, v185
    v_max3_f32 v14, v14, v186, v187
    v_max3_f32 v13, v13, v188, v189
    v_max3_f32 v14, v14, v190, v191
    ds_read_b128 v[16:19], v12 offset:57344
    ds_read_b128 v[20:23], v12 offset:58368
    ds_read_b128 v[24:27], v12 offset:59392
    ds_read_b128 v[28:31], v12 offset:60416
    s_waitcnt lgkmcnt(4)
    v_mfma_f32_32x32x16_bf16 v[128:143], v[32:35], v[8:11], 0
    v_max3_f32 v13, v13, v64, v65
    v_max3_f32 v14, v14, v66, v67
    v_max3_f32 v13, v13, v68, v69
    v_max3_f32 v14, v14, v70, v71
    v_max3_f32 v13, v13, v72, v73
    v_max3_f32 v14, v14, v74, v75
    v_max3_f32 v13, v13, v76, v77
    v_max3_f32 v14, v14, v78, v79
    v_mfma_f32_32x32x16_bf16 v[144:159], v[36:39], v[8:11], 0
    v_max3_f32 v13, v13, v80, v81
    v_max3_f32 v14, v14, v82, v83
    v_max3_f32 v13, v13, v84, v85
    v_max3_f32 v14, v14, v86, v87
    v_max3_f32 v13, v13, v88, v89
    v_max3_f32 v14, v14, v90, v91
    v_max3_f32 v13, v13, v92, v93
    v_max3_f32 v14, v14, v94, v95
    v_mfma_f32_32x32x16_bf16 v[160:175], v[40:43], v[8:11], 0
    v_max3_f32 v13, v13, v96, v97
    v_max3_f32 v14, v14, v98, v99
    v_max3_f32 v13, v13, v100, v101
    v_max3_f32 v14, v14, v102, v103
    v_max3_f32 v13, v13, v104, v105
    v_max3_f32 v14, v14, v106, v107
    v_max3_f32 v13, v13, v108, v109
    v_max3_f32 v14, v14, v110, v111
    v_mfma_f32_32x32x16_bf16 v[176:191], v[44:47], v[8:11], 0
    v_max3_f32 v13, v13, v112, v113
    v_max3_f32 v14, v14, v114, v115
    v_max3_f32 v13, v13, v116, v117
    v_max3_f32 v14, v14, v118, v119
    v_max3_f32 v13, v13, v120, v121
    v_max3_f32 v14, v14, v122, v123
    v_max3_f32 v13, v13, v124, v125
    v_max3_f32 v14, v14, v126, v127
    ds_read_b128 v[32:35], v12 offset:61440
    ds_read_b128 v[36:39], v12 offset:62464
    ds_read_b128 v[40:43], v12 offset:63488
    ds_read_b128 v[44:47], v12 offset:64512
    s_waitcnt lgkmcnt(4)
    v_mfma_f32_32x32x16_bf16 v[64:79], v[16:19], v[8:11], 0
    v_max3_f32 v13, v13, v128, v129
    v_max3_f32 v14, v14, v130, v131
    v_max3_f32 v13, v13, v132, v133
    v_max3_f32 v14, v14, v134, v135
    v_max3_f32 v13, v13, v136, v137
    v_max3_f32 v14, v14, v138, v139
    v_max3_f32 v13, v13, v140, v141
    v_max3_f32 v14, v14, v142, v143
    v_mfma_f32_32x32x16_bf16 v[80:95], v[20:23], v[8:11], 0
    v_max3_f32 v13, v13, v144, v145
    v_max3_f32 v14, v14, v146, v147
    v_max3_f32 v13, v13, v148, v149
    v_max3_f32 v14, v14, v150, v151
    v_max3_f32 v13, v13, v152, v153
    v_max3_f32 v14, v14, v154, v155
    v_max3_f32 v13, v13, v156, v157
    v_max3_f32 v14, v14, v158, v159
    v_mfma_f32_32x32x16_bf16 v[96:111], v[24:27], v[8:11], 0
    v_max3_f32 v13, v13, v160, v161
    v_max3_f32 v14, v14, v162, v163
    v_max3_f32 v13, v13, v164, v165
    v_max3_f32 v14, v14, v166, v167
    v_max3_f32 v13, v13, v168, v169
    v_max3_f32 v14, v14, v170, v171
    v_max3_f32 v13, v13, v172, v173
    v_max3_f32 v14, v14, v174, v175
    v_mfma_f32_32x32x16_bf16 v[112:127], v[28:31], v[8:11], 0
    v_max3_f32 v13, v13, v176, v177
    v_max3_f32 v14, v14, v178, v179
    v_max3_f32 v13, v13, v180, v181
    v_max3_f32 v14, v14, v182, v183
    v_max3_f32 v13, v13, v184, v185
    v_max3_f32 v14, v14, v186, v187
    v_max3_f32 v13, v13, v188, v189
    v_max3_f32 v14, v14, v190, v191
    s_waitcnt lgkmcnt(0)
    v_mfma_f32_32x32x16_bf16 v[128:143], v[32:35], v[8:11], 0
    v_max3_f32 v13, v13, v64, v65
    v_max3_f32 v14, v14, v66, v67
    v_max3_f32 v13, v13, v68, v69
    v_max3_f32 v14, v14, v70, v71
    v_max3_f32 v13, v13, v72, v73
    v_max3_f32 v14, v14, v74, v75
    v_max3_f32 v13, v13, v76, v77
    v_max3_f32 v14, v14, v78, v79
    v_mfma_f32_32x32x16_bf16 v[144:159], v[36:39], v[8:11], 0
    v_max3_f32 v13, v13, v80, v81
    v_max3_f32 v14, v14, v82, v83
    v_max3_f32 v13, v13, v84, v85
    v_max3_f32 v14, v14, v86, v87
    v_max3_f32 v13, v13, v88, v89
    v_max3_f32 v14, v14, v90, v91
    v_max3_f32 v13, v13, v92, v93
    v_max3_f32 v14, v14, v94, v95
    v_mfma_f32_32x32x16_bf16 v[160:175], v[40:43], v[8:11], 0
    v_max3_f32 v13, v13, v96, v97
    v_max3_f32 v14, v14, v98, v99
    v_max3_f32 v13, v13, v100, v101
    v_max3_f32 v14, v14, v102, v103
    v_max3_f32 v13, v13, v104, v105
    v_max3_f32 v14, v14, v106, v107
    v_max3_f32 v13, v13, v108, v109
    v_max3_f32 v14, v14, v110, v111
    v_mfma_f32_32x32x16_bf16 v[176:191], v[44:47], v[8:11], 0
    v_max3_f32 v13, v13, v112, v113
    v_max3_f32 v14, v14, v114, v115
    v_max3_f32 v13, v13, v116, v117
    v_max3_f32 v14, v14, v118, v119
    v_max3_f32 v13, v13, v120, v121
    v_max3_f32 v14, v14, v122, v123
    v_max3_f32 v13, v13, v124, v125
    v_max3_f32 v14, v14, v126, v127
    s_nop 15
    v_max3_f32 v13, v13, v128, v129
    v_max3_f32 v14, v14, v130, v131
    v_max3_f32 v13, v13, v132, v133
    v_max3_f32 v14, v14, v134, v135
    v_max3_f32 v13, v13, v136, v137
    v_max3_f32 v14, v14, v138, v139
    v_max3_f32 v13, v13, v140, v141
    v_max3_f32 v14, v14, v142, v143
    v_max3_f32 v13, v13, v144, v145
    v_max3_f32 v14, v14, v146, v147
    v_max3_f32 v13, v13, v148, v149
    v_max3_f32 v14, v14, v150, v151
    v_max3_f32 v13, v13, v152, v153
    v_max3_f32 v14, v14, v154, v155
    v_max3_f32 v13, v13, v156, v157
    v_max3_f32 v14, v14, v158, v159
    v_max3_f32 v13, v13, v160, v161
    v_max3_f32 v14, v14, v162, v163
    v_max3_f32 v13, v13, v164, v165
    v_max3_f32 v14, v14, v166, v167
    v_max3_f32 v13, v13, v168, v169
    v_max3_f32 v14, v14, v170, v171
    v_max3_f32 v13, v13, v172, v173
    v_max3_f32 v14, v14, v174, v175
    v_max3_f32 v13, v13, v176, v177
    v_max3_f32 v14, v14, v178, v179
    v_max3_f32 v13, v13, v180, v181
    v_max3_f32 v14, v14, v182, v183
    v_max3_f32 v13, v13, v184, v185
    v_max3_f32 v14, v14, v186, v187
    v_max3_f32 v13, v13, v188, v189
    v_max3_f32 v14, v14, v190, v191
    v_max_f32 v13, v13, v14
    v_mov_b32 v14, v13
    s_nop 1
    v_permlane32_swap_b32 v13, v14
    s_nop 1
    v_max_f32 v13, v13, v14
    v_sub_f32 v13, 0, v13

    v_mov_b32 v48, v13
    v_mov_b32 v96, 0
    v_mov_b32 v49, v13
    v_mov_b32 v97, 0
    v_mov_b32 v50, v13
    v_mov_b32 v98, 0
    v_mov_b32 v51, v13
    v_mov_b32 v99, 0
    v_mov_b32 v52, v13
    v_mov_b32 v100, 0
    v_mov_b32 v53, v13
    v_mov_b32 v101, 0
    v_mov_b32 v54, v13
    v_mov_b32 v102, 0
    v_mov_b32 v55, v13
    v_mov_b32 v103, 0
    v_mov_b32 v56, v13
    v_mov_b32 v104, 0
    v_mov_b32 v57, v13
    v_mov_b32 v105, 0
    v_mov_b32 v58, v13
    v_mov_b32 v106, 0
    v_mov_b32 v59, v13
    v_mov_b32 v107, 0
    v_mov_b32 v60, v13
    v_mov_b32 v108, 0
    v_mov_b32 v61, v13
    v_mov_b32 v109, 0
    v_mov_b32 v62, v13
    v_mov_b32 v110, 0
    v_mov_b32 v63, v13
    v_mov_b32 v111, 0
    s_waitcnt lgkmcnt(0)
    v_cmp_eq_u32 vcc, 16, v3
    v_mov_b32 v15, 0x3f803f80
    s_nop 1
    v_cndmask_b32 v15, 0, v15, vcc

    v_mov_b32 v24, v15
    v_mov_b32 v25, v15
    v_mov_b32 v26, v15
    v_mov_b32 v27, v15
    v_mov_b32 v28, v15
    v_mov_b32 v29, v15
    v_mov_b32 v30, v15
    v_mov_b32 v31, v15
    v_mov_b32 v32, v15
    v_mov_b32 v33, v15
    v_mov_b32 v34, v15
    v_mov_b32 v35, v15
    v_mov_b32 v36, v15
    v_mov_b32 v37, v15
    v_mov_b32 v38, v15
    v_mov_b32 v39, v15
    v_lshlrev_b32 v12, 5, v3
    v_lshl_add_u32 v12, v4, 4, v12
    v_lshlrev_b32 v15, 4, v3
    v_lshl_add_u32 v15, v4, 8, v15
    v_add_u32 v15, 65536, v15
    s_mov_b32 s26, 0x0000ffff
    s_mov_b32 s27, 0x0000ffff
    s_waitcnt vmcnt(0)
    s_barrier
    ds_read_b128 v[16:19], v12
    ds_read_b128 v[20:23], v12 offset:1024
    s_mov_b64 exec, s[26:27]
    ds_read_b128 v[24:27], v15
    ds_read_b128 v[28:31], v15 offset:512
    s_mov_b64 exec, -1
    s_waitcnt lgkmcnt(0)
    v_mfma_f32_32x32x16_bf16 v[64:79], v[16:19], v[8:11], v[48:63]
    s_mov_b32 s23, 0
    s_and_b32 s36, s3, 1
    s_lshr_b32 s37, s3, 1
    s_and_b32 s37, s37, 1
    s_lshr_b32 s38, s3, 2
    s_lshl_b32 s39, s14, 1
    s_add_u32 s39, s39, s36
    s_lshl_b32 s40, s15, 1
    s_add_u32 s40, s40, s37
    s_add_u32 s41, s38, 32
    s_lshl_b32 s42, s41, 16
    s_lshl_b32 s43, s39, 10
    s_add_u32 s42, s42, s43
    s_add_u32 s42, s42, 6291456
    s_mul_i32 s43, s40, 118
    s_add_u32 s43, s43, s41
    s_lshl_b32 s43, s43, 10
    s_add_u32 s43, s43, 14680064

    v_lshlrev_b32 v160, 5, v3
    v_lshl_add_u32 v160, v4, 4, v160

    buffer_load_dwordx4 v[128:131], v160, s[8:11], s42 offen
    buffer_load_dwordx4 v[132:135], v7, s[8:11], s43 offen
    s_add_u32 s42, s42, 131072
    s_add_u32 s43, s43, 2048

    buffer_load_dwordx4 v[136:139], v160, s[8:11], s42 offen
    buffer_load_dwordx4 v[140:143], v7, s[8:11], s43 offen
    s_add_u32 s42, s42, 131072
    s_add_u32 s43, s43, 2048

    s_waitcnt lgkmcnt(0)
    ds_read_b128 v[16:19], v12 offset:2048
    s_mov_b64 exec, s[26:27]
    ds_read_b128 v[32:35], v15 offset:1024
    ds_read_b128 v[36:39], v15 offset:1536
    s_mov_b64 exec, -1
    v_mfma_f32_32x32x16_bf16 v[80:95], v[20:23], v[8:11], v[48:63]

    buffer_load_dwordx4 v[144:147], v160, s[8:11], s42 offen
    buffer_load_dwordx4 v[148:151], v7, s[8:11], s43 offen
    s_add_u32 s42, s42, 131072
    s_add_u32 s43, s43, 2048

    v_exp_f32 v64, v64
    v_exp_f32 v65, v65
    v_exp_f32 v66, v66
    v_exp_f32 v67, v67
    v_exp_f32 v68, v68
    v_exp_f32 v69, v69
    v_exp_f32 v70, v70
    v_exp_f32 v71, v71
    v_cvt_pk_bf16_f32 v40, v64, v65
    v_cvt_pk_bf16_f32 v41, v66, v67
    v_cvt_pk_bf16_f32 v42, v68, v69
    v_cvt_pk_bf16_f32 v43, v70, v71
    v_exp_f32 v72, v72
    v_exp_f32 v73, v73
    v_exp_f32 v74, v74
    v_exp_f32 v75, v75
    v_exp_f32 v76, v76
    v_exp_f32 v77, v77
    v_exp_f32 v78, v78
    v_exp_f32 v79, v79
    v_mfma_f32_32x32x16_bf16 v[96:111], v[24:27], v[40:43], v[96:111]
    v_cvt_pk_bf16_f32 v44, v72, v73
    v_cvt_pk_bf16_f32 v45, v74, v75
    v_cvt_pk_bf16_f32 v46, v76, v77
    v_cvt_pk_bf16_f32 v47, v78, v79
    s_waitcnt vmcnt(4)
    v_mfma_f32_32x32x16_bf16 v[112:127], v[132:135], v[128:131], 0
    v_mfma_f32_32x32x16_bf16 v[96:111], v[28:31], v[44:47], v[96:111]
    s_waitcnt lgkmcnt(0)
    ds_read_b128 v[20:23], v12 offset:3072
    s_mov_b64 exec, s[26:27]
    ds_read_b128 v[24:27], v15 offset:2048
    ds_read_b128 v[28:31], v15 offset:2560
    s_mov_b64 exec, -1
    v_mfma_f32_32x32x16_bf16 v[64:79], v[16:19], v[8:11], v[48:63]

    buffer_load_dwordx4 v[152:155], v160, s[8:11], s42 offen
    buffer_load_dwordx4 v[156:159], v7, s[8:11], s43 offen
    s_add_u32 s42, s42, 131072
    s_add_u32 s43, s43, 2048

    v_exp_f32 v80, v80
    v_exp_f32 v81, v81
    v_exp_f32 v82, v82
    v_exp_f32 v83, v83
    v_exp_f32 v84, v84
    v_exp_f32 v85, v85
    v_exp_f32 v86, v86
    v_exp_f32 v87, v87
    v_cvt_pk_bf16_f32 v40, v80, v81
    v_cvt_pk_bf16_f32 v41, v82, v83
    v_cvt_pk_bf16_f32 v42, v84, v85
    v_cvt_pk_bf16_f32 v43, v86, v87
    v_exp_f32 v88, v88
    v_exp_f32 v89, v89
    v_exp_f32 v90, v90
    v_exp_f32 v91, v91
    v_exp_f32 v92, v92
    v_exp_f32 v93, v93
    v_exp_f32 v94, v94
    v_exp_f32 v95, v95
    v_mfma_f32_32x32x16_bf16 v[96:111], v[32:35], v[40:43], v[96:111]
    v_cvt_pk_bf16_f32 v44, v88, v89
    v_cvt_pk_bf16_f32 v45, v90, v91
    v_cvt_pk_bf16_f32 v46, v92, v93
    v_cvt_pk_bf16_f32 v47, v94, v95
    s_waitcnt vmcnt(4)
    v_mfma_f32_32x32x16_bf16 v[112:127], v[140:143], v[136:139], v[112:127]
    v_mfma_f32_32x32x16_bf16 v[96:111], v[36:39], v[44:47], v[96:111]
    s_waitcnt lgkmcnt(0)
    ds_read_b128 v[16:19], v12 offset:4096
    s_mov_b64 exec, s[26:27]
    ds_read_b128 v[32:35], v15 offset:3072
    ds_read_b128 v[36:39], v15 offset:3584
    s_mov_b64 exec, -1
    v_mfma_f32_32x32x16_bf16 v[80:95], v[20:23], v[8:11], v[48:63]

    buffer_load_dwordx4 v[128:131], v160, s[8:11], s42 offen
    buffer_load_dwordx4 v[132:135], v7, s[8:11], s43 offen
    s_add_u32 s42, s42, 131072
    s_add_u32 s43, s43, 2048

    v_exp_f32 v64, v64
    v_exp_f32 v65, v65
    v_exp_f32 v66, v66
    v_exp_f32 v67, v67
    v_exp_f32 v68, v68
    v_exp_f32 v69, v69
    v_exp_f32 v70, v70
    v_exp_f32 v71, v71
    v_cvt_pk_bf16_f32 v40, v64, v65
    v_cvt_pk_bf16_f32 v41, v66, v67
    v_cvt_pk_bf16_f32 v42, v68, v69
    v_cvt_pk_bf16_f32 v43, v70, v71
    v_exp_f32 v72, v72
    v_exp_f32 v73, v73
    v_exp_f32 v74, v74
    v_exp_f32 v75, v75
    v_exp_f32 v76, v76
    v_exp_f32 v77, v77
    v_exp_f32 v78, v78
    v_exp_f32 v79, v79
    v_mfma_f32_32x32x16_bf16 v[96:111], v[24:27], v[40:43], v[96:111]
    v_cvt_pk_bf16_f32 v44, v72, v73
    v_cvt_pk_bf16_f32 v45, v74, v75
    v_cvt_pk_bf16_f32 v46, v76, v77
    v_cvt_pk_bf16_f32 v47, v78, v79
    s_waitcnt vmcnt(4)
    v_mfma_f32_32x32x16_bf16 v[112:127], v[148:151], v[144:147], v[112:127]
    v_mfma_f32_32x32x16_bf16 v[96:111], v[28:31], v[44:47], v[96:111]
    s_waitcnt lgkmcnt(0)
    ds_read_b128 v[20:23], v12 offset:5120
    s_mov_b64 exec, s[26:27]
    ds_read_b128 v[24:27], v15 offset:4096
    ds_read_b128 v[28:31], v15 offset:4608
    s_mov_b64 exec, -1
    v_mfma_f32_32x32x16_bf16 v[64:79], v[16:19], v[8:11], v[48:63]

    buffer_load_dwordx4 v[136:139], v160, s[8:11], s42 offen
    buffer_load_dwordx4 v[140:143], v7, s[8:11], s43 offen
    s_add_u32 s42, s42, 131072
    s_add_u32 s43, s43, 2048

    v_exp_f32 v80, v80
    v_exp_f32 v81, v81
    v_exp_f32 v82, v82
    v_exp_f32 v83, v83
    v_exp_f32 v84, v84
    v_exp_f32 v85, v85
    v_exp_f32 v86, v86
    v_exp_f32 v87, v87
    v_cvt_pk_bf16_f32 v40, v80, v81
    v_cvt_pk_bf16_f32 v41, v82, v83
    v_cvt_pk_bf16_f32 v42, v84, v85
    v_cvt_pk_bf16_f32 v43, v86, v87
    v_exp_f32 v88, v88
    v_exp_f32 v89, v89
    v_exp_f32 v90, v90
    v_exp_f32 v91, v91
    v_exp_f32 v92, v92
    v_exp_f32 v93, v93
    v_exp_f32 v94, v94
    v_exp_f32 v95, v95
    v_mfma_f32_32x32x16_bf16 v[96:111], v[32:35], v[40:43], v[96:111]
    v_cvt_pk_bf16_f32 v44, v88, v89
    v_cvt_pk_bf16_f32 v45, v90, v91
    v_cvt_pk_bf16_f32 v46, v92, v93
    v_cvt_pk_bf16_f32 v47, v94, v95
    s_waitcnt vmcnt(4)
    v_mfma_f32_32x32x16_bf16 v[112:127], v[156:159], v[152:155], v[112:127]
    v_mfma_f32_32x32x16_bf16 v[96:111], v[36:39], v[44:47], v[96:111]
    v_add_u32 v12, 4096, v12
    v_add_u32 v15, 4096, v15

K2_p2a:
    s_waitcnt lgkmcnt(0)
    ds_read_b128 v[16:19], v12 offset:2048
    s_mov_b64 exec, s[26:27]
    ds_read_b128 v[32:35], v15 offset:1024
    ds_read_b128 v[36:39], v15 offset:1536
    s_mov_b64 exec, -1
    v_mfma_f32_32x32x16_bf16 v[80:95], v[20:23], v[8:11], v[48:63]

    buffer_load_dwordx4 v[144:147], v160, s[8:11], s42 offen
    buffer_load_dwordx4 v[148:151], v7, s[8:11], s43 offen
    s_add_u32 s42, s42, 131072
    s_add_u32 s43, s43, 2048

    v_exp_f32 v64, v64
    v_exp_f32 v65, v65
    v_exp_f32 v66, v66
    v_exp_f32 v67, v67
    v_exp_f32 v68, v68
    v_exp_f32 v69, v69
    v_exp_f32 v70, v70
    v_exp_f32 v71, v71
    v_cvt_pk_bf16_f32 v40, v64, v65
    v_cvt_pk_bf16_f32 v41, v66, v67
    v_cvt_pk_bf16_f32 v42, v68, v69
    v_cvt_pk_bf16_f32 v43, v70, v71
    v_exp_f32 v72, v72
    v_exp_f32 v73, v73
    v_exp_f32 v74, v74
    v_exp_f32 v75, v75
    v_exp_f32 v76, v76
    v_exp_f32 v77, v77
    v_exp_f32 v78, v78
    v_exp_f32 v79, v79
    v_mfma_f32_32x32x16_bf16 v[96:111], v[24:27], v[40:43], v[96:111]
    v_cvt_pk_bf16_f32 v44, v72, v73
    v_cvt_pk_bf16_f32 v45, v74, v75
    v_cvt_pk_bf16_f32 v46, v76, v77
    v_cvt_pk_bf16_f32 v47, v78, v79
    s_waitcnt vmcnt(4)
    v_mfma_f32_32x32x16_bf16 v[112:127], v[132:135], v[128:131], v[112:127]
    v_mfma_f32_32x32x16_bf16 v[96:111], v[28:31], v[44:47], v[96:111]
    s_waitcnt lgkmcnt(0)
    ds_read_b128 v[20:23], v12 offset:3072
    s_mov_b64 exec, s[26:27]
    ds_read_b128 v[24:27], v15 offset:2048
    ds_read_b128 v[28:31], v15 offset:2560
    s_mov_b64 exec, -1
    v_mfma_f32_32x32x16_bf16 v[64:79], v[16:19], v[8:11], v[48:63]

    buffer_load_dwordx4 v[152:155], v160, s[8:11], s42 offen
    buffer_load_dwordx4 v[156:159], v7, s[8:11], s43 offen
    s_add_u32 s42, s42, 131072
    s_add_u32 s43, s43, 2048

    v_exp_f32 v80, v80
    v_exp_f32 v81, v81
    v_exp_f32 v82, v82
    v_exp_f32 v83, v83
    v_exp_f32 v84, v84
    v_exp_f32 v85, v85
    v_exp_f32 v86, v86
    v_exp_f32 v87, v87
    v_cvt_pk_bf16_f32 v40, v80, v81
    v_cvt_pk_bf16_f32 v41, v82, v83
    v_cvt_pk_bf16_f32 v42, v84, v85
    v_cvt_pk_bf16_f32 v43, v86, v87
    v_exp_f32 v88, v88
    v_exp_f32 v89, v89
    v_exp_f32 v90, v90
    v_exp_f32 v91, v91
    v_exp_f32 v92, v92
    v_exp_f32 v93, v93
    v_exp_f32 v94, v94
    v_exp_f32 v95, v95
    v_mfma_f32_32x32x16_bf16 v[96:111], v[32:35], v[40:43], v[96:111]
    v_cvt_pk_bf16_f32 v44, v88, v89
    v_cvt_pk_bf16_f32 v45, v90, v91
    v_cvt_pk_bf16_f32 v46, v92, v93
    v_cvt_pk_bf16_f32 v47, v94, v95
    s_waitcnt vmcnt(4)
    v_mfma_f32_32x32x16_bf16 v[112:127], v[140:143], v[136:139], v[112:127]
    v_mfma_f32_32x32x16_bf16 v[96:111], v[36:39], v[44:47], v[96:111]
    s_waitcnt lgkmcnt(0)
    ds_read_b128 v[16:19], v12 offset:4096
    s_mov_b64 exec, s[26:27]
    ds_read_b128 v[32:35], v15 offset:3072
    ds_read_b128 v[36:39], v15 offset:3584
    s_mov_b64 exec, -1
    v_mfma_f32_32x32x16_bf16 v[80:95], v[20:23], v[8:11], v[48:63]

    buffer_load_dwordx4 v[128:131], v160, s[8:11], s42 offen
    buffer_load_dwordx4 v[132:135], v7, s[8:11], s43 offen
    s_add_u32 s42, s42, 131072
    s_add_u32 s43, s43, 2048

    v_exp_f32 v64, v64
    v_exp_f32 v65, v65
    v_exp_f32 v66, v66
    v_exp_f32 v67, v67
    v_exp_f32 v68, v68
    v_exp_f32 v69, v69
    v_exp_f32 v70, v70
    v_exp_f32 v71, v71
    v_cvt_pk_bf16_f32 v40, v64, v65
    v_cvt_pk_bf16_f32 v41, v66, v67
    v_cvt_pk_bf16_f32 v42, v68, v69
    v_cvt_pk_bf16_f32 v43, v70, v71
    v_exp_f32 v72, v72
    v_exp_f32 v73, v73
    v_exp_f32 v74, v74
    v_exp_f32 v75, v75
    v_exp_f32 v76, v76
    v_exp_f32 v77, v77
    v_exp_f32 v78, v78
    v_exp_f32 v79, v79
    v_mfma_f32_32x32x16_bf16 v[96:111], v[24:27], v[40:43], v[96:111]
    v_cvt_pk_bf16_f32 v44, v72, v73
    v_cvt_pk_bf16_f32 v45, v74, v75
    v_cvt_pk_bf16_f32 v46, v76, v77
    v_cvt_pk_bf16_f32 v47, v78, v79
    s_waitcnt vmcnt(4)
    v_mfma_f32_32x32x16_bf16 v[112:127], v[148:151], v[144:147], v[112:127]
    v_mfma_f32_32x32x16_bf16 v[96:111], v[28:31], v[44:47], v[96:111]
    s_waitcnt lgkmcnt(0)
    ds_read_b128 v[20:23], v12 offset:5120
    s_mov_b64 exec, s[26:27]
    ds_read_b128 v[24:27], v15 offset:4096
    ds_read_b128 v[28:31], v15 offset:4608
    s_mov_b64 exec, -1
    v_mfma_f32_32x32x16_bf16 v[64:79], v[16:19], v[8:11], v[48:63]

    buffer_load_dwordx4 v[136:139], v160, s[8:11], s42 offen
    buffer_load_dwordx4 v[140:143], v7, s[8:11], s43 offen
    s_add_u32 s42, s42, 131072
    s_add_u32 s43, s43, 2048

    v_exp_f32 v80, v80
    v_exp_f32 v81, v81
    v_exp_f32 v82, v82
    v_exp_f32 v83, v83
    v_exp_f32 v84, v84
    v_exp_f32 v85, v85
    v_exp_f32 v86, v86
    v_exp_f32 v87, v87
    v_cvt_pk_bf16_f32 v40, v80, v81
    v_cvt_pk_bf16_f32 v41, v82, v83
    v_cvt_pk_bf16_f32 v42, v84, v85
    v_cvt_pk_bf16_f32 v43, v86, v87
    v_exp_f32 v88, v88
    v_exp_f32 v89, v89
    v_exp_f32 v90, v90
    v_exp_f32 v91, v91
    v_exp_f32 v92, v92
    v_exp_f32 v93, v93
    v_exp_f32 v94, v94
    v_exp_f32 v95, v95
    v_mfma_f32_32x32x16_bf16 v[96:111], v[32:35], v[40:43], v[96:111]
    v_cvt_pk_bf16_f32 v44, v88, v89
    v_cvt_pk_bf16_f32 v45, v90, v91
    v_cvt_pk_bf16_f32 v46, v92, v93
    v_cvt_pk_bf16_f32 v47, v94, v95
    s_waitcnt vmcnt(4)
    v_mfma_f32_32x32x16_bf16 v[112:127], v[156:159], v[152:155], v[112:127]
    v_mfma_f32_32x32x16_bf16 v[96:111], v[36:39], v[44:47], v[96:111]
    v_add_u32 v12, 4096, v12
    v_add_u32 v15, 4096, v15

    s_add_u32 s23, s23, 1
    s_cmp_lt_u32 s23, 9
    s_cbranch_scc1 K2_p2a

    s_waitcnt lgkmcnt(0)
    ds_read_b128 v[16:19], v12 offset:2048
    s_mov_b64 exec, s[26:27]
    ds_read_b128 v[32:35], v15 offset:1024
    ds_read_b128 v[36:39], v15 offset:1536
    s_mov_b64 exec, -1
    v_mfma_f32_32x32x16_bf16 v[80:95], v[20:23], v[8:11], v[48:63]

    buffer_load_dwordx4 v[144:147], v160, s[8:11], s42 offen
    buffer_load_dwordx4 v[148:151], v7, s[8:11], s43 offen
    s_add_u32 s42, s42, 131072
    s_add_u32 s43, s43, 2048

    v_exp_f32 v64, v64
    v_exp_f32 v65, v65
    v_exp_f32 v66, v66
    v_exp_f32 v67, v67
    v_exp_f32 v68, v68
    v_exp_f32 v69, v69
    v_exp_f32 v70, v70
    v_exp_f32 v71, v71
    v_cvt_pk_bf16_f32 v40, v64, v65
    v_cvt_pk_bf16_f32 v41, v66, v67
    v_cvt_pk_bf16_f32 v42, v68, v69
    v_cvt_pk_bf16_f32 v43, v70, v71
    v_exp_f32 v72, v72
    v_exp_f32 v73, v73
    v_exp_f32 v74, v74
    v_exp_f32 v75, v75
    v_exp_f32 v76, v76
    v_exp_f32 v77, v77
    v_exp_f32 v78, v78
    v_exp_f32 v79, v79
    v_mfma_f32_32x32x16_bf16 v[96:111], v[24:27], v[40:43], v[96:111]
    v_cvt_pk_bf16_f32 v44, v72, v73
    v_cvt_pk_bf16_f32 v45, v74, v75
    v_cvt_pk_bf16_f32 v46, v76, v77
    v_cvt_pk_bf16_f32 v47, v78, v79
    s_waitcnt vmcnt(4)
    v_mfma_f32_32x32x16_bf16 v[112:127], v[132:135], v[128:131], v[112:127]
    v_mfma_f32_32x32x16_bf16 v[96:111], v[28:31], v[44:47], v[96:111]
    s_waitcnt lgkmcnt(0)
    ds_read_b128 v[20:23], v12 offset:3072
    s_mov_b64 exec, s[26:27]
    ds_read_b128 v[24:27], v15 offset:2048
    ds_read_b128 v[28:31], v15 offset:2560
    s_mov_b64 exec, -1
    v_mfma_f32_32x32x16_bf16 v[64:79], v[16:19], v[8:11], v[48:63]

    v_exp_f32 v80, v80
    v_exp_f32 v81, v81
    v_exp_f32 v82, v82
    v_exp_f32 v83, v83
    v_exp_f32 v84, v84
    v_exp_f32 v85, v85
    v_exp_f32 v86, v86
    v_exp_f32 v87, v87
    v_cvt_pk_bf16_f32 v40, v80, v81
    v_cvt_pk_bf16_f32 v41, v82, v83
    v_cvt_pk_bf16_f32 v42, v84, v85
    v_cvt_pk_bf16_f32 v43, v86, v87
    v_exp_f32 v88, v88
    v_exp_f32 v89, v89
    v_exp_f32 v90, v90
    v_exp_f32 v91, v91
    v_exp_f32 v92, v92
    v_exp_f32 v93, v93
    v_exp_f32 v94, v94
    v_exp_f32 v95, v95
    v_mfma_f32_32x32x16_bf16 v[96:111], v[32:35], v[40:43], v[96:111]
    v_cvt_pk_bf16_f32 v44, v88, v89
    v_cvt_pk_bf16_f32 v45, v90, v91
    v_cvt_pk_bf16_f32 v46, v92, v93
    v_cvt_pk_bf16_f32 v47, v94, v95
    s_waitcnt vmcnt(2)
    v_mfma_f32_32x32x16_bf16 v[112:127], v[140:143], v[136:139], v[112:127]
    v_mfma_f32_32x32x16_bf16 v[96:111], v[36:39], v[44:47], v[96:111]
    s_waitcnt lgkmcnt(0)
    ds_read_b128 v[16:19], v12 offset:4096
    s_mov_b64 exec, s[26:27]
    ds_read_b128 v[32:35], v15 offset:3072
    ds_read_b128 v[36:39], v15 offset:3584
    s_mov_b64 exec, -1
    v_mfma_f32_32x32x16_bf16 v[80:95], v[20:23], v[8:11], v[48:63]

    v_exp_f32 v64, v64
    v_exp_f32 v65, v65
    v_exp_f32 v66, v66
    v_exp_f32 v67, v67
    v_exp_f32 v68, v68
    v_exp_f32 v69, v69
    v_exp_f32 v70, v70
    v_exp_f32 v71, v71
    v_cvt_pk_bf16_f32 v40, v64, v65
    v_cvt_pk_bf16_f32 v41, v66, v67
    v_cvt_pk_bf16_f32 v42, v68, v69
    v_cvt_pk_bf16_f32 v43, v70, v71
    v_exp_f32 v72, v72
    v_exp_f32 v73, v73
    v_exp_f32 v74, v74
    v_exp_f32 v75, v75
    v_exp_f32 v76, v76
    v_exp_f32 v77, v77
    v_exp_f32 v78, v78
    v_exp_f32 v79, v79
    v_mfma_f32_32x32x16_bf16 v[96:111], v[24:27], v[40:43], v[96:111]
    v_cvt_pk_bf16_f32 v44, v72, v73
    v_cvt_pk_bf16_f32 v45, v74, v75
    v_cvt_pk_bf16_f32 v46, v76, v77
    v_cvt_pk_bf16_f32 v47, v78, v79
    s_waitcnt vmcnt(0)
    v_mfma_f32_32x32x16_bf16 v[112:127], v[148:151], v[144:147], v[112:127]
    v_mfma_f32_32x32x16_bf16 v[96:111], v[28:31], v[44:47], v[96:111]
    s_waitcnt lgkmcnt(0)
    ds_read_b128 v[20:23], v12 offset:5120
    s_mov_b64 exec, s[26:27]
    ds_read_b128 v[24:27], v15 offset:4096
    ds_read_b128 v[28:31], v15 offset:4608
    s_mov_b64 exec, -1
    v_mfma_f32_32x32x16_bf16 v[64:79], v[16:19], v[8:11], v[48:63]

    v_exp_f32 v80, v80
    v_exp_f32 v81, v81
    v_exp_f32 v82, v82
    v_exp_f32 v83, v83
    v_exp_f32 v84, v84
    v_exp_f32 v85, v85
    v_exp_f32 v86, v86
    v_exp_f32 v87, v87
    v_cvt_pk_bf16_f32 v40, v80, v81
    v_cvt_pk_bf16_f32 v41, v82, v83
    v_cvt_pk_bf16_f32 v42, v84, v85
    v_cvt_pk_bf16_f32 v43, v86, v87
    v_exp_f32 v88, v88
    v_exp_f32 v89, v89
    v_exp_f32 v90, v90
    v_exp_f32 v91, v91
    v_exp_f32 v92, v92
    v_exp_f32 v93, v93
    v_exp_f32 v94, v94
    v_exp_f32 v95, v95
    v_mfma_f32_32x32x16_bf16 v[96:111], v[32:35], v[40:43], v[96:111]
    v_cvt_pk_bf16_f32 v44, v88, v89
    v_cvt_pk_bf16_f32 v45, v90, v91
    v_cvt_pk_bf16_f32 v46, v92, v93
    v_cvt_pk_bf16_f32 v47, v94, v95
    s_nop 1
    v_mfma_f32_32x32x16_bf16 v[96:111], v[36:39], v[44:47], v[96:111]
    v_add_u32 v12, 4096, v12
    v_add_u32 v15, 4096, v15

    s_mov_b32 s23, 0
K2_p2b:
    s_waitcnt lgkmcnt(0)
    ds_read_b128 v[16:19], v12 offset:2048
    s_mov_b64 exec, s[26:27]
    ds_read_b128 v[32:35], v15 offset:1024
    ds_read_b128 v[36:39], v15 offset:1536
    s_mov_b64 exec, -1
    v_mfma_f32_32x32x16_bf16 v[80:95], v[20:23], v[8:11], v[48:63]

    v_exp_f32 v64, v64
    v_exp_f32 v65, v65
    v_exp_f32 v66, v66
    v_exp_f32 v67, v67
    v_exp_f32 v68, v68
    v_exp_f32 v69, v69
    v_exp_f32 v70, v70
    v_exp_f32 v71, v71
    v_cvt_pk_bf16_f32 v40, v64, v65
    v_cvt_pk_bf16_f32 v41, v66, v67
    v_cvt_pk_bf16_f32 v42, v68, v69
    v_cvt_pk_bf16_f32 v43, v70, v71
    v_exp_f32 v72, v72
    v_exp_f32 v73, v73
    v_exp_f32 v74, v74
    v_exp_f32 v75, v75
    v_exp_f32 v76, v76
    v_exp_f32 v77, v77
    v_exp_f32 v78, v78
    v_exp_f32 v79, v79
    v_mfma_f32_32x32x16_bf16 v[96:111], v[24:27], v[40:43], v[96:111]
    v_cvt_pk_bf16_f32 v44, v72, v73
    v_cvt_pk_bf16_f32 v45, v74, v75
    v_cvt_pk_bf16_f32 v46, v76, v77
    v_cvt_pk_bf16_f32 v47, v78, v79
    s_nop 1
    v_mfma_f32_32x32x16_bf16 v[96:111], v[28:31], v[44:47], v[96:111]
    s_waitcnt lgkmcnt(0)
    ds_read_b128 v[20:23], v12 offset:3072
    s_mov_b64 exec, s[26:27]
    ds_read_b128 v[24:27], v15 offset:2048
    ds_read_b128 v[28:31], v15 offset:2560
    s_mov_b64 exec, -1
    v_mfma_f32_32x32x16_bf16 v[64:79], v[16:19], v[8:11], v[48:63]

    v_exp_f32 v80, v80
    v_exp_f32 v81, v81
    v_exp_f32 v82, v82
    v_exp_f32 v83, v83
    v_exp_f32 v84, v84
    v_exp_f32 v85, v85
    v_exp_f32 v86, v86
    v_exp_f32 v87, v87
    v_cvt_pk_bf16_f32 v40, v80, v81
    v_cvt_pk_bf16_f32 v41, v82, v83
    v_cvt_pk_bf16_f32 v42, v84, v85
    v_cvt_pk_bf16_f32 v43, v86, v87
    v_exp_f32 v88, v88
    v_exp_f32 v89, v89
    v_exp_f32 v90, v90
    v_exp_f32 v91, v91
    v_exp_f32 v92, v92
    v_exp_f32 v93, v93
    v_exp_f32 v94, v94
    v_exp_f32 v95, v95
    v_mfma_f32_32x32x16_bf16 v[96:111], v[32:35], v[40:43], v[96:111]
    v_cvt_pk_bf16_f32 v44, v88, v89
    v_cvt_pk_bf16_f32 v45, v90, v91
    v_cvt_pk_bf16_f32 v46, v92, v93
    v_cvt_pk_bf16_f32 v47, v94, v95
    s_nop 1
    v_mfma_f32_32x32x16_bf16 v[96:111], v[36:39], v[44:47], v[96:111]
    s_waitcnt lgkmcnt(0)
    ds_read_b128 v[16:19], v12 offset:4096
    s_mov_b64 exec, s[26:27]
    ds_read_b128 v[32:35], v15 offset:3072
    ds_read_b128 v[36:39], v15 offset:3584
    s_mov_b64 exec, -1
    v_mfma_f32_32x32x16_bf16 v[80:95], v[20:23], v[8:11], v[48:63]

    v_exp_f32 v64, v64
    v_exp_f32 v65, v65
    v_exp_f32 v66, v66
    v_exp_f32 v67, v67
    v_exp_f32 v68, v68
    v_exp_f32 v69, v69
    v_exp_f32 v70, v70
    v_exp_f32 v71, v71
    v_cvt_pk_bf16_f32 v40, v64, v65
    v_cvt_pk_bf16_f32 v41, v66, v67
    v_cvt_pk_bf16_f32 v42, v68, v69
    v_cvt_pk_bf16_f32 v43, v70, v71
    v_exp_f32 v72, v72
    v_exp_f32 v73, v73
    v_exp_f32 v74, v74
    v_exp_f32 v75, v75
    v_exp_f32 v76, v76
    v_exp_f32 v77, v77
    v_exp_f32 v78, v78
    v_exp_f32 v79, v79
    v_mfma_f32_32x32x16_bf16 v[96:111], v[24:27], v[40:43], v[96:111]
    v_cvt_pk_bf16_f32 v44, v72, v73
    v_cvt_pk_bf16_f32 v45, v74, v75
    v_cvt_pk_bf16_f32 v46, v76, v77
    v_cvt_pk_bf16_f32 v47, v78, v79
    s_nop 1
    v_mfma_f32_32x32x16_bf16 v[96:111], v[28:31], v[44:47], v[96:111]
    s_waitcnt lgkmcnt(0)
    ds_read_b128 v[20:23], v12 offset:5120
    s_mov_b64 exec, s[26:27]
    ds_read_b128 v[24:27], v15 offset:4096
    ds_read_b128 v[28:31], v15 offset:4608
    s_mov_b64 exec, -1
    v_mfma_f32_32x32x16_bf16 v[64:79], v[16:19], v[8:11], v[48:63]

    v_exp_f32 v80, v80
    v_exp_f32 v81, v81
    v_exp_f32 v82, v82
    v_exp_f32 v83, v83
    v_exp_f32 v84, v84
    v_exp_f32 v85, v85
    v_exp_f32 v86, v86
    v_exp_f32 v87, v87
    v_cvt_pk_bf16_f32 v40, v80, v81
    v_cvt_pk_bf16_f32 v41, v82, v83
    v_cvt_pk_bf16_f32 v42, v84, v85
    v_cvt_pk_bf16_f32 v43, v86, v87
    v_exp_f32 v88, v88
    v_exp_f32 v89, v89
    v_exp_f32 v90, v90
    v_exp_f32 v91, v91
    v_exp_f32 v92, v92
    v_exp_f32 v93, v93
    v_exp_f32 v94, v94
    v_exp_f32 v95, v95
    v_mfma_f32_32x32x16_bf16 v[96:111], v[32:35], v[40:43], v[96:111]
    v_cvt_pk_bf16_f32 v44, v88, v89
    v_cvt_pk_bf16_f32 v45, v90, v91
    v_cvt_pk_bf16_f32 v46, v92, v93
    v_cvt_pk_bf16_f32 v47, v94, v95
    s_nop 1
    v_mfma_f32_32x32x16_bf16 v[96:111], v[36:39], v[44:47], v[96:111]
    v_add_u32 v12, 4096, v12
    v_add_u32 v15, 4096, v15

    s_add_u32 s23, s23, 1
    s_cmp_lt_u32 s23, 5
    s_cbranch_scc1 K2_p2b
    s_nop 15
    s_waitcnt lgkmcnt(0)
    s_barrier
    s_and_b32 s44, s3, 3
    s_lshl_b32 s44, s44, 12
    v_add_u32 v16, s44, v7
    s_cmp_eq_u32 s38, 0
    s_cbranch_scc1 K2_red
    ds_write_b128 v16, v[112:115]
    ds_write_b128 v16, v[116:119] offset:1024
    ds_write_b128 v16, v[120:123] offset:2048
    ds_write_b128 v16, v[124:127] offset:3072
    s_waitcnt lgkmcnt(0)
    s_barrier
    s_branch K2_fin

K2_red:
    s_barrier
    ds_read_b128 v[20:23], v16
    ds_read_b128 v[24:27], v16 offset:1024
    ds_read_b128 v[28:31], v16 offset:2048
    ds_read_b128 v[32:35], v16 offset:3072
    s_lshl_b32 s44, s39, 4
    s_add_u32 s44, s44, s40
    s_lshl_b32 s44, s44, 12
    s_add_u32 s44, s44, 16777216
    s_waitcnt lgkmcnt(0)

    v_add_f32 v112, v20, v112
    v_add_f32 v113, v21, v113
    v_add_f32 v114, v22, v114
    v_add_f32 v115, v23, v115
    v_add_f32 v116, v24, v116
    v_add_f32 v117, v25, v117
    v_add_f32 v118, v26, v118
    v_add_f32 v119, v27, v119
    v_add_f32 v120, v28, v120
    v_add_f32 v121, v29, v121
    v_add_f32 v122, v30, v122
    v_add_f32 v123, v31, v123
    v_add_f32 v124, v32, v124
    v_add_f32 v125, v33, v125
    v_add_f32 v126, v34, v126
    v_add_f32 v127, v35, v127
    buffer_store_dwordx4 v[112:115], v7, s[8:11], s44 offen offset:0
    buffer_store_dwordx4 v[116:119], v7, s[8:11], s44 offen offset:1024
    buffer_store_dwordx4 v[120:123], v7, s[8:11], s44 offen offset:2048
    buffer_store_dwordx4 v[124:127], v7, s[8:11], s44 offen offset:3072
K2_fin:
    v_mov_b32 v13, v104
    v_mov_b32 v14, v104
    s_nop 1
    v_permlane32_swap_b32 v13, v14
    s_nop 1
    v_rcp_f32 v13, v13
    s_nop 0

    v_mul_f32 v96, v13, v96
    v_mul_f32 v97, v13, v97
    v_mul_f32 v98, v13, v98
    v_mul_f32 v99, v13, v99
    v_mul_f32 v100, v13, v100
    v_mul_f32 v101, v13, v101
    v_mul_f32 v102, v13, v102
    v_mul_f32 v103, v13, v103
    v_cvt_pk_bf16_f32 v40, v96, v97
    v_cvt_pk_bf16_f32 v41, v98, v99
    v_cvt_pk_bf16_f32 v42, v100, v101
    v_cvt_pk_bf16_f32 v43, v102, v103
    v_lshlrev_b32 v6, 5, v5
    v_lshl_add_u32 v6, v4, 3, v6
    s_add_u32 s20, s17, 6291456
    buffer_store_dwordx2 v[40:41], v6, s[8:11], s20 offen
    buffer_store_dwordx2 v[42:43], v6, s[8:11], s20 offen offset:16

K2_end:
    s_endpgm
.globl k3_kernel
.p2align 8
.type k3_kernel,@function
k3_kernel:
    s_cmp_ge_u32 s2, 256
    s_cbranch_scc1 K3_end
    s_load_dwordx2 s[4:5], s[0:1], 0
    s_load_dwordx2 s[10:11], s[0:1], 56
    s_load_dwordx2 s[12:13], s[0:1], 72
    v_lshrrev_b32 v1, 6, v0
    v_and_b32 v2, 63, v0
    s_nop 0
    v_readfirstlane_b32 s3, v1
    s_and_b32 s14, s2, 7
    s_lshl_b32 s14, s14, 2
    s_lshr_b32 s15, s2, 3
    s_and_b32 s15, s15, 3
    s_add_u32 s14, s14, s15
    s_lshr_b32 s15, s2, 5
    s_and_b32 s36, s3, 1
    s_lshr_b32 s37, s3, 1
    s_lshl_b32 s39, s14, 1
    s_add_u32 s39, s39, s36
    s_lshl_b32 s40, s15, 1
    s_add_u32 s40, s40, s37
    v_and_b32 v3, 31, v2
    v_lshrrev_b32 v4, 5, v2
    s_lshl_b32 s38, s39, 5
    v_add_u32 v5, s38, v3
    v_lshlrev_b32 v7, 4, v2
    v_lshlrev_b32 v8, 5, v3
    v_lshl_add_u32 v8, v4, 4, v8
    s_waitcnt lgkmcnt(0)
    s_mov_b32 s16, s4
    s_mov_b32 s17, s5
    s_mov_b32 s18, 0x200000
    s_mov_b32 s19, 0x00020000
    s_mov_b32 s28, s10
    s_mov_b32 s29, s11
    s_mov_b32 s30, 0x200000
    s_mov_b32 s31, 0x00020000
    s_mov_b32 s32, s12
    s_mov_b32 s33, s13
    s_mov_b32 s34, 25165824
    s_mov_b32 s35, 0x00020000
    s_lshl_b32 s42, s39, 10
    s_add_u32 s42, s42, 6291456
    s_mul_i32 s43, s40, 120832
    s_add_u32 s43, s43, 14680064
    s_lshl_b32 s44, s39, 4
    s_add_u32 s44, s44, s40
    s_lshl_b32 s44, s44, 12
    s_add_u32 s44, s44, 16777216
    v_lshlrev_b32 v6, 10, v5
    v_lshl_add_u32 v6, v4, 4, v6
    s_lshl_b32 s45, s40, 6

    buffer_load_dwordx4 v[64:67], v8, s[32:35], s42 offen
    buffer_load_dwordx4 v[68:71], v7, s[32:35], s43 offen
    s_add_u32 s42, s42, 65536
    s_add_u32 s43, s43, 1024

    buffer_load_dwordx4 v[72:75], v8, s[32:35], s42 offen
    buffer_load_dwordx4 v[76:79], v7, s[32:35], s43 offen
    s_add_u32 s42, s42, 65536
    s_add_u32 s43, s43, 1024

    buffer_load_dwordx4 v[80:83], v8, s[32:35], s42 offen
    buffer_load_dwordx4 v[84:87], v7, s[32:35], s43 offen
    s_add_u32 s42, s42, 65536
    s_add_u32 s43, s43, 1024

    buffer_load_dwordx4 v[88:91], v8, s[32:35], s42 offen
    buffer_load_dwordx4 v[92:95], v7, s[32:35], s43 offen
    s_add_u32 s42, s42, 65536
    s_add_u32 s43, s43, 1024

    buffer_load_dwordx4 v[96:99], v8, s[32:35], s42 offen
    buffer_load_dwordx4 v[100:103], v7, s[32:35], s43 offen
    s_add_u32 s42, s42, 65536
    s_add_u32 s43, s43, 1024

    buffer_load_dwordx4 v[104:107], v8, s[32:35], s42 offen
    buffer_load_dwordx4 v[108:111], v7, s[32:35], s43 offen
    s_add_u32 s42, s42, 65536
    s_add_u32 s43, s43, 1024

    buffer_load_dwordx4 v[112:115], v8, s[32:35], s42 offen
    buffer_load_dwordx4 v[116:119], v7, s[32:35], s43 offen
    s_add_u32 s42, s42, 65536
    s_add_u32 s43, s43, 1024

    buffer_load_dwordx4 v[120:123], v8, s[32:35], s42 offen
    buffer_load_dwordx4 v[124:127], v7, s[32:35], s43 offen
    s_add_u32 s42, s42, 65536
    s_add_u32 s43, s43, 1024

    buffer_load_dwordx4 v[128:131], v8, s[32:35], s42 offen
    buffer_load_dwordx4 v[132:135], v7, s[32:35], s43 offen
    s_add_u32 s42, s42, 65536
    s_add_u32 s43, s43, 1024

    buffer_load_dwordx4 v[136:139], v8, s[32:35], s42 offen
    buffer_load_dwordx4 v[140:143], v7, s[32:35], s43 offen
    s_add_u32 s42, s42, 65536
    s_add_u32 s43, s43, 1024

    buffer_load_dwordx4 v[144:147], v8, s[32:35], s42 offen
    buffer_load_dwordx4 v[148:151], v7, s[32:35], s43 offen
    s_add_u32 s42, s42, 65536
    s_add_u32 s43, s43, 1024

    buffer_load_dwordx4 v[152:155], v8, s[32:35], s42 offen
    buffer_load_dwordx4 v[156:159], v7, s[32:35], s43 offen
    s_add_u32 s42, s42, 65536
    s_add_u32 s43, s43, 1024

    buffer_load_dwordx4 v[160:163], v8, s[32:35], s42 offen
    buffer_load_dwordx4 v[164:167], v7, s[32:35], s43 offen
    s_add_u32 s42, s42, 65536
    s_add_u32 s43, s43, 1024

    buffer_load_dwordx4 v[168:171], v8, s[32:35], s42 offen
    buffer_load_dwordx4 v[172:175], v7, s[32:35], s43 offen
    s_add_u32 s42, s42, 65536
    s_add_u32 s43, s43, 1024

    buffer_load_dwordx4 v[176:179], v8, s[32:35], s42 offen
    buffer_load_dwordx4 v[180:183], v7, s[32:35], s43 offen
    s_add_u32 s42, s42, 65536
    s_add_u32 s43, s43, 1024

    buffer_load_dwordx4 v[184:187], v8, s[32:35], s42 offen
    buffer_load_dwordx4 v[188:191], v7, s[32:35], s43 offen
    s_add_u32 s42, s42, 65536
    s_add_u32 s43, s43, 1024

    buffer_load_dwordx4 v[32:35], v7, s[32:35], s44 offen offset:0
    buffer_load_dwordx4 v[36:39], v7, s[32:35], s44 offen offset:1024
    buffer_load_dwordx4 v[40:43], v7, s[32:35], s44 offen offset:2048
    buffer_load_dwordx4 v[44:47], v7, s[32:35], s44 offen offset:3072
    buffer_load_dwordx4 v[48:51], v6, s[16:19], s45 offen
    buffer_load_dwordx4 v[52:55], v6, s[16:19], s45 offen offset:32
    s_waitcnt vmcnt(36)
    v_mfma_f32_32x32x16_bf16 v[16:31], v[68:71], v[64:67], 0
    buffer_load_dwordx4 v[64:67], v8, s[32:35], s42 offen
    buffer_load_dwordx4 v[68:71], v7, s[32:35], s43 offen
    s_add_u32 s42, s42, 65536
    s_add_u32 s43, s43, 1024

    s_waitcnt vmcnt(36)
    v_mfma_f32_32x32x16_bf16 v[16:31], v[76:79], v[72:75], v[16:31]
    buffer_load_dwordx4 v[72:75], v8, s[32:35], s42 offen
    buffer_load_dwordx4 v[76:79], v7, s[32:35], s43 offen
    s_add_u32 s42, s42, 65536
    s_add_u32 s43, s43, 1024

    s_waitcnt vmcnt(36)
    v_mfma_f32_32x32x16_bf16 v[16:31], v[84:87], v[80:83], v[16:31]
    buffer_load_dwordx4 v[80:83], v8, s[32:35], s42 offen
    buffer_load_dwordx4 v[84:87], v7, s[32:35], s43 offen
    s_add_u32 s42, s42, 65536
    s_add_u32 s43, s43, 1024

    s_waitcnt vmcnt(36)
    v_mfma_f32_32x32x16_bf16 v[16:31], v[92:95], v[88:91], v[16:31]
    buffer_load_dwordx4 v[88:91], v8, s[32:35], s42 offen
    buffer_load_dwordx4 v[92:95], v7, s[32:35], s43 offen
    s_add_u32 s42, s42, 65536
    s_add_u32 s43, s43, 1024

    s_waitcnt vmcnt(36)
    v_mfma_f32_32x32x16_bf16 v[16:31], v[100:103], v[96:99], v[16:31]
    buffer_load_dwordx4 v[96:99], v8, s[32:35], s42 offen
    buffer_load_dwordx4 v[100:103], v7, s[32:35], s43 offen
    s_add_u32 s42, s42, 65536
    s_add_u32 s43, s43, 1024

    s_waitcnt vmcnt(36)
    v_mfma_f32_32x32x16_bf16 v[16:31], v[108:111], v[104:107], v[16:31]
    buffer_load_dwordx4 v[104:107], v8, s[32:35], s42 offen
    buffer_load_dwordx4 v[108:111], v7, s[32:35], s43 offen
    s_add_u32 s42, s42, 65536
    s_add_u32 s43, s43, 1024

    s_waitcnt vmcnt(36)
    v_mfma_f32_32x32x16_bf16 v[16:31], v[116:119], v[112:115], v[16:31]
    buffer_load_dwordx4 v[112:115], v8, s[32:35], s42 offen
    buffer_load_dwordx4 v[116:119], v7, s[32:35], s43 offen
    s_add_u32 s42, s42, 65536
    s_add_u32 s43, s43, 1024

    s_waitcnt vmcnt(36)
    v_mfma_f32_32x32x16_bf16 v[16:31], v[124:127], v[120:123], v[16:31]
    buffer_load_dwordx4 v[120:123], v8, s[32:35], s42 offen
    buffer_load_dwordx4 v[124:127], v7, s[32:35], s43 offen
    s_add_u32 s42, s42, 65536
    s_add_u32 s43, s43, 1024

    s_waitcnt vmcnt(36)
    v_mfma_f32_32x32x16_bf16 v[16:31], v[132:135], v[128:131], v[16:31]
    buffer_load_dwordx4 v[128:131], v8, s[32:35], s42 offen
    buffer_load_dwordx4 v[132:135], v7, s[32:35], s43 offen
    s_add_u32 s42, s42, 65536
    s_add_u32 s43, s43, 1024

    s_waitcnt vmcnt(36)
    v_mfma_f32_32x32x16_bf16 v[16:31], v[140:143], v[136:139], v[16:31]
    buffer_load_dwordx4 v[136:139], v8, s[32:35], s42 offen
    buffer_load_dwordx4 v[140:143], v7, s[32:35], s43 offen
    s_add_u32 s42, s42, 65536
    s_add_u32 s43, s43, 1024

    s_waitcnt vmcnt(36)
    v_mfma_f32_32x32x16_bf16 v[16:31], v[148:151], v[144:147], v[16:31]
    buffer_load_dwordx4 v[144:147], v8, s[32:35], s42 offen
    buffer_load_dwordx4 v[148:151], v7, s[32:35], s43 offen
    s_add_u32 s42, s42, 65536
    s_add_u32 s43, s43, 1024

    s_waitcnt vmcnt(36)
    v_mfma_f32_32x32x16_bf16 v[16:31], v[156:159], v[152:155], v[16:31]
    buffer_load_dwordx4 v[152:155], v8, s[32:35], s42 offen
    buffer_load_dwordx4 v[156:159], v7, s[32:35], s43 offen
    s_add_u32 s42, s42, 65536
    s_add_u32 s43, s43, 1024

    s_waitcnt vmcnt(36)
    v_mfma_f32_32x32x16_bf16 v[16:31], v[164:167], v[160:163], v[16:31]
    buffer_load_dwordx4 v[160:163], v8, s[32:35], s42 offen
    buffer_load_dwordx4 v[164:167], v7, s[32:35], s43 offen
    s_add_u32 s42, s42, 65536
    s_add_u32 s43, s43, 1024

    s_waitcnt vmcnt(36)
    v_mfma_f32_32x32x16_bf16 v[16:31], v[172:175], v[168:171], v[16:31]
    buffer_load_dwordx4 v[168:171], v8, s[32:35], s42 offen
    buffer_load_dwordx4 v[172:175], v7, s[32:35], s43 offen
    s_add_u32 s42, s42, 65536
    s_add_u32 s43, s43, 1024

    s_waitcnt vmcnt(36)
    v_mfma_f32_32x32x16_bf16 v[16:31], v[180:183], v[176:179], v[16:31]
    buffer_load_dwordx4 v[176:179], v8, s[32:35], s42 offen
    buffer_load_dwordx4 v[180:183], v7, s[32:35], s43 offen
    s_add_u32 s42, s42, 65536
    s_add_u32 s43, s43, 1024

    s_waitcnt vmcnt(36)
    v_mfma_f32_32x32x16_bf16 v[16:31], v[188:191], v[184:187], v[16:31]
    buffer_load_dwordx4 v[184:187], v8, s[32:35], s42 offen
    buffer_load_dwordx4 v[188:191], v7, s[32:35], s43 offen
    s_add_u32 s42, s42, 65536
    s_add_u32 s43, s43, 1024

    s_waitcnt vmcnt(30)
    v_mfma_f32_32x32x16_bf16 v[16:31], v[68:71], v[64:67], v[16:31]
    s_waitcnt vmcnt(28)
    v_mfma_f32_32x32x16_bf16 v[16:31], v[76:79], v[72:75], v[16:31]
    s_waitcnt vmcnt(26)
    v_mfma_f32_32x32x16_bf16 v[16:31], v[84:87], v[80:83], v[16:31]
    s_waitcnt vmcnt(24)
    v_mfma_f32_32x32x16_bf16 v[16:31], v[92:95], v[88:91], v[16:31]
    s_waitcnt vmcnt(22)
    v_mfma_f32_32x32x16_bf16 v[16:31], v[100:103], v[96:99], v[16:31]
    s_waitcnt vmcnt(20)
    v_mfma_f32_32x32x16_bf16 v[16:31], v[108:111], v[104:107], v[16:31]
    s_waitcnt vmcnt(18)
    v_mfma_f32_32x32x16_bf16 v[16:31], v[116:119], v[112:115], v[16:31]
    s_waitcnt vmcnt(16)
    v_mfma_f32_32x32x16_bf16 v[16:31], v[124:127], v[120:123], v[16:31]
    s_waitcnt vmcnt(14)
    v_mfma_f32_32x32x16_bf16 v[16:31], v[132:135], v[128:131], v[16:31]
    s_waitcnt vmcnt(12)
    v_mfma_f32_32x32x16_bf16 v[16:31], v[140:143], v[136:139], v[16:31]
    s_waitcnt vmcnt(10)
    v_mfma_f32_32x32x16_bf16 v[16:31], v[148:151], v[144:147], v[16:31]
    s_waitcnt vmcnt(8)
    v_mfma_f32_32x32x16_bf16 v[16:31], v[156:159], v[152:155], v[16:31]
    s_waitcnt vmcnt(6)
    v_mfma_f32_32x32x16_bf16 v[16:31], v[164:167], v[160:163], v[16:31]
    s_waitcnt vmcnt(4)
    v_mfma_f32_32x32x16_bf16 v[16:31], v[172:175], v[168:171], v[16:31]
    s_waitcnt vmcnt(2)
    v_mfma_f32_32x32x16_bf16 v[16:31], v[180:183], v[176:179], v[16:31]
    s_waitcnt vmcnt(0)
    v_mfma_f32_32x32x16_bf16 v[16:31], v[188:191], v[184:187], v[16:31]
    s_nop 15
    v_add_f32 v16, v32, v16
    v_add_f32 v17, v33, v17
    v_add_f32 v18, v34, v18
    v_add_f32 v19, v35, v19
    v_add_f32 v20, v36, v20
    v_add_f32 v21, v37, v21
    v_add_f32 v22, v38, v22
    v_add_f32 v23, v39, v23
    v_add_f32 v24, v40, v24
    v_add_f32 v25, v41, v25
    v_add_f32 v26, v42, v26
    v_add_f32 v27, v43, v27
    v_add_f32 v28, v44, v28
    v_add_f32 v29, v45, v29
    v_add_f32 v30, v46, v30
    v_add_f32 v31, v47, v31
    v_permlane32_swap_b32 v16, v20
    v_permlane32_swap_b32 v17, v21
    v_permlane32_swap_b32 v18, v22
    v_permlane32_swap_b32 v19, v23

    v_permlane32_swap_b32 v24, v28
    v_permlane32_swap_b32 v25, v29
    v_permlane32_swap_b32 v26, v30
    v_permlane32_swap_b32 v27, v31

    v_lshlrev_b32 v40, 16, v48
    v_and_b32 v41, 0xffff0000, v48
    v_add_f32 v16, v40, v16
    v_add_f32 v17, v41, v17
    v_cvt_pk_bf16_f32 v56, v16, v17

    v_lshlrev_b32 v40, 16, v49
    v_and_b32 v41, 0xffff0000, v49
    v_add_f32 v18, v40, v18
    v_add_f32 v19, v41, v19
    v_cvt_pk_bf16_f32 v57, v18, v19

    v_lshlrev_b32 v40, 16, v50
    v_and_b32 v41, 0xffff0000, v50
    v_add_f32 v20, v40, v20
    v_add_f32 v21, v41, v21
    v_cvt_pk_bf16_f32 v58, v20, v21

    v_lshlrev_b32 v40, 16, v51
    v_and_b32 v41, 0xffff0000, v51
    v_add_f32 v22, v40, v22
    v_add_f32 v23, v41, v23
    v_cvt_pk_bf16_f32 v59, v22, v23

    v_lshlrev_b32 v40, 16, v52
    v_and_b32 v41, 0xffff0000, v52
    v_add_f32 v24, v40, v24
    v_add_f32 v25, v41, v25
    v_cvt_pk_bf16_f32 v60, v24, v25

    v_lshlrev_b32 v40, 16, v53
    v_and_b32 v41, 0xffff0000, v53
    v_add_f32 v26, v40, v26
    v_add_f32 v27, v41, v27
    v_cvt_pk_bf16_f32 v61, v26, v27

    v_lshlrev_b32 v40, 16, v54
    v_and_b32 v41, 0xffff0000, v54
    v_add_f32 v28, v40, v28
    v_add_f32 v29, v41, v29
    v_cvt_pk_bf16_f32 v62, v28, v29

    v_lshlrev_b32 v40, 16, v55
    v_and_b32 v41, 0xffff0000, v55
    v_add_f32 v30, v40, v30
    v_add_f32 v31, v41, v31
    v_cvt_pk_bf16_f32 v63, v30, v31

    buffer_store_dwordx4 v[56:59], v6, s[28:31], s45 offen
    buffer_store_dwordx4 v[60:63], v6, s[28:31], s45 offen offset:32

K3_end:
    s_endpgm
.section .rodata,"a"
.p2align 6
.amdhsa_kernel k1_kernel
  .amdhsa_next_free_vgpr 256
  .amdhsa_next_free_sgpr 102
  .amdhsa_accum_offset 256
  .amdhsa_group_segment_fixed_size 0
  .amdhsa_kernarg_size 80
  .amdhsa_user_sgpr_count 2
  .amdhsa_user_sgpr_kernarg_segment_ptr 1
  .amdhsa_system_sgpr_workgroup_id_x 1
.end_amdhsa_kernel

.p2align 6
.amdhsa_kernel k2_kernel
  .amdhsa_next_free_vgpr 192
  .amdhsa_next_free_sgpr 102
  .amdhsa_accum_offset 192
  .amdhsa_group_segment_fixed_size 0
  .amdhsa_kernarg_size 80
  .amdhsa_user_sgpr_count 2
  .amdhsa_user_sgpr_kernarg_segment_ptr 1
  .amdhsa_system_sgpr_workgroup_id_x 1
.end_amdhsa_kernel

.p2align 6
.amdhsa_kernel k3_kernel
  .amdhsa_next_free_vgpr 192
  .amdhsa_next_free_sgpr 102
  .amdhsa_accum_offset 192
  .amdhsa_group_segment_fixed_size 0
  .amdhsa_kernarg_size 80
  .amdhsa_user_sgpr_count 2
  .amdhsa_user_sgpr_kernarg_segment_ptr 1
  .amdhsa_system_sgpr_workgroup_id_x 1
.end_amdhsa_kernel
```
